```python
import torch

def _softmax(x, axis=-1):
    return torch.softmax(x, dim=axis)

def _gelu(x):
    return torch.nn.functional.gelu(x, approximate='tanh')

def _silu(x):
    return torch.nn.functional.silu(x)

def _sigmoid(x):
    return torch.sigmoid(x)

def _layernorm(x, axis=-1, eps=1e-05):
    m = x.mean(dim=axis, keepdim=True)
    v = x.var(dim=axis, keepdim=True, unbiased=False)
    return (x - m) / torch.sqrt(v + eps)

def _scatter_add(tgt, idx, src, axis=0):
    return tgt.clone().index_add_(axis, idx, src)

def _segment_sum(src, seg, n):
    out = torch.zeros((n,) + src.shape[1:], dtype=src.dtype)
    return out.index_add_(0, seg, src)

def _pad(x, pw):
    flat = tuple((v for pair in reversed(pw) for v in pair))
    return torch.nn.functional.pad(x, flat)
kernel_name = 'adaLN_cond__sliding_local_dilated__glu_gated_bilinear__prompt'

def setup_inputs():

    _w = lambda a: (lambda t: t.to(torch.bfloat16) if t.is_floating_point() else t)(torch.as_tensor(a))

    def _A_setup():
        B, S, D = (1, 2048, 576)
        return {'x': _w((lambda *s: torch.randn(*s, dtype=torch.bfloat16) * 0.05)(B, S, D)), 'wqkv': _w((lambda *s: torch.randn(*s, dtype=torch.bfloat16) * 0.05)(D, 3 * D)), 'wo': _w((lambda *s: torch.randn(*s, dtype=torch.bfloat16) * 0.05)(D, D))}
    _A_in = _A_setup()

    def _B_setup():
        B, S, D, F = (1, 2048, 576, 4608)
        return {'x': _w((lambda *s: torch.randn(*s, dtype=torch.bfloat16) * 0.05)(B, S, D)), 'w_gate': _w((lambda *s: torch.randn(*s, dtype=torch.bfloat16) * 0.8)(D, F) * D ** (-0.5)), 'w_up': _w((lambda *s: torch.randn(*s, dtype=torch.bfloat16) * 0.8)(D, F) * D ** (-0.5)), 'w_down': _w((lambda *s: torch.randn(*s, dtype=torch.bfloat16) * 0.8)(F, D) * F ** (-0.5))}
    _B_in = _B_setup()
    return {'A_x': _A_in['x'], 'A_wqkv': _A_in['wqkv'], 'A_wo': _A_in['wo'], 'B_x': _B_in['x'], 'B_w_gate': _B_in['w_gate'], 'B_w_up': _B_in['w_up'], 'B_w_down': _B_in['w_down'], 'c': _w((lambda *s: torch.randn(*s, dtype=torch.bfloat16) * 0.1)(1, 576) * 8.0), 'w_mod': _w((lambda *s: torch.randn(*s, dtype=torch.bfloat16) * 0.1)(576, 6 * 576) * 576 ** (-0.5) * 8.0)}

def reference(A_x, A_wqkv, A_wo, B_x, B_w_gate, B_w_up, B_w_down, c, w_mod):

    def _A_ref(x, wqkv, wo):
        B, S, D = x.shape
        H = 32
        Dh = D // H
        W, dil = (8, 2)
        qkv = (lambda x, *d: x.permute(*d))((x @ wqkv).reshape(B, S, 3, H, Dh), 2, 0, 3, 1, 4)
        q, k, v = (qkv[0], qkv[1], qkv[2])
        scale = Dh ** (-0.5)
        pos = torch.arange(S)
        off = torch.arange(W) * dil
        idx = pos[:, None] - off[None, :]
        mask = idx >= 0
        idx_c = torch.where(mask, idx, 0).reshape(-1)
        kg = k[:, :, idx_c, :].reshape(B, H, S, W, Dh)
        vg = v[:, :, idx_c, :].reshape(B, H, S, W, Dh)
        logits = torch.einsum('bhsd,bhswd->bhsw', q, kg) * scale
        logits = torch.where(mask[None, None, :, :], logits, -1000000000.0)
        attn = _softmax(logits, axis=-1)
        o = torch.einsum('bhsw,bhswd->bhsd', attn, vg)
        return (lambda x, *d: x.permute(*d))(o, 0, 2, 1, 3).reshape(B, S, D) @ wo

    def _B_ref(x, w_gate, w_up, w_down):
        g = torch.einsum('bsd,df->bsf', x, w_gate)
        u = torch.einsum('bsd,df->bsf', x, w_up)
        h = g * u
        return torch.einsum('bsf,fd->bsd', h, w_down)
    x = A_x
    mod = (_silu(c) @ w_mod).reshape(c.shape[0], 6, 1, -1)
    sa, ca, ga, sb, cb, gb = (mod[:, 0].clone(), mod[:, 1].clone(), mod[:, 2].clone(), mod[:, 3].clone(), mod[:, 4].clone(), mod[:, 5].clone())
    h = _layernorm(x, axis=-1) * (1 + ca) + sa
    x = x + ga * _A_ref(h, A_wqkv, A_wo)
    h = _layernorm(x, axis=-1) * (1 + cb) + sb
    x = x + gb * _B_ref(h, B_w_gate, B_w_up, B_w_down)
    return x
```

```asm
; @launch kernel=prep_kernel grid=(317,1,1) block=(256,1,1) lds=12288
; @launch kernel=qkv_kernel grid=(256,1,1) block=(256,1,1) lds=163584
; @launch kernel=wo_kernel grid=(256,1,1) block=(256,1,1) lds=40960
; @launch kernel=mlp_kernel grid=(256,1,1) block=(256,1,1) lds=147456
; @launch kernel=reduce_kernel grid=(576,1,1) block=(256,1,1) lds=0
.amdgcn_target "amdgcn-amd-amdhsa--gfx950"
.text
.globl prep_kernel
.p2align 8
.type prep_kernel,@function
prep_kernel:
s_cmp_ge_u32 s2, 317
s_cbranch_scc1 L_prep_end
s_load_dwordx4 s[4:7], s[0:1], 0
s_load_dwordx2 s[40:41], s[0:1], 16
s_load_dwordx4 s[44:47], s[0:1], 56
s_load_dwordx4 s[68:71], s[0:1], 80
s_load_dwordx4 s[48:51], s[0:1], 32
s_load_dwordx2 s[52:53], s[0:1], 48
v_lshrrev_b32 v1, 6, v0
v_and_b32 v2, 63, v0
s_nop 0
v_readfirstlane_b32 s3, v1
s_waitcnt lgkmcnt(0)
s_mov_b32 s8, s4
s_and_b32 s9, s5, 0xffff
s_mov_b32 s10, 2359296
s_mov_b32 s11, 0x00020000
s_mov_b32 s12, s6
s_and_b32 s13, s7, 0xffff
s_mov_b32 s14, 1990656
s_mov_b32 s15, 0x00020000
s_mov_b32 s16, s40
s_and_b32 s17, s41, 0xffff
s_mov_b32 s18, 663552
s_mov_b32 s19, 0x00020000
s_mov_b32 s20, s44
s_and_b32 s21, s45, 0xffff
s_mov_b32 s22, 1152
s_mov_b32 s23, 0x00020000
s_mov_b32 s24, s46
s_and_b32 s25, s47, 0xffff
s_mov_b32 s26, 3981312
s_mov_b32 s27, 0x00020000
s_mov_b32 s28, s70
s_and_b32 s29, s71, 0xffff
s_mov_b32 s30, 268435456
s_mov_b32 s31, 0x00020000
s_cmp_ge_u32 s2, 218
s_cbranch_scc1 L_prep_pack
s_cmp_ge_u32 s2, 90
s_cbranch_scc1 L_prep_ln
s_mul_hi_u32 s33, s2, 238609295
s_mul_i32 s34, s33, 18
s_sub_u32 s34, s2, s34
s_mul_i32 s36, s33, 1327104
s_lshl_b32 s35, s34, 7
s_add_u32 s36, s36, s35
s_sub_u32 s37, s2, 36
s_lshl_b32 s37, s37, 7
s_cmp_ge_u32 s2, 54
s_cselect_b32 s36, s37, s36
s_mul_i32 s38, s33, 768
s_cselect_b32 s38, 0, s38
v_lshlrev_b32 v3, 1, v0
buffer_load_ushort v4, v3, s[20:23], 0 offen
buffer_load_ushort v5, v3, s[20:23], 0 offen offset:512
buffer_load_ushort v6, v3, s[20:23], 0 offen offset:1024
v_lshrrev_b32 v7, 3, v0
v_mul_u32_u24 v7, 6912, v7
v_and_b32 v8, 7, v0
v_lshl_add_u32 v7, v8, 4, v7
buffer_load_dwordx4 v[16:19], v7, s[24:27], s36 offen
s_add_u32 s36, s36, 221184
buffer_load_dwordx4 v[20:23], v7, s[24:27], s36 offen
s_add_u32 s36, s36, 221184
buffer_load_dwordx4 v[24:27], v7, s[24:27], s36 offen
s_add_u32 s36, s36, 221184
buffer_load_dwordx4 v[28:31], v7, s[24:27], s36 offen
s_add_u32 s36, s36, 221184
buffer_load_dwordx4 v[32:35], v7, s[24:27], s36 offen
s_add_u32 s36, s36, 221184
buffer_load_dwordx4 v[36:39], v7, s[24:27], s36 offen
s_add_u32 s36, s36, 221184
s_cmp_lt_u32 s2, 54
s_cbranch_scc1 L_prep_b6
buffer_load_dwordx4 v[40:43], v7, s[24:27], s36 offen
s_add_u32 s36, s36, 221184
buffer_load_dwordx4 v[44:47], v7, s[24:27], s36 offen
s_add_u32 s36, s36, 221184
buffer_load_dwordx4 v[48:51], v7, s[24:27], s36 offen
s_add_u32 s36, s36, 221184
buffer_load_dwordx4 v[52:55], v7, s[24:27], s36 offen
s_add_u32 s36, s36, 221184
buffer_load_dwordx4 v[56:59], v7, s[24:27], s36 offen
s_add_u32 s36, s36, 221184
buffer_load_dwordx4 v[60:63], v7, s[24:27], s36 offen
s_add_u32 s36, s36, 221184
buffer_load_dwordx4 v[64:67], v7, s[24:27], s36 offen
s_add_u32 s36, s36, 221184
buffer_load_dwordx4 v[68:71], v7, s[24:27], s36 offen
s_add_u32 s36, s36, 221184
buffer_load_dwordx4 v[72:75], v7, s[24:27], s36 offen
s_add_u32 s36, s36, 221184
buffer_load_dwordx4 v[76:79], v7, s[24:27], s36 offen
s_add_u32 s36, s36, 221184
buffer_load_dwordx4 v[80:83], v7, s[24:27], s36 offen
s_add_u32 s36, s36, 221184
buffer_load_dwordx4 v[84:87], v7, s[24:27], s36 offen
s_waitcnt vmcnt(18)
s_branch L_prep_b7
L_prep_b6:
s_waitcnt vmcnt(6)
L_prep_b7:
v_lshlrev_b32 v4, 16, v4
v_mul_f32 v12, 0xbfb8aa3b, v4
v_exp_f32 v12, v12
s_nop 0
v_add_f32 v12, 1.0, v12
v_rcp_f32 v12, v12
s_nop 0
v_mul_f32 v12, v4, v12
v_cvt_pk_bf16_f32 v12, v12, 0
v_lshlrev_b32 v13, 2, v0
ds_write_b32 v13, v12 offset:0
v_lshlrev_b32 v5, 16, v5
v_mul_f32 v12, 0xbfb8aa3b, v5
v_exp_f32 v12, v12
s_nop 0
v_add_f32 v12, 1.0, v12
v_rcp_f32 v12, v12
s_nop 0
v_mul_f32 v12, v5, v12
v_cvt_pk_bf16_f32 v12, v12, 0
v_lshlrev_b32 v13, 2, v0
ds_write_b32 v13, v12 offset:1024
v_lshlrev_b32 v6, 16, v6
v_mul_f32 v12, 0xbfb8aa3b, v6
v_exp_f32 v12, v12
s_nop 0
v_add_f32 v12, 1.0, v12
v_rcp_f32 v12, v12
s_nop 0
v_mul_f32 v12, v6, v12
v_cvt_pk_bf16_f32 v12, v12, 0
v_lshlrev_b32 v13, 2, v0
v_cmp_gt_u32 vcc, 64, v0
s_and_saveexec_b64 s[54:55], vcc
ds_write_b32 v13, v12 offset:2048
s_mov_b64 exec, s[54:55]
s_waitcnt lgkmcnt(0)
s_barrier
v_lshrrev_b32 v13, 3, v0
v_lshlrev_b32 v13, 2, v13
v_add_u32 v13, s38, v13
s_cmp_lt_u32 s2, 54
s_cbranch_scc1 L_prep_third
v_mov_b32 v120, 0
v_mov_b32 v121, 0
v_mov_b32 v122, 0
v_mov_b32 v123, 0
v_mov_b32 v124, 0
v_mov_b32 v125, 0
v_mov_b32 v126, 0
v_mov_b32 v127, 0
ds_read_b32 v132, v13 offset:0
ds_read_b32 v133, v13 offset:128
ds_read_b32 v134, v13 offset:256
ds_read_b32 v135, v13 offset:384
ds_read_b32 v136, v13 offset:512
ds_read_b32 v137, v13 offset:640
ds_read_b32 v138, v13 offset:768
ds_read_b32 v139, v13 offset:896
ds_read_b32 v140, v13 offset:1024
s_waitcnt vmcnt(0) lgkmcnt(0)
v_lshlrev_b32 v131, 16, v132
v_dot2c_f32_bf16 v120, v16, v132
v_dot2c_f32_bf16 v121, v16, v131
v_dot2c_f32_bf16 v122, v17, v132
v_dot2c_f32_bf16 v123, v17, v131
v_dot2c_f32_bf16 v124, v18, v132
v_dot2c_f32_bf16 v125, v18, v131
v_dot2c_f32_bf16 v126, v19, v132
v_dot2c_f32_bf16 v127, v19, v131
v_lshlrev_b32 v131, 16, v133
v_dot2c_f32_bf16 v120, v20, v133
v_dot2c_f32_bf16 v121, v20, v131
v_dot2c_f32_bf16 v122, v21, v133
v_dot2c_f32_bf16 v123, v21, v131
v_dot2c_f32_bf16 v124, v22, v133
v_dot2c_f32_bf16 v125, v22, v131
v_dot2c_f32_bf16 v126, v23, v133
v_dot2c_f32_bf16 v127, v23, v131
v_lshlrev_b32 v131, 16, v134
v_dot2c_f32_bf16 v120, v24, v134
v_dot2c_f32_bf16 v121, v24, v131
v_dot2c_f32_bf16 v122, v25, v134
v_dot2c_f32_bf16 v123, v25, v131
v_dot2c_f32_bf16 v124, v26, v134
v_dot2c_f32_bf16 v125, v26, v131
v_dot2c_f32_bf16 v126, v27, v134
v_dot2c_f32_bf16 v127, v27, v131
v_lshlrev_b32 v131, 16, v135
v_dot2c_f32_bf16 v120, v28, v135
v_dot2c_f32_bf16 v121, v28, v131
v_dot2c_f32_bf16 v122, v29, v135
v_dot2c_f32_bf16 v123, v29, v131
v_dot2c_f32_bf16 v124, v30, v135
v_dot2c_f32_bf16 v125, v30, v131
v_dot2c_f32_bf16 v126, v31, v135
v_dot2c_f32_bf16 v127, v31, v131
v_lshlrev_b32 v131, 16, v136
v_dot2c_f32_bf16 v120, v32, v136
v_dot2c_f32_bf16 v121, v32, v131
v_dot2c_f32_bf16 v122, v33, v136
v_dot2c_f32_bf16 v123, v33, v131
v_dot2c_f32_bf16 v124, v34, v136
v_dot2c_f32_bf16 v125, v34, v131
v_dot2c_f32_bf16 v126, v35, v136
v_dot2c_f32_bf16 v127, v35, v131
v_lshlrev_b32 v131, 16, v137
v_dot2c_f32_bf16 v120, v36, v137
v_dot2c_f32_bf16 v121, v36, v131
v_dot2c_f32_bf16 v122, v37, v137
v_dot2c_f32_bf16 v123, v37, v131
v_dot2c_f32_bf16 v124, v38, v137
v_dot2c_f32_bf16 v125, v38, v131
v_dot2c_f32_bf16 v126, v39, v137
v_dot2c_f32_bf16 v127, v39, v131
v_lshlrev_b32 v131, 16, v138
v_dot2c_f32_bf16 v120, v40, v138
v_dot2c_f32_bf16 v121, v40, v131
v_dot2c_f32_bf16 v122, v41, v138
v_dot2c_f32_bf16 v123, v41, v131
v_dot2c_f32_bf16 v124, v42, v138
v_dot2c_f32_bf16 v125, v42, v131
v_dot2c_f32_bf16 v126, v43, v138
v_dot2c_f32_bf16 v127, v43, v131
v_lshlrev_b32 v131, 16, v139
v_dot2c_f32_bf16 v120, v44, v139
v_dot2c_f32_bf16 v121, v44, v131
v_dot2c_f32_bf16 v122, v45, v139
v_dot2c_f32_bf16 v123, v45, v131
v_dot2c_f32_bf16 v124, v46, v139
v_dot2c_f32_bf16 v125, v46, v131
v_dot2c_f32_bf16 v126, v47, v139
v_dot2c_f32_bf16 v127, v47, v131
v_lshlrev_b32 v131, 16, v140
v_dot2c_f32_bf16 v120, v48, v140
v_dot2c_f32_bf16 v121, v48, v131
v_dot2c_f32_bf16 v122, v49, v140
v_dot2c_f32_bf16 v123, v49, v131
v_dot2c_f32_bf16 v124, v50, v140
v_dot2c_f32_bf16 v125, v50, v131
v_dot2c_f32_bf16 v126, v51, v140
v_dot2c_f32_bf16 v127, v51, v131
ds_read_b32 v132, v13 offset:1152
ds_read_b32 v133, v13 offset:1280
ds_read_b32 v134, v13 offset:1408
ds_read_b32 v135, v13 offset:1536
ds_read_b32 v136, v13 offset:1664
ds_read_b32 v137, v13 offset:1792
ds_read_b32 v138, v13 offset:1920
ds_read_b32 v139, v13 offset:2048
ds_read_b32 v140, v13 offset:2176
s_waitcnt vmcnt(0) lgkmcnt(0)
v_lshlrev_b32 v131, 16, v132
v_dot2c_f32_bf16 v120, v52, v132
v_dot2c_f32_bf16 v121, v52, v131
v_dot2c_f32_bf16 v122, v53, v132
v_dot2c_f32_bf16 v123, v53, v131
v_dot2c_f32_bf16 v124, v54, v132
v_dot2c_f32_bf16 v125, v54, v131
v_dot2c_f32_bf16 v126, v55, v132
v_dot2c_f32_bf16 v127, v55, v131
v_lshlrev_b32 v131, 16, v133
v_dot2c_f32_bf16 v120, v56, v133
v_dot2c_f32_bf16 v121, v56, v131
v_dot2c_f32_bf16 v122, v57, v133
v_dot2c_f32_bf16 v123, v57, v131
v_dot2c_f32_bf16 v124, v58, v133
v_dot2c_f32_bf16 v125, v58, v131
v_dot2c_f32_bf16 v126, v59, v133
v_dot2c_f32_bf16 v127, v59, v131
v_lshlrev_b32 v131, 16, v134
v_dot2c_f32_bf16 v120, v60, v134
v_dot2c_f32_bf16 v121, v60, v131
v_dot2c_f32_bf16 v122, v61, v134
v_dot2c_f32_bf16 v123, v61, v131
v_dot2c_f32_bf16 v124, v62, v134
v_dot2c_f32_bf16 v125, v62, v131
v_dot2c_f32_bf16 v126, v63, v134
v_dot2c_f32_bf16 v127, v63, v131
v_lshlrev_b32 v131, 16, v135
v_dot2c_f32_bf16 v120, v64, v135
v_dot2c_f32_bf16 v121, v64, v131
v_dot2c_f32_bf16 v122, v65, v135
v_dot2c_f32_bf16 v123, v65, v131
v_dot2c_f32_bf16 v124, v66, v135
v_dot2c_f32_bf16 v125, v66, v131
v_dot2c_f32_bf16 v126, v67, v135
v_dot2c_f32_bf16 v127, v67, v131
v_lshlrev_b32 v131, 16, v136
v_dot2c_f32_bf16 v120, v68, v136
v_dot2c_f32_bf16 v121, v68, v131
v_dot2c_f32_bf16 v122, v69, v136
v_dot2c_f32_bf16 v123, v69, v131
v_dot2c_f32_bf16 v124, v70, v136
v_dot2c_f32_bf16 v125, v70, v131
v_dot2c_f32_bf16 v126, v71, v136
v_dot2c_f32_bf16 v127, v71, v131
v_lshlrev_b32 v131, 16, v137
v_dot2c_f32_bf16 v120, v72, v137
v_dot2c_f32_bf16 v121, v72, v131
v_dot2c_f32_bf16 v122, v73, v137
v_dot2c_f32_bf16 v123, v73, v131
v_dot2c_f32_bf16 v124, v74, v137
v_dot2c_f32_bf16 v125, v74, v131
v_dot2c_f32_bf16 v126, v75, v137
v_dot2c_f32_bf16 v127, v75, v131
v_lshlrev_b32 v131, 16, v138
v_dot2c_f32_bf16 v120, v76, v138
v_dot2c_f32_bf16 v121, v76, v131
v_dot2c_f32_bf16 v122, v77, v138
v_dot2c_f32_bf16 v123, v77, v131
v_dot2c_f32_bf16 v124, v78, v138
v_dot2c_f32_bf16 v125, v78, v131
v_dot2c_f32_bf16 v126, v79, v138
v_dot2c_f32_bf16 v127, v79, v131
v_lshlrev_b32 v131, 16, v139
v_dot2c_f32_bf16 v120, v80, v139
v_dot2c_f32_bf16 v121, v80, v131
v_dot2c_f32_bf16 v122, v81, v139
v_dot2c_f32_bf16 v123, v81, v131
v_dot2c_f32_bf16 v124, v82, v139
v_dot2c_f32_bf16 v125, v82, v131
v_dot2c_f32_bf16 v126, v83, v139
v_dot2c_f32_bf16 v127, v83, v131
v_lshlrev_b32 v131, 16, v140
v_dot2c_f32_bf16 v120, v84, v140
v_dot2c_f32_bf16 v121, v84, v131
v_dot2c_f32_bf16 v122, v85, v140
v_dot2c_f32_bf16 v123, v85, v131
v_dot2c_f32_bf16 v124, v86, v140
v_dot2c_f32_bf16 v125, v86, v131
v_dot2c_f32_bf16 v126, v87, v140
v_dot2c_f32_bf16 v127, v87, v131
s_nop 1
v_permlane32_swap_b32 v120, v124
v_permlane32_swap_b32 v121, v125
v_permlane32_swap_b32 v122, v126
v_permlane32_swap_b32 v123, v127
s_nop 1
v_add_f32 v120, v120, v124
v_add_f32 v121, v121, v125
v_add_f32 v122, v122, v126
v_add_f32 v123, v123, v127
s_nop 1
v_permlane16_swap_b32 v120, v122
v_permlane16_swap_b32 v121, v123
s_nop 1
v_add_f32 v120, v120, v122
v_add_f32 v121, v121, v123
s_nop 1
v_add_f32_dpp v120, v120, v120 row_ror:8 row_mask:0xf bank_mask:0xf
v_add_f32_dpp v121, v121, v121 row_ror:8 row_mask:0xf bank_mask:0xf
v_and_b32 v12, 7, v2
v_lshlrev_b32 v12, 5, v12
v_lshrrev_b32 v14, 5, v2
v_lshl_add_u32 v12, v14, 4, v12
v_bfe_u32 v14, v2, 4, 1
v_lshl_add_u32 v12, v14, 3, v12
v_lshl_add_u32 v12, v1, 8, v12
ds_write_b64 v12, v[120:121] offset:4096
s_waitcnt lgkmcnt(0)
s_barrier
s_cmp_lg_u32 s3, 0
s_cbranch_scc1 L_prep_tail
v_lshlrev_b32 v13, 2, v2
ds_read_b32 v88, v13 offset:4096
ds_read_b32 v89, v13 offset:4352
ds_read_b32 v90, v13 offset:4608
ds_read_b32 v91, v13 offset:4864
s_waitcnt lgkmcnt(0)
v_add_f32 v88, v88, v89
v_add_f32 v90, v90, v91
v_add_f32 v88, v88, v90
s_sub_u32 s58, s2, 54
s_lshl_b32 s58, s58, 8
s_add_u32 s58, s58, 10485760
buffer_store_dword v88, v13, s[28:31], s58 offen
s_branch L_prep_tail
L_prep_third:
v_mov_b32 v120, 0
v_mov_b32 v121, 0
v_mov_b32 v122, 0
v_mov_b32 v123, 0
v_mov_b32 v124, 0
v_mov_b32 v125, 0
v_mov_b32 v126, 0
v_mov_b32 v127, 0
ds_read_b32 v132, v13 offset:0
ds_read_b32 v133, v13 offset:128
ds_read_b32 v134, v13 offset:256
ds_read_b32 v135, v13 offset:384
ds_read_b32 v136, v13 offset:512
ds_read_b32 v137, v13 offset:640
s_waitcnt vmcnt(0) lgkmcnt(0)
v_lshlrev_b32 v131, 16, v132
v_dot2c_f32_bf16 v120, v16, v132
v_dot2c_f32_bf16 v121, v16, v131
v_dot2c_f32_bf16 v122, v17, v132
v_dot2c_f32_bf16 v123, v17, v131
v_dot2c_f32_bf16 v124, v18, v132
v_dot2c_f32_bf16 v125, v18, v131
v_dot2c_f32_bf16 v126, v19, v132
v_dot2c_f32_bf16 v127, v19, v131
v_lshlrev_b32 v131, 16, v133
v_dot2c_f32_bf16 v120, v20, v133
v_dot2c_f32_bf16 v121, v20, v131
v_dot2c_f32_bf16 v122, v21, v133
v_dot2c_f32_bf16 v123, v21, v131
v_dot2c_f32_bf16 v124, v22, v133
v_dot2c_f32_bf16 v125, v22, v131
v_dot2c_f32_bf16 v126, v23, v133
v_dot2c_f32_bf16 v127, v23, v131
v_lshlrev_b32 v131, 16, v134
v_dot2c_f32_bf16 v120, v24, v134
v_dot2c_f32_bf16 v121, v24, v131
v_dot2c_f32_bf16 v122, v25, v134
v_dot2c_f32_bf16 v123, v25, v131
v_dot2c_f32_bf16 v124, v26, v134
v_dot2c_f32_bf16 v125, v26, v131
v_dot2c_f32_bf16 v126, v27, v134
v_dot2c_f32_bf16 v127, v27, v131
v_lshlrev_b32 v131, 16, v135
v_dot2c_f32_bf16 v120, v28, v135
v_dot2c_f32_bf16 v121, v28, v131
v_dot2c_f32_bf16 v122, v29, v135
v_dot2c_f32_bf16 v123, v29, v131
v_dot2c_f32_bf16 v124, v30, v135
v_dot2c_f32_bf16 v125, v30, v131
v_dot2c_f32_bf16 v126, v31, v135
v_dot2c_f32_bf16 v127, v31, v131
v_lshlrev_b32 v131, 16, v136
v_dot2c_f32_bf16 v120, v32, v136
v_dot2c_f32_bf16 v121, v32, v131
v_dot2c_f32_bf16 v122, v33, v136
v_dot2c_f32_bf16 v123, v33, v131
v_dot2c_f32_bf16 v124, v34, v136
v_dot2c_f32_bf16 v125, v34, v131
v_dot2c_f32_bf16 v126, v35, v136
v_dot2c_f32_bf16 v127, v35, v131
v_lshlrev_b32 v131, 16, v137
v_dot2c_f32_bf16 v120, v36, v137
v_dot2c_f32_bf16 v121, v36, v131
v_dot2c_f32_bf16 v122, v37, v137
v_dot2c_f32_bf16 v123, v37, v131
v_dot2c_f32_bf16 v124, v38, v137
v_dot2c_f32_bf16 v125, v38, v131
v_dot2c_f32_bf16 v126, v39, v137
v_dot2c_f32_bf16 v127, v39, v131
s_nop 1
v_permlane32_swap_b32 v120, v124
v_permlane32_swap_b32 v121, v125
v_permlane32_swap_b32 v122, v126
v_permlane32_swap_b32 v123, v127
s_nop 1
v_add_f32 v120, v120, v124
v_add_f32 v121, v121, v125
v_add_f32 v122, v122, v126
v_add_f32 v123, v123, v127
s_nop 1
v_permlane16_swap_b32 v120, v122
v_permlane16_swap_b32 v121, v123
s_nop 1
v_add_f32 v120, v120, v122
v_add_f32 v121, v121, v123
s_nop 1
v_add_f32_dpp v120, v120, v120 row_ror:8 row_mask:0xf bank_mask:0xf
v_add_f32_dpp v121, v121, v121 row_ror:8 row_mask:0xf bank_mask:0xf
v_and_b32 v12, 7, v2
v_lshlrev_b32 v12, 5, v12
v_lshrrev_b32 v14, 5, v2
v_lshl_add_u32 v12, v14, 4, v12
v_bfe_u32 v14, v2, 4, 1
v_lshl_add_u32 v12, v14, 3, v12
v_lshl_add_u32 v12, v1, 8, v12
ds_write_b64 v12, v[120:121] offset:4096
s_waitcnt lgkmcnt(0)
s_barrier
s_cmp_lg_u32 s3, 0
s_cbranch_scc1 L_prep_tail
v_lshlrev_b32 v13, 2, v2
ds_read_b32 v88, v13 offset:4096
ds_read_b32 v89, v13 offset:4352
ds_read_b32 v90, v13 offset:4608
ds_read_b32 v91, v13 offset:4864
s_waitcnt lgkmcnt(0)
v_add_f32 v88, v88, v89
v_add_f32 v90, v90, v91
v_add_f32 v88, v88, v90
s_cmp_ge_u32 s34, 9
s_cselect_b32 s57, 1.0, 0
s_cmp_eq_u32 s33, 0
s_cselect_b32 s57, s57, 0
v_add_f32 v88, s57, v88
s_mul_i32 s58, s33, 4608
s_lshl_b32 s59, s34, 8
s_add_u32 s58, s58, s59
s_add_u32 s58, s58, 10518528
buffer_store_dword v88, v13, s[28:31], s58 offen sc1
s_waitcnt vmcnt(0)
v_mov_b32 v12, 0
v_mov_b32 v14, 1
v_cmp_eq_u32 vcc, 0, v2
s_and_saveexec_b64 s[54:55], vcc
global_atomic_add v15, v12, v14, s[68:69] sc0 sc1
s_waitcnt vmcnt(0)
v_readfirstlane_b32 s59, v15
s_cmp_lg_u32 s59, 53
s_cbranch_scc1 L_prep_notlast
global_store_dword v12, v14, s[68:69] offset:128 sc1
L_prep_notlast:
s_mov_b64 exec, s[54:55]
s_branch L_prep_tail
L_prep_ln:
s_sub_u32 s32, s2, 90
v_and_b32 v9, 15, v2
v_lshrrev_b32 v11, 4, v2
v_mul_u32_u24 v10, 1152, v9
v_lshl_add_u32 v10, v11, 4, v10
s_mul_i32 s37, s32, 18432
s_lshl_b32 s38, s3, 6
s_add_u32 s37, s37, s38
buffer_load_dwordx4 v[16:19], v10, s[8:11], s37 offen offset:0
buffer_load_dwordx4 v[20:23], v10, s[8:11], s37 offen offset:256
buffer_load_dwordx4 v[24:27], v10, s[8:11], s37 offen offset:512
buffer_load_dwordx4 v[28:31], v10, s[8:11], s37 offen offset:768
v_mov_b32 v32, 0
v_mov_b32 v33, 0
v_mov_b32 v34, 0
v_mov_b32 v35, 0
s_cmp_ge_u32 s3, 2
s_cbranch_scc1 L_prep_ln4
buffer_load_dwordx4 v[32:35], v10, s[8:11], s37 offen offset:1024
L_prep_ln4:
s_mov_b32 s56, 0x3f803f80
v_mov_b32 v12, 0
v_mov_b32 v13, 0
s_waitcnt vmcnt(0)
v_dot2c_f32_bf16 v12, s56, v16
v_dot2c_f32_bf16 v13, v16, v16
v_dot2c_f32_bf16 v12, s56, v17
v_dot2c_f32_bf16 v13, v17, v17
v_dot2c_f32_bf16 v12, s56, v18
v_dot2c_f32_bf16 v13, v18, v18
v_dot2c_f32_bf16 v12, s56, v19
v_dot2c_f32_bf16 v13, v19, v19
v_dot2c_f32_bf16 v12, s56, v20
v_dot2c_f32_bf16 v13, v20, v20
v_dot2c_f32_bf16 v12, s56, v21
v_dot2c_f32_bf16 v13, v21, v21
v_dot2c_f32_bf16 v12, s56, v22
v_dot2c_f32_bf16 v13, v22, v22
v_dot2c_f32_bf16 v12, s56, v23
v_dot2c_f32_bf16 v13, v23, v23
v_dot2c_f32_bf16 v12, s56, v24
v_dot2c_f32_bf16 v13, v24, v24
v_dot2c_f32_bf16 v12, s56, v25
v_dot2c_f32_bf16 v13, v25, v25
v_dot2c_f32_bf16 v12, s56, v26
v_dot2c_f32_bf16 v13, v26, v26
v_dot2c_f32_bf16 v12, s56, v27
v_dot2c_f32_bf16 v13, v27, v27
v_dot2c_f32_bf16 v12, s56, v28
v_dot2c_f32_bf16 v13, v28, v28
v_dot2c_f32_bf16 v12, s56, v29
v_dot2c_f32_bf16 v13, v29, v29
v_dot2c_f32_bf16 v12, s56, v30
v_dot2c_f32_bf16 v13, v30, v30
v_dot2c_f32_bf16 v12, s56, v31
v_dot2c_f32_bf16 v13, v31, v31
v_dot2c_f32_bf16 v12, s56, v32
v_dot2c_f32_bf16 v13, v32, v32
v_dot2c_f32_bf16 v12, s56, v33
v_dot2c_f32_bf16 v13, v33, v33
v_dot2c_f32_bf16 v12, s56, v34
v_dot2c_f32_bf16 v13, v34, v34
v_dot2c_f32_bf16 v12, s56, v35
v_dot2c_f32_bf16 v13, v35, v35
v_lshlrev_b32 v14, 3, v0
s_nop 1
ds_write_b64 v14, v[12:13] offset:0
v_lshlrev_b32 v14, 3, v9
s_waitcnt lgkmcnt(0)
s_barrier
ds_read_b64 v[88:89], v14 offset:0
ds_read_b64 v[90:91], v14 offset:128
ds_read_b64 v[92:93], v14 offset:256
ds_read_b64 v[94:95], v14 offset:384
ds_read_b64 v[96:97], v14 offset:512
ds_read_b64 v[98:99], v14 offset:640
ds_read_b64 v[100:101], v14 offset:768
ds_read_b64 v[102:103], v14 offset:896
ds_read_b64 v[104:105], v14 offset:1024
ds_read_b64 v[106:107], v14 offset:1152
ds_read_b64 v[108:109], v14 offset:1280
ds_read_b64 v[110:111], v14 offset:1408
ds_read_b64 v[112:113], v14 offset:1536
ds_read_b64 v[114:115], v14 offset:1664
s_waitcnt lgkmcnt(8)
ds_read_b64 v[116:117], v14 offset:1792
ds_read_b64 v[118:119], v14 offset:1920
s_waitcnt lgkmcnt(0)
v_add_f32 v88, v88, v104
v_add_f32 v89, v89, v105
v_add_f32 v90, v90, v106
v_add_f32 v91, v91, v107
v_add_f32 v92, v92, v108
v_add_f32 v93, v93, v109
v_add_f32 v94, v94, v110
v_add_f32 v95, v95, v111
v_add_f32 v96, v96, v112
v_add_f32 v97, v97, v113
v_add_f32 v98, v98, v114
v_add_f32 v99, v99, v115
v_add_f32 v100, v100, v116
v_add_f32 v101, v101, v117
v_add_f32 v102, v102, v118
v_add_f32 v103, v103, v119
v_add_f32 v88, v88, v96
v_add_f32 v89, v89, v97
v_add_f32 v90, v90, v98
v_add_f32 v91, v91, v99
v_add_f32 v92, v92, v100
v_add_f32 v93, v93, v101
v_add_f32 v94, v94, v102
v_add_f32 v95, v95, v103
v_add_f32 v88, v88, v92
v_add_f32 v89, v89, v93
v_add_f32 v90, v90, v94
v_add_f32 v91, v91, v95
v_add_f32 v88, v88, v90
v_add_f32 v89, v89, v91
s_mov_b32 s57, 0x3ae38e39
v_mul_f32 v12, s57, v88
v_mul_f32 v13, s57, v89
v_fma_f32 v13, -v12, v12, v13
v_max_f32 v13, 0, v13
v_add_f32 v13, 0x3727c5ac, v13
v_rsq_f32 v13, v13
s_nop 0
v_mul_f32 v12, v12, v13
v_lshlrev_b32 v40, 16, v16
v_and_b32 v41, 0xffff0000, v16
v_fma_f32 v40, v40, v13, -v12
v_fma_f32 v41, v41, v13, -v12
v_lshlrev_b32 v42, 16, v17
v_and_b32 v43, 0xffff0000, v17
v_fma_f32 v42, v42, v13, -v12
v_fma_f32 v43, v43, v13, -v12
v_lshlrev_b32 v44, 16, v18
v_and_b32 v45, 0xffff0000, v18
v_fma_f32 v44, v44, v13, -v12
v_fma_f32 v45, v45, v13, -v12
v_lshlrev_b32 v46, 16, v19
v_and_b32 v47, 0xffff0000, v19
v_fma_f32 v46, v46, v13, -v12
v_fma_f32 v47, v47, v13, -v12
v_lshlrev_b32 v48, 16, v20
v_and_b32 v49, 0xffff0000, v20
v_fma_f32 v48, v48, v13, -v12
v_fma_f32 v49, v49, v13, -v12
v_lshlrev_b32 v50, 16, v21
v_and_b32 v51, 0xffff0000, v21
v_fma_f32 v50, v50, v13, -v12
v_fma_f32 v51, v51, v13, -v12
v_lshlrev_b32 v52, 16, v22
v_and_b32 v53, 0xffff0000, v22
v_fma_f32 v52, v52, v13, -v12
v_fma_f32 v53, v53, v13, -v12
v_lshlrev_b32 v54, 16, v23
v_and_b32 v55, 0xffff0000, v23
v_fma_f32 v54, v54, v13, -v12
v_fma_f32 v55, v55, v13, -v12
v_lshlrev_b32 v56, 16, v24
v_and_b32 v57, 0xffff0000, v24
v_fma_f32 v56, v56, v13, -v12
v_fma_f32 v57, v57, v13, -v12
v_lshlrev_b32 v58, 16, v25
v_and_b32 v59, 0xffff0000, v25
v_fma_f32 v58, v58, v13, -v12
v_fma_f32 v59, v59, v13, -v12
v_lshlrev_b32 v60, 16, v26
v_and_b32 v61, 0xffff0000, v26
v_fma_f32 v60, v60, v13, -v12
v_fma_f32 v61, v61, v13, -v12
v_lshlrev_b32 v62, 16, v27
v_and_b32 v63, 0xffff0000, v27
v_fma_f32 v62, v62, v13, -v12
v_fma_f32 v63, v63, v13, -v12
v_lshlrev_b32 v64, 16, v28
v_and_b32 v65, 0xffff0000, v28
v_fma_f32 v64, v64, v13, -v12
v_fma_f32 v65, v65, v13, -v12
v_lshlrev_b32 v66, 16, v29
v_and_b32 v67, 0xffff0000, v29
v_fma_f32 v66, v66, v13, -v12
v_fma_f32 v67, v67, v13, -v12
v_lshlrev_b32 v68, 16, v30
v_and_b32 v69, 0xffff0000, v30
v_fma_f32 v68, v68, v13, -v12
v_fma_f32 v69, v69, v13, -v12
v_lshlrev_b32 v70, 16, v31
v_and_b32 v71, 0xffff0000, v31
v_fma_f32 v70, v70, v13, -v12
v_fma_f32 v71, v71, v13, -v12
v_lshlrev_b32 v72, 16, v32
v_and_b32 v73, 0xffff0000, v32
v_fma_f32 v72, v72, v13, -v12
v_fma_f32 v73, v73, v13, -v12
v_lshlrev_b32 v74, 16, v33
v_and_b32 v75, 0xffff0000, v33
v_fma_f32 v74, v74, v13, -v12
v_fma_f32 v75, v75, v13, -v12
v_lshlrev_b32 v76, 16, v34
v_and_b32 v77, 0xffff0000, v34
v_fma_f32 v76, v76, v13, -v12
v_fma_f32 v77, v77, v13, -v12
v_lshlrev_b32 v78, 16, v35
v_and_b32 v79, 0xffff0000, v35
v_fma_f32 v78, v78, v13, -v12
v_fma_f32 v79, v79, v13, -v12
s_cmp_lg_u32 s3, 0
s_cbranch_scc1 L_prep_lnw
s_mov_b32 s58, 0x40000
v_mov_b32 v14, 0
L_prep_poll:
global_load_dword v15, v14, s[68:69] offset:128 sc1
s_sub_u32 s58, s58, 1
s_cmp_eq_u32 s58, 0
s_cbranch_scc1 L_prep_lnw
s_waitcnt vmcnt(0)
v_readfirstlane_b32 s59, v15
s_cmp_eq_u32 s59, 0
s_cbranch_scc1 L_prep_poll
L_prep_lnw:
s_waitcnt vmcnt(0)
s_barrier
v_lshlrev_b32 v14, 4, v0
v_cmp_gt_u32 vcc, 32, v0
s_mov_b32 s58, 10518528
buffer_load_dwordx4 v[88:91], v14, s[28:31], s58 offen sc1
s_mov_b32 s58, 10523136
buffer_load_dwordx4 v[92:95], v14, s[28:31], s58 offen sc1
s_mov_b32 s58, 10527744
buffer_load_dwordx4 v[96:99], v14, s[28:31], s58 offen sc1
s_and_saveexec_b64 s[54:55], vcc
s_mov_b32 s58, 10522624
buffer_load_dwordx4 v[100:103], v14, s[28:31], s58 offen sc1
s_mov_b32 s58, 10527232
buffer_load_dwordx4 v[104:107], v14, s[28:31], s58 offen sc1
s_mov_b32 s58, 10531840
buffer_load_dwordx4 v[108:111], v14, s[28:31], s58 offen sc1
s_mov_b64 exec, s[54:55]
s_waitcnt vmcnt(0)
v_add_f32 v88, v88, v92
v_add_f32 v88, v88, v96
v_add_f32 v89, v89, v93
v_add_f32 v89, v89, v97
v_add_f32 v90, v90, v94
v_add_f32 v90, v90, v98
v_add_f32 v91, v91, v95
v_add_f32 v91, v91, v99
v_add_f32 v100, v100, v104
v_add_f32 v100, v100, v108
v_add_f32 v101, v101, v105
v_add_f32 v101, v101, v109
v_add_f32 v102, v102, v106
v_add_f32 v102, v102, v110
v_add_f32 v103, v103, v107
v_add_f32 v103, v103, v111
ds_write_b128 v14, v[88:91] offset:4096
s_and_saveexec_b64 s[54:55], vcc
ds_write_b128 v14, v[100:103] offset:8192
s_mov_b64 exec, s[54:55]
v_lshlrev_b32 v14, 5, v11
s_lshl_b32 s58, s3, 7
v_add_u32 v14, s58, v14
s_waitcnt lgkmcnt(0)
s_barrier
ds_read_b128 v[88:91], v14 offset:4096
ds_read_b128 v[92:95], v14 offset:4112
ds_read_b128 v[96:99], v14 offset:6400
ds_read_b128 v[100:103], v14 offset:6416
ds_read_b128 v[104:107], v14 offset:4608
ds_read_b128 v[108:111], v14 offset:4624
ds_read_b128 v[112:115], v14 offset:6912
ds_read_b128 v[116:119], v14 offset:6928
ds_read_b128 v[120:123], v14 offset:5120
ds_read_b128 v[124:127], v14 offset:5136
ds_read_b128 v[128:131], v14 offset:7424
ds_read_b128 v[132:135], v14 offset:7440
s_waitcnt lgkmcnt(4)
ds_read_b128 v[136:139], v14 offset:5632
ds_read_b128 v[140:143], v14 offset:5648
ds_read_b128 v[144:147], v14 offset:7936
ds_read_b128 v[148:151], v14 offset:7952
s_waitcnt lgkmcnt(0)
s_cmp_ge_u32 s3, 2
s_cbranch_scc1 L_prep_ln5
ds_read_b128 v[152:155], v14 offset:6144
ds_read_b128 v[156:159], v14 offset:6160
ds_read_b128 v[160:163], v14 offset:8448
ds_read_b128 v[164:167], v14 offset:8464
L_prep_ln5:
s_mul_i32 s60, s32, 18432
s_lshl_b32 s61, s3, 10
s_add_u32 s60, s60, s61
s_add_u32 s60, s60, 5242880
v_lshlrev_b32 v12, 4, v2
s_waitcnt lgkmcnt(0)
v_fma_f32 v40, v40, v96, v88
v_fma_f32 v41, v41, v97, v89
v_fma_f32 v42, v42, v98, v90
v_fma_f32 v43, v43, v99, v91
v_fma_f32 v44, v44, v100, v92
v_fma_f32 v45, v45, v101, v93
v_fma_f32 v46, v46, v102, v94
v_fma_f32 v47, v47, v103, v95
v_cvt_pk_bf16_f32 v16, v40, v41
v_cvt_pk_bf16_f32 v17, v42, v43
v_cvt_pk_bf16_f32 v18, v44, v45
v_cvt_pk_bf16_f32 v19, v46, v47
buffer_store_dwordx4 v[16:19], v12, s[28:31], s60 offen
s_add_u32 s60, s60, 4096
v_fma_f32 v48, v48, v112, v104
v_fma_f32 v49, v49, v113, v105
v_fma_f32 v50, v50, v114, v106
v_fma_f32 v51, v51, v115, v107
v_fma_f32 v52, v52, v116, v108
v_fma_f32 v53, v53, v117, v109
v_fma_f32 v54, v54, v118, v110
v_fma_f32 v55, v55, v119, v111
v_cvt_pk_bf16_f32 v20, v48, v49
v_cvt_pk_bf16_f32 v21, v50, v51
v_cvt_pk_bf16_f32 v22, v52, v53
v_cvt_pk_bf16_f32 v23, v54, v55
buffer_store_dwordx4 v[20:23], v12, s[28:31], s60 offen
s_add_u32 s60, s60, 4096
v_fma_f32 v56, v56, v128, v120
v_fma_f32 v57, v57, v129, v121
v_fma_f32 v58, v58, v130, v122
v_fma_f32 v59, v59, v131, v123
v_fma_f32 v60, v60, v132, v124
v_fma_f32 v61, v61, v133, v125
v_fma_f32 v62, v62, v134, v126
v_fma_f32 v63, v63, v135, v127
v_cvt_pk_bf16_f32 v24, v56, v57
v_cvt_pk_bf16_f32 v25, v58, v59
v_cvt_pk_bf16_f32 v26, v60, v61
v_cvt_pk_bf16_f32 v27, v62, v63
buffer_store_dwordx4 v[24:27], v12, s[28:31], s60 offen
s_add_u32 s60, s60, 4096
v_fma_f32 v64, v64, v144, v136
v_fma_f32 v65, v65, v145, v137
v_fma_f32 v66, v66, v146, v138
v_fma_f32 v67, v67, v147, v139
v_fma_f32 v68, v68, v148, v140
v_fma_f32 v69, v69, v149, v141
v_fma_f32 v70, v70, v150, v142
v_fma_f32 v71, v71, v151, v143
v_cvt_pk_bf16_f32 v28, v64, v65
v_cvt_pk_bf16_f32 v29, v66, v67
v_cvt_pk_bf16_f32 v30, v68, v69
v_cvt_pk_bf16_f32 v31, v70, v71
buffer_store_dwordx4 v[28:31], v12, s[28:31], s60 offen
s_add_u32 s60, s60, 4096
s_cmp_ge_u32 s3, 2
s_cbranch_scc1 L_prep_done
v_fma_f32 v72, v72, v160, v152
v_fma_f32 v73, v73, v161, v153
v_fma_f32 v74, v74, v162, v154
v_fma_f32 v75, v75, v163, v155
v_fma_f32 v76, v76, v164, v156
v_fma_f32 v77, v77, v165, v157
v_fma_f32 v78, v78, v166, v158
v_fma_f32 v79, v79, v167, v159
v_cvt_pk_bf16_f32 v32, v72, v73
v_cvt_pk_bf16_f32 v33, v74, v75
v_cvt_pk_bf16_f32 v34, v76, v77
v_cvt_pk_bf16_f32 v35, v78, v79
buffer_store_dwordx4 v[32:35], v12, s[28:31], s60 offen
s_branch L_prep_done
L_prep_pack:
s_sub_u32 s32, s2, 218
s_lshl_b32 s32, s32, 2
s_add_u32 s32, s32, s3
v_and_b32 v3, 15, v2
v_lshrrev_b32 v4, 4, v2
s_cmp_ge_u32 s2, 317
s_cbranch_scc1 L_prep_pf
s_cmp_ge_u32 s2, 290
s_cbranch_scc1 L_prep_packo
s_mul_hi_u32 s33, s32, 238609295
s_mul_i32 s34, s33, 18
s_sub_u32 s34, s32, s34
s_mul_i32 s35, s33, 72
s_mul_i32 s36, s34, 110592
s_add_u32 s35, s35, s36
v_mul_u32_u24 v5, 27648, v4
v_lshl_add_u32 v6, v3, 1, v5
v_lshrrev_b32 v7, 2, v3
v_mul_u32_u24 v7, 1152, v7
v_bfe_u32 v8, v3, 1, 1
v_mul_u32_u24 v8, 36, v8
v_and_b32 v9, 1, v3
v_lshlrev_b32 v9, 1, v9
v_add3_u32 v7, v7, v8, v9
v_add3_u32 v7, v7, v5, 32
v_mov_b32 v8, 0x40000000
v_cmp_gt_u32 vcc, 12, v3
s_nop 1
v_cndmask_b32 v7, v8, v7, vcc
s_add_u32 s37, s35, 0
buffer_load_ushort v16, v6, s[12:15], s37 offen
s_add_u32 s37, s35, 3456
buffer_load_ushort v17, v6, s[12:15], s37 offen
s_add_u32 s37, s35, 6912
buffer_load_ushort v18, v6, s[12:15], s37 offen
s_add_u32 s37, s35, 10368
buffer_load_ushort v19, v6, s[12:15], s37 offen
s_add_u32 s37, s35, 13824
buffer_load_ushort v20, v6, s[12:15], s37 offen
s_add_u32 s37, s35, 17280
buffer_load_ushort v21, v6, s[12:15], s37 offen
s_add_u32 s37, s35, 20736
buffer_load_ushort v22, v6, s[12:15], s37 offen
s_add_u32 s37, s35, 24192
buffer_load_ushort v23, v6, s[12:15], s37 offen
s_add_u32 s37, s35, 36
buffer_load_ushort v24, v6, s[12:15], s37 offen
s_add_u32 s37, s35, 3492
buffer_load_ushort v25, v6, s[12:15], s37 offen
s_add_u32 s37, s35, 6948
buffer_load_ushort v26, v6, s[12:15], s37 offen
s_add_u32 s37, s35, 10404
buffer_load_ushort v27, v6, s[12:15], s37 offen
s_add_u32 s37, s35, 13860
buffer_load_ushort v28, v6, s[12:15], s37 offen
s_add_u32 s37, s35, 17316
buffer_load_ushort v29, v6, s[12:15], s37 offen
s_add_u32 s37, s35, 20772
buffer_load_ushort v30, v6, s[12:15], s37 offen
s_add_u32 s37, s35, 24228
buffer_load_ushort v31, v6, s[12:15], s37 offen
s_add_u32 s37, s35, 1152
buffer_load_ushort v32, v6, s[12:15], s37 offen
s_add_u32 s37, s35, 4608
buffer_load_ushort v33, v6, s[12:15], s37 offen
s_add_u32 s37, s35, 8064
buffer_load_ushort v34, v6, s[12:15], s37 offen
s_add_u32 s37, s35, 11520
buffer_load_ushort v35, v6, s[12:15], s37 offen
s_add_u32 s37, s35, 14976
buffer_load_ushort v36, v6, s[12:15], s37 offen
s_add_u32 s37, s35, 18432
buffer_load_ushort v37, v6, s[12:15], s37 offen
s_add_u32 s37, s35, 21888
buffer_load_ushort v38, v6, s[12:15], s37 offen
s_add_u32 s37, s35, 25344
buffer_load_ushort v39, v6, s[12:15], s37 offen
s_add_u32 s37, s35, 1188
buffer_load_ushort v40, v6, s[12:15], s37 offen
s_add_u32 s37, s35, 4644
buffer_load_ushort v41, v6, s[12:15], s37 offen
s_add_u32 s37, s35, 8100
buffer_load_ushort v42, v6, s[12:15], s37 offen
s_add_u32 s37, s35, 11556
buffer_load_ushort v43, v6, s[12:15], s37 offen
s_add_u32 s37, s35, 15012
buffer_load_ushort v44, v6, s[12:15], s37 offen
s_add_u32 s37, s35, 18468
buffer_load_ushort v45, v6, s[12:15], s37 offen
s_add_u32 s37, s35, 21924
buffer_load_ushort v46, v6, s[12:15], s37 offen
s_add_u32 s37, s35, 25380
buffer_load_ushort v47, v6, s[12:15], s37 offen
s_add_u32 s37, s35, 2304
buffer_load_ushort v48, v6, s[12:15], s37 offen
s_add_u32 s37, s35, 5760
buffer_load_ushort v49, v6, s[12:15], s37 offen
s_add_u32 s37, s35, 9216
buffer_load_ushort v50, v6, s[12:15], s37 offen
s_add_u32 s37, s35, 12672
buffer_load_ushort v51, v6, s[12:15], s37 offen
s_add_u32 s37, s35, 16128
buffer_load_ushort v52, v6, s[12:15], s37 offen
s_add_u32 s37, s35, 19584
buffer_load_ushort v53, v6, s[12:15], s37 offen
s_add_u32 s37, s35, 23040
buffer_load_ushort v54, v6, s[12:15], s37 offen
s_add_u32 s37, s35, 26496
buffer_load_ushort v55, v6, s[12:15], s37 offen
s_add_u32 s37, s35, 2340
buffer_load_ushort v56, v6, s[12:15], s37 offen
s_add_u32 s37, s35, 5796
buffer_load_ushort v57, v6, s[12:15], s37 offen
s_add_u32 s37, s35, 9252
buffer_load_ushort v58, v6, s[12:15], s37 offen
s_add_u32 s37, s35, 12708
buffer_load_ushort v59, v6, s[12:15], s37 offen
s_add_u32 s37, s35, 16164
buffer_load_ushort v60, v6, s[12:15], s37 offen
s_add_u32 s37, s35, 19620
buffer_load_ushort v61, v6, s[12:15], s37 offen
s_add_u32 s37, s35, 23076
buffer_load_ushort v62, v6, s[12:15], s37 offen
s_add_u32 s37, s35, 26532
buffer_load_ushort v63, v6, s[12:15], s37 offen
s_add_u32 s37, s35, 0
buffer_load_ushort v64, v7, s[12:15], s37 offen
s_add_u32 s37, s35, 3456
buffer_load_ushort v65, v7, s[12:15], s37 offen
s_add_u32 s37, s35, 6912
buffer_load_ushort v66, v7, s[12:15], s37 offen
s_add_u32 s37, s35, 10368
buffer_load_ushort v67, v7, s[12:15], s37 offen
s_add_u32 s37, s35, 13824
buffer_load_ushort v68, v7, s[12:15], s37 offen
s_add_u32 s37, s35, 17280
buffer_load_ushort v69, v7, s[12:15], s37 offen
s_add_u32 s37, s35, 20736
buffer_load_ushort v70, v7, s[12:15], s37 offen
s_add_u32 s37, s35, 24192
buffer_load_ushort v71, v7, s[12:15], s37 offen
s_mul_i32 s38, s33, 129024
s_mul_i32 s39, s34, 7168
s_add_u32 s38, s38, s39
s_add_u32 s38, s38, 11534336
v_lshlrev_b32 v12, 4, v2
s_waitcnt vmcnt(48)
v_lshl_or_b32 v80, v17, 16, v16
v_lshl_or_b32 v81, v19, 16, v18
v_lshl_or_b32 v82, v21, 16, v20
v_lshl_or_b32 v83, v23, 16, v22
buffer_store_dwordx4 v[80:83], v12, s[28:31], s38 offen
s_add_u32 s38, s38, 1024
s_waitcnt vmcnt(41)
v_lshl_or_b32 v84, v25, 16, v24
v_lshl_or_b32 v85, v27, 16, v26
v_lshl_or_b32 v86, v29, 16, v28
v_lshl_or_b32 v87, v31, 16, v30
buffer_store_dwordx4 v[84:87], v12, s[28:31], s38 offen
s_add_u32 s38, s38, 1024
s_waitcnt vmcnt(34)
v_lshl_or_b32 v88, v33, 16, v32
v_lshl_or_b32 v89, v35, 16, v34
v_lshl_or_b32 v90, v37, 16, v36
v_lshl_or_b32 v91, v39, 16, v38
buffer_store_dwordx4 v[88:91], v12, s[28:31], s38 offen
s_add_u32 s38, s38, 1024
s_waitcnt vmcnt(27)
v_lshl_or_b32 v92, v41, 16, v40
v_lshl_or_b32 v93, v43, 16, v42
v_lshl_or_b32 v94, v45, 16, v44
v_lshl_or_b32 v95, v47, 16, v46
buffer_store_dwordx4 v[92:95], v12, s[28:31], s38 offen
s_add_u32 s38, s38, 1024
s_waitcnt vmcnt(20)
v_lshl_or_b32 v96, v49, 16, v48
v_lshl_or_b32 v97, v51, 16, v50
v_lshl_or_b32 v98, v53, 16, v52
v_lshl_or_b32 v99, v55, 16, v54
buffer_store_dwordx4 v[96:99], v12, s[28:31], s38 offen
s_add_u32 s38, s38, 1024
s_waitcnt vmcnt(13)
v_lshl_or_b32 v100, v57, 16, v56
v_lshl_or_b32 v101, v59, 16, v58
v_lshl_or_b32 v102, v61, 16, v60
v_lshl_or_b32 v103, v63, 16, v62
buffer_store_dwordx4 v[100:103], v12, s[28:31], s38 offen
s_add_u32 s38, s38, 1024
s_waitcnt vmcnt(6)
v_lshl_or_b32 v104, v65, 16, v64
v_lshl_or_b32 v105, v67, 16, v66
v_lshl_or_b32 v106, v69, 16, v68
v_lshl_or_b32 v107, v71, 16, v70
buffer_store_dwordx4 v[104:107], v12, s[28:31], s38 offen
s_branch L_prep_tail
L_prep_packo:
s_sub_u32 s32, s32, 288
s_mul_hi_u32 s33, s32, 238609295
s_mul_i32 s34, s33, 18
s_sub_u32 s34, s32, s34
v_lshlrev_b32 v6, 1, v3
s_cmp_ge_u32 s34, 16
s_cbranch_scc1 L_prep_otail
s_mul_i32 s35, s34, 41472
v_mul_u32_u24 v5, 4608, v4
v_add_u32 v6, v6, v5
s_mov_b32 s60, 0
s_mov_b32 s61, 1152
s_mov_b32 s62, 2304
s_mov_b32 s63, 3456
s_mov_b32 s64, 20736
s_mov_b32 s65, 21888
s_mov_b32 s66, 23040
s_mov_b32 s67, 24192
s_branch L_prep_oload
L_prep_otail:
s_sub_u32 s35, s34, 16
s_mul_i32 s35, s35, 331776
v_mul_u32_u24 v5, 41472, v4
v_add_u32 v6, v6, v5
s_mov_b32 s60, 18432
s_mov_b32 s61, 19584
s_mov_b32 s62, 39168
s_mov_b32 s63, 40320
s_mov_b32 s64, 184320
s_mov_b32 s65, 185472
s_mov_b32 s66, 205056
s_mov_b32 s67, 206208
L_prep_oload:
s_mul_i32 s36, s33, 192
s_add_u32 s35, s35, s36
s_add_u32 s60, s60, s35
s_add_u32 s61, s61, s35
s_add_u32 s62, s62, s35
s_add_u32 s63, s63, s35
s_add_u32 s64, s64, s35
s_add_u32 s65, s65, s35
s_add_u32 s66, s66, s35
s_add_u32 s67, s67, s35
buffer_load_ushort v16, v6, s[16:19], s60 offen offset:0
buffer_load_ushort v17, v6, s[16:19], s61 offen offset:0
buffer_load_ushort v18, v6, s[16:19], s62 offen offset:0
buffer_load_ushort v19, v6, s[16:19], s63 offen offset:0
buffer_load_ushort v20, v6, s[16:19], s64 offen offset:0
buffer_load_ushort v21, v6, s[16:19], s65 offen offset:0
buffer_load_ushort v22, v6, s[16:19], s66 offen offset:0
buffer_load_ushort v23, v6, s[16:19], s67 offen offset:0
buffer_load_ushort v24, v6, s[16:19], s60 offen offset:32
buffer_load_ushort v25, v6, s[16:19], s61 offen offset:32
buffer_load_ushort v26, v6, s[16:19], s62 offen offset:32
buffer_load_ushort v27, v6, s[16:19], s63 offen offset:32
buffer_load_ushort v28, v6, s[16:19], s64 offen offset:32
buffer_load_ushort v29, v6, s[16:19], s65 offen offset:32
buffer_load_ushort v30, v6, s[16:19], s66 offen offset:32
buffer_load_ushort v31, v6, s[16:19], s67 offen offset:32
buffer_load_ushort v32, v6, s[16:19], s60 offen offset:64
buffer_load_ushort v33, v6, s[16:19], s61 offen offset:64
buffer_load_ushort v34, v6, s[16:19], s62 offen offset:64
buffer_load_ushort v35, v6, s[16:19], s63 offen offset:64
buffer_load_ushort v36, v6, s[16:19], s64 offen offset:64
buffer_load_ushort v37, v6, s[16:19], s65 offen offset:64
buffer_load_ushort v38, v6, s[16:19], s66 offen offset:64
buffer_load_ushort v39, v6, s[16:19], s67 offen offset:64
buffer_load_ushort v40, v6, s[16:19], s60 offen offset:96
buffer_load_ushort v41, v6, s[16:19], s61 offen offset:96
buffer_load_ushort v42, v6, s[16:19], s62 offen offset:96
buffer_load_ushort v43, v6, s[16:19], s63 offen offset:96
buffer_load_ushort v44, v6, s[16:19], s64 offen offset:96
buffer_load_ushort v45, v6, s[16:19], s65 offen offset:96
buffer_load_ushort v46, v6, s[16:19], s66 offen offset:96
buffer_load_ushort v47, v6, s[16:19], s67 offen offset:96
buffer_load_ushort v48, v6, s[16:19], s60 offen offset:128
buffer_load_ushort v49, v6, s[16:19], s61 offen offset:128
buffer_load_ushort v50, v6, s[16:19], s62 offen offset:128
buffer_load_ushort v51, v6, s[16:19], s63 offen offset:128
buffer_load_ushort v52, v6, s[16:19], s64 offen offset:128
buffer_load_ushort v53, v6, s[16:19], s65 offen offset:128
buffer_load_ushort v54, v6, s[16:19], s66 offen offset:128
buffer_load_ushort v55, v6, s[16:19], s67 offen offset:128
buffer_load_ushort v56, v6, s[16:19], s60 offen offset:160
buffer_load_ushort v57, v6, s[16:19], s61 offen offset:160
buffer_load_ushort v58, v6, s[16:19], s62 offen offset:160
buffer_load_ushort v59, v6, s[16:19], s63 offen offset:160
buffer_load_ushort v60, v6, s[16:19], s64 offen offset:160
buffer_load_ushort v61, v6, s[16:19], s65 offen offset:160
buffer_load_ushort v62, v6, s[16:19], s66 offen offset:160
buffer_load_ushort v63, v6, s[16:19], s67 offen offset:160
s_mul_i32 s38, s33, 110592
s_lshl_b32 s39, s34, 10
s_add_u32 s38, s38, s39
s_add_u32 s38, s38, 14680064
v_lshlrev_b32 v12, 4, v2
s_waitcnt vmcnt(40)
v_lshl_or_b32 v80, v17, 16, v16
v_lshl_or_b32 v81, v19, 16, v18
v_lshl_or_b32 v82, v21, 16, v20
v_lshl_or_b32 v83, v23, 16, v22
buffer_store_dwordx4 v[80:83], v12, s[28:31], s38 offen
s_add_u32 s38, s38, 18432
s_waitcnt vmcnt(33)
v_lshl_or_b32 v84, v25, 16, v24
v_lshl_or_b32 v85, v27, 16, v26
v_lshl_or_b32 v86, v29, 16, v28
v_lshl_or_b32 v87, v31, 16, v30
buffer_store_dwordx4 v[84:87], v12, s[28:31], s38 offen
s_add_u32 s38, s38, 18432
s_waitcnt vmcnt(26)
v_lshl_or_b32 v88, v33, 16, v32
v_lshl_or_b32 v89, v35, 16, v34
v_lshl_or_b32 v90, v37, 16, v36
v_lshl_or_b32 v91, v39, 16, v38
buffer_store_dwordx4 v[88:91], v12, s[28:31], s38 offen
s_add_u32 s38, s38, 18432
s_waitcnt vmcnt(19)
v_lshl_or_b32 v92, v41, 16, v40
v_lshl_or_b32 v93, v43, 16, v42
v_lshl_or_b32 v94, v45, 16, v44
v_lshl_or_b32 v95, v47, 16, v46
buffer_store_dwordx4 v[92:95], v12, s[28:31], s38 offen
s_add_u32 s38, s38, 18432
s_waitcnt vmcnt(12)
v_lshl_or_b32 v96, v49, 16, v48
v_lshl_or_b32 v97, v51, 16, v50
v_lshl_or_b32 v98, v53, 16, v52
v_lshl_or_b32 v99, v55, 16, v54
buffer_store_dwordx4 v[96:99], v12, s[28:31], s38 offen
s_add_u32 s38, s38, 18432
s_waitcnt vmcnt(5)
v_lshl_or_b32 v100, v57, 16, v56
v_lshl_or_b32 v101, v59, 16, v58
v_lshl_or_b32 v102, v61, 16, v60
v_lshl_or_b32 v103, v63, 16, v62
buffer_store_dwordx4 v[100:103], v12, s[28:31], s38 offen
s_and_b32 s39, s32, 31
s_sub_u32 s39, s2, 290
s_lshl_b32 s39, s39, 2
s_add_u32 s39, s39, s3
s_and_b32 s39, s39, 31
s_getpc_b64 s[60:61]
L_pc_k0:
v_lshlrev_b32 v13, 6, v2
s_lshl_b32 s39, s39, 12
v_add_u32 v13, s39, v13
v_min_u32 v13, L_text_end-L_pc_k0-4, v13
global_load_dword v14, v13, s[60:61]
s_branch L_prep_tail
L_prep_pf:
L_prep_tail:
L_prep_done:
L_prep_end:
s_endpgm
.globl qkv_kernel
.p2align 8
.type qkv_kernel,@function
qkv_kernel:
s_cmp_ge_u32 s2, 256
s_cbranch_scc1 L_qkv_end
s_load_dwordx2 s[4:5], s[0:1], 88
v_lshrrev_b32 v1, 6, v0
v_and_b32 v2, 63, v0
s_nop 0
v_readfirstlane_b32 s3, v1
s_waitcnt lgkmcnt(0)
s_mov_b32 s8, s4
s_and_b32 s9, s5, 0xffff
s_mov_b32 s10, 268435456
s_mov_b32 s11, 0x00020000
s_load_dwordx4 s[48:51], s[0:1], 32
s_load_dwordx2 s[52:53], s[0:1], 48
s_and_b32 s22, s2, 7
s_lshr_b32 s23, s2, 3
s_and_b32 s12, s22, 1
s_lshl_b32 s12, s12, 3
s_and_b32 s24, s23, 7
s_add_u32 s12, s12, s24
s_lshr_b32 s13, s22, 1
s_lshl_b32 s13, s13, 2
s_lshr_b32 s24, s23, 3
s_add_u32 s13, s13, s24
s_mul_i32 s14, s12, 129024
s_add_u32 s14, s14, 11534336
s_lshl_b32 s16, s13, 3
s_sub_u32 s17, s16, 1
s_max_i32 s17, s17, 0
s_mul_i32 s17, s17, 18432
s_add_u32 s17, s17, 5242880
s_lshl_b32 s18, s3, 1
s_add_u32 s18, s18, s16
s_mul_i32 s19, s18, 18432
s_add_u32 s19, s19, 5242880
s_add_u32 s15, s19, 18432
v_lshlrev_b32 v3, 4, v2
s_mul_i32 s26, s3, 6144
s_add_u32 s25, s14, s26
s_add_u32 s27, s25, 3072
s_add_u32 s28, s26, 3072
s_mov_b32 s29, 21504
s_cmp_eq_u32 s3, 3
s_cselect_b32 s27, s17, s27
s_cselect_b32 s28, 129024, s28
s_cselect_b32 s29, 3072, s29
s_lshl_b32 s20, s2, 8
s_add_u32 s20, s20, 10551296
v_lshlrev_b32 v4, 2, v2
v_mov_b32 v5, -1
s_cmp_lg_u32 s3, 0
s_cbranch_scc1 L_qkv_noclr
buffer_store_dword v5, v4, s[8:11], s20 offen
L_qkv_noclr:
s_bfe_u32 s44, s2, 0x10003
s_lshl_b32 s44, s44, 2
s_add_u32 s44, s44, s3
s_getpc_b64 s[46:47]
L_pc_k1:
v_lshlrev_b32 v15, 6, v2
s_lshl_b32 s44, s44, 12
v_add_u32 v15, s44, v15
v_min_u32 v15, L_qkv_end-L_pc_k1-4, v15
global_load_dword a151, v15, s[46:47]
s_mov_b32 m0, s26
s_nop 0
buffer_load_dwordx4 v3, s[8:11], s25 offen offset:0 lds
buffer_load_dwordx4 v3, s[8:11], s25 offen offset:1024 lds
buffer_load_dwordx4 v3, s[8:11], s25 offen offset:2048 lds
s_mov_b32 m0, s28
s_nop 0
buffer_load_dwordx4 v3, s[8:11], s27 offen offset:0 lds
buffer_load_dwordx4 v3, s[8:11], s27 offen offset:1024 lds
buffer_load_dwordx4 v3, s[8:11], s27 offen offset:2048 lds
buffer_load_dwordx4 a[0:3], v3, s[8:11], s19 offen offset:0
buffer_load_dwordx4 a[72:75], v3, s[8:11], s15 offen offset:0
buffer_load_dwordx4 a[4:7], v3, s[8:11], s19 offen offset:1024
buffer_load_dwordx4 a[76:79], v3, s[8:11], s15 offen offset:1024
buffer_load_dwordx4 a[8:11], v3, s[8:11], s19 offen offset:2048
buffer_load_dwordx4 a[80:83], v3, s[8:11], s15 offen offset:2048
s_add_u32 s25, s25, 21504
s_add_u32 s26, s26, 21504
s_add_u32 s27, s27, s29
s_add_u32 s28, s28, s29
s_add_u32 s19, s19, 3072
s_add_u32 s15, s15, 3072
s_barrier
s_mov_b32 m0, s26
s_nop 0
buffer_load_dwordx4 v3, s[8:11], s25 offen offset:0 lds
buffer_load_dwordx4 v3, s[8:11], s25 offen offset:1024 lds
buffer_load_dwordx4 v3, s[8:11], s25 offen offset:2048 lds
s_mov_b32 m0, s28
s_nop 0
buffer_load_dwordx4 v3, s[8:11], s27 offen offset:0 lds
buffer_load_dwordx4 v3, s[8:11], s27 offen offset:1024 lds
buffer_load_dwordx4 v3, s[8:11], s27 offen offset:2048 lds
buffer_load_dwordx4 a[12:15], v3, s[8:11], s19 offen offset:0
buffer_load_dwordx4 a[84:87], v3, s[8:11], s15 offen offset:0
buffer_load_dwordx4 a[16:19], v3, s[8:11], s19 offen offset:1024
buffer_load_dwordx4 a[88:91], v3, s[8:11], s15 offen offset:1024
buffer_load_dwordx4 a[20:23], v3, s[8:11], s19 offen offset:2048
buffer_load_dwordx4 a[92:95], v3, s[8:11], s15 offen offset:2048
s_add_u32 s25, s25, 21504
s_add_u32 s26, s26, 21504
s_add_u32 s27, s27, s29
s_add_u32 s28, s28, s29
s_add_u32 s19, s19, 3072
s_add_u32 s15, s15, 3072
s_barrier
s_mov_b32 m0, s26
s_nop 0
buffer_load_dwordx4 v3, s[8:11], s25 offen offset:0 lds
buffer_load_dwordx4 v3, s[8:11], s25 offen offset:1024 lds
buffer_load_dwordx4 v3, s[8:11], s25 offen offset:2048 lds
s_mov_b32 m0, s28
s_nop 0
buffer_load_dwordx4 v3, s[8:11], s27 offen offset:0 lds
buffer_load_dwordx4 v3, s[8:11], s27 offen offset:1024 lds
buffer_load_dwordx4 v3, s[8:11], s27 offen offset:2048 lds
buffer_load_dwordx4 a[24:27], v3, s[8:11], s19 offen offset:0
buffer_load_dwordx4 a[96:99], v3, s[8:11], s15 offen offset:0
buffer_load_dwordx4 a[28:31], v3, s[8:11], s19 offen offset:1024
buffer_load_dwordx4 a[100:103], v3, s[8:11], s15 offen offset:1024
buffer_load_dwordx4 a[32:35], v3, s[8:11], s19 offen offset:2048
buffer_load_dwordx4 a[104:107], v3, s[8:11], s15 offen offset:2048
s_add_u32 s25, s25, 21504
s_add_u32 s26, s26, 21504
s_add_u32 s27, s27, s29
s_add_u32 s28, s28, s29
s_add_u32 s19, s19, 3072
s_add_u32 s15, s15, 3072
s_waitcnt vmcnt(36)
s_mov_b64 exec, 0
s_cmp_eq_u32 s3, 0
s_cbranch_scc1 L_qkv_pad0
s_cmp_eq_u32 s3, 1
s_cbranch_scc1 L_qkv_pad1
s_cmp_eq_u32 s3, 2
s_cbranch_scc1 L_qkv_padret
s_cmp_eq_u32 s3, 3
s_cbranch_scc1 L_qkv_padret
L_qkv_padret:
s_mov_b64 exec, -1
s_waitcnt lgkmcnt(0)
s_mov_b32 s32, s52
s_and_b32 s33, s53, 0xffff
s_mov_b32 s34, 5308416
s_mov_b32 s35, 0x00020000
s_mov_b32 s36, s48
s_and_b32 s37, s49, 0xffff
s_mov_b32 s38, 5308416
s_mov_b32 s39, 0x00020000
s_mov_b32 s40, s50
s_and_b32 s41, s51, 0xffff
s_mov_b32 s42, 5308416
s_mov_b32 s43, 0x00020000
s_lshl_b32 s30, s2, 2
s_add_u32 s30, s30, s3
s_mul_i32 s30, s30, 5184
v_lshlrev_b32 v13, 6, v2
v_add_u32 v14, 4096, v13
v_min_u32 v14, 5120, v14
v_add_u32 v4, 64512, v3
s_add_u32 s22, s3, 2
s_lshl_b32 s22, s22, 10
v_add_u32 v5, s22, v3
v_add_u32 v6, 64512, v5
v_add_u32 v12, 129024, v3
s_waitcnt vmcnt(24)
s_barrier
s_branch L_qkv_al
.p2align 12
L_qkv_al:
L_qkv_pad0:
s_cbranch_execz L_qkv_padret
ds_read_b128 v[16:19], v3 offset:0
ds_read_b128 v[20:23], v3 offset:1024
ds_read_b128 v[24:27], v3 offset:2048
ds_read_b128 v[28:31], v3 offset:3072
ds_read_b128 v[32:35], v3 offset:4096
ds_read_b128 v[36:39], v3 offset:5120
ds_read_b128 v[40:43], v3 offset:6144
ds_read_b128 v[44:47], v5 offset:0
ds_read_b128 v[48:51], v12 offset:0
s_waitcnt lgkmcnt(0)
v_mfma_f32_16x16x32_bf16 v[88:91], v[16:19], a[0:3], 0
ds_read_b128 v[52:55], v3 offset:7168
v_mfma_f32_16x16x32_bf16 v[92:95], v[16:19], a[72:75], 0
ds_read_b128 v[56:59], v3 offset:8192
v_mfma_f32_16x16x32_bf16 v[96:99], v[20:23], a[0:3], 0
ds_read_b128 v[60:63], v3 offset:9216
v_mfma_f32_16x16x32_bf16 v[100:103], v[20:23], a[72:75], 0
ds_read_b128 v[64:67], v3 offset:10240
v_mfma_f32_16x16x32_bf16 v[104:107], v[24:27], a[0:3], 0
ds_read_b128 v[68:71], v3 offset:11264
v_mfma_f32_16x16x32_bf16 v[108:111], v[24:27], a[72:75], 0
ds_read_b128 v[72:75], v3 offset:12288
v_mfma_f32_16x16x32_bf16 v[112:115], v[28:31], a[0:3], 0
ds_read_b128 v[76:79], v3 offset:13312
v_mfma_f32_16x16x32_bf16 v[116:119], v[28:31], a[72:75], 0
ds_read_b128 v[80:83], v5 offset:7168
v_mfma_f32_16x16x32_bf16 v[120:123], v[32:35], a[0:3], 0
ds_read_b128 v[84:87], v12 offset:1024
v_mfma_f32_16x16x32_bf16 v[124:127], v[32:35], a[72:75], 0
s_mov_b32 m0, s26
s_nop 0
buffer_load_dwordx4 v3, s[8:11], s25 offen offset:0 lds
buffer_load_dwordx4 v3, s[8:11], s25 offen offset:1024 lds
v_mfma_f32_16x16x32_bf16 v[128:131], v[36:39], a[0:3], 0
buffer_load_dwordx4 v3, s[8:11], s25 offen offset:2048 lds
s_mov_b32 m0, s28
s_nop 0
v_mfma_f32_16x16x32_bf16 v[132:135], v[36:39], a[72:75], 0
buffer_load_dwordx4 v3, s[8:11], s27 offen offset:0 lds
v_mfma_f32_16x16x32_bf16 v[136:139], v[40:43], a[0:3], 0
buffer_load_dwordx4 v3, s[8:11], s27 offen offset:1024 lds
v_mfma_f32_16x16x32_bf16 v[140:143], v[40:43], a[72:75], 0
buffer_load_dwordx4 v3, s[8:11], s27 offen offset:2048 lds
v_mfma_f32_16x16x32_bf16 v[144:147], v[44:47], v[48:51], 0
v_mfma_f32_16x16x32_bf16 v[148:151], v[40:43], v[48:51], 0
s_waitcnt lgkmcnt(0)
v_mfma_f32_16x16x32_bf16 v[88:91], v[52:55], a[4:7], v[88:91]
ds_read_b128 v[16:19], v3 offset:14336
v_mfma_f32_16x16x32_bf16 v[92:95], v[52:55], a[76:79], v[92:95]
ds_read_b128 v[20:23], v3 offset:15360
v_mfma_f32_16x16x32_bf16 v[96:99], v[56:59], a[4:7], v[96:99]
ds_read_b128 v[24:27], v3 offset:16384
v_mfma_f32_16x16x32_bf16 v[100:103], v[56:59], a[76:79], v[100:103]
ds_read_b128 v[28:31], v3 offset:17408
v_mfma_f32_16x16x32_bf16 v[104:107], v[60:63], a[4:7], v[104:107]
ds_read_b128 v[32:35], v3 offset:18432
v_mfma_f32_16x16x32_bf16 v[108:111], v[60:63], a[76:79], v[108:111]
ds_read_b128 v[36:39], v3 offset:19456
v_mfma_f32_16x16x32_bf16 v[112:115], v[64:67], a[4:7], v[112:115]
ds_read_b128 v[40:43], v3 offset:20480
v_mfma_f32_16x16x32_bf16 v[116:119], v[64:67], a[76:79], v[116:119]
ds_read_b128 v[44:47], v5 offset:14336
v_mfma_f32_16x16x32_bf16 v[120:123], v[68:71], a[4:7], v[120:123]
ds_read_b128 v[48:51], v12 offset:2048
v_mfma_f32_16x16x32_bf16 v[124:127], v[68:71], a[76:79], v[124:127]
buffer_load_dwordx4 a[36:39], v3, s[8:11], s19 offen offset:0
buffer_load_dwordx4 a[108:111], v3, s[8:11], s15 offen offset:0
buffer_load_dwordx4 a[40:43], v3, s[8:11], s19 offen offset:1024
buffer_load_dwordx4 a[112:115], v3, s[8:11], s15 offen offset:1024
buffer_load_dwordx4 a[44:47], v3, s[8:11], s19 offen offset:2048
buffer_load_dwordx4 a[116:119], v3, s[8:11], s15 offen offset:2048
s_add_u32 s25, s25, 21504
s_add_u32 s26, s26, 21504
s_add_u32 s27, s27, s29
s_add_u32 s28, s28, s29
s_add_u32 s19, s19, 3072
s_add_u32 s15, s15, 3072
v_mfma_f32_16x16x32_bf16 v[128:131], v[72:75], a[4:7], v[128:131]
v_mfma_f32_16x16x32_bf16 v[132:135], v[72:75], a[76:79], v[132:135]
v_mfma_f32_16x16x32_bf16 v[136:139], v[76:79], a[4:7], v[136:139]
v_mfma_f32_16x16x32_bf16 v[140:143], v[76:79], a[76:79], v[140:143]
v_mfma_f32_16x16x32_bf16 v[144:147], v[80:83], v[84:87], v[144:147]
v_mfma_f32_16x16x32_bf16 v[148:151], v[76:79], v[84:87], v[148:151]
s_waitcnt lgkmcnt(0)
s_waitcnt vmcnt(24)
s_barrier
v_mfma_f32_16x16x32_bf16 v[88:91], v[16:19], a[8:11], v[88:91]
ds_read_b128 v[52:55], v3 offset:21504
v_mfma_f32_16x16x32_bf16 v[92:95], v[16:19], a[80:83], v[92:95]
ds_read_b128 v[56:59], v3 offset:22528
v_mfma_f32_16x16x32_bf16 v[96:99], v[20:23], a[8:11], v[96:99]
ds_read_b128 v[60:63], v3 offset:23552
v_mfma_f32_16x16x32_bf16 v[100:103], v[20:23], a[80:83], v[100:103]
ds_read_b128 v[64:67], v3 offset:24576
v_mfma_f32_16x16x32_bf16 v[104:107], v[24:27], a[8:11], v[104:107]
ds_read_b128 v[68:71], v3 offset:25600
v_mfma_f32_16x16x32_bf16 v[108:111], v[24:27], a[80:83], v[108:111]
ds_read_b128 v[72:75], v3 offset:26624
v_mfma_f32_16x16x32_bf16 v[112:115], v[28:31], a[8:11], v[112:115]
ds_read_b128 v[76:79], v3 offset:27648
v_mfma_f32_16x16x32_bf16 v[116:119], v[28:31], a[80:83], v[116:119]
ds_read_b128 v[80:83], v5 offset:21504
v_mfma_f32_16x16x32_bf16 v[120:123], v[32:35], a[8:11], v[120:123]
ds_read_b128 v[84:87], v12 offset:3072
v_mfma_f32_16x16x32_bf16 v[124:127], v[32:35], a[80:83], v[124:127]
v_mfma_f32_16x16x32_bf16 v[128:131], v[36:39], a[8:11], v[128:131]
v_mfma_f32_16x16x32_bf16 v[132:135], v[36:39], a[80:83], v[132:135]
v_mfma_f32_16x16x32_bf16 v[136:139], v[40:43], a[8:11], v[136:139]
v_mfma_f32_16x16x32_bf16 v[140:143], v[40:43], a[80:83], v[140:143]
v_mfma_f32_16x16x32_bf16 v[144:147], v[44:47], v[48:51], v[144:147]
v_mfma_f32_16x16x32_bf16 v[148:151], v[40:43], v[48:51], v[148:151]
s_waitcnt lgkmcnt(0)
v_mfma_f32_16x16x32_bf16 v[88:91], v[52:55], a[12:15], v[88:91]
ds_read_b128 v[16:19], v3 offset:28672
v_mfma_f32_16x16x32_bf16 v[92:95], v[52:55], a[84:87], v[92:95]
ds_read_b128 v[20:23], v3 offset:29696
v_mfma_f32_16x16x32_bf16 v[96:99], v[56:59], a[12:15], v[96:99]
ds_read_b128 v[24:27], v3 offset:30720
v_mfma_f32_16x16x32_bf16 v[100:103], v[56:59], a[84:87], v[100:103]
ds_read_b128 v[28:31], v3 offset:31744
v_mfma_f32_16x16x32_bf16 v[104:107], v[60:63], a[12:15], v[104:107]
ds_read_b128 v[32:35], v3 offset:32768
v_mfma_f32_16x16x32_bf16 v[108:111], v[60:63], a[84:87], v[108:111]
ds_read_b128 v[36:39], v3 offset:33792
v_mfma_f32_16x16x32_bf16 v[112:115], v[64:67], a[12:15], v[112:115]
ds_read_b128 v[40:43], v3 offset:34816
v_mfma_f32_16x16x32_bf16 v[116:119], v[64:67], a[84:87], v[116:119]
ds_read_b128 v[44:47], v5 offset:28672
v_mfma_f32_16x16x32_bf16 v[120:123], v[68:71], a[12:15], v[120:123]
ds_read_b128 v[48:51], v12 offset:4096
v_mfma_f32_16x16x32_bf16 v[124:127], v[68:71], a[84:87], v[124:127]
s_mov_b32 m0, s26
s_nop 0
buffer_load_dwordx4 v3, s[8:11], s25 offen offset:0 lds
buffer_load_dwordx4 v3, s[8:11], s25 offen offset:1024 lds
v_mfma_f32_16x16x32_bf16 v[128:131], v[72:75], a[12:15], v[128:131]
buffer_load_dwordx4 v3, s[8:11], s25 offen offset:2048 lds
s_mov_b32 m0, s28
s_nop 0
v_mfma_f32_16x16x32_bf16 v[132:135], v[72:75], a[84:87], v[132:135]
buffer_load_dwordx4 v3, s[8:11], s27 offen offset:0 lds
v_mfma_f32_16x16x32_bf16 v[136:139], v[76:79], a[12:15], v[136:139]
buffer_load_dwordx4 v3, s[8:11], s27 offen offset:1024 lds
v_mfma_f32_16x16x32_bf16 v[140:143], v[76:79], a[84:87], v[140:143]
buffer_load_dwordx4 v3, s[8:11], s27 offen offset:2048 lds
v_mfma_f32_16x16x32_bf16 v[144:147], v[80:83], v[84:87], v[144:147]
v_mfma_f32_16x16x32_bf16 v[148:151], v[76:79], v[84:87], v[148:151]
s_waitcnt lgkmcnt(0)
v_mfma_f32_16x16x32_bf16 v[88:91], v[16:19], a[16:19], v[88:91]
ds_read_b128 v[52:55], v3 offset:35840
v_mfma_f32_16x16x32_bf16 v[92:95], v[16:19], a[88:91], v[92:95]
ds_read_b128 v[56:59], v3 offset:36864
v_mfma_f32_16x16x32_bf16 v[96:99], v[20:23], a[16:19], v[96:99]
ds_read_b128 v[60:63], v3 offset:37888
v_mfma_f32_16x16x32_bf16 v[100:103], v[20:23], a[88:91], v[100:103]
ds_read_b128 v[64:67], v3 offset:38912
v_mfma_f32_16x16x32_bf16 v[104:107], v[24:27], a[16:19], v[104:107]
ds_read_b128 v[68:71], v3 offset:39936
v_mfma_f32_16x16x32_bf16 v[108:111], v[24:27], a[88:91], v[108:111]
ds_read_b128 v[72:75], v3 offset:40960
v_mfma_f32_16x16x32_bf16 v[112:115], v[28:31], a[16:19], v[112:115]
ds_read_b128 v[76:79], v3 offset:41984
v_mfma_f32_16x16x32_bf16 v[116:119], v[28:31], a[88:91], v[116:119]
ds_read_b128 v[80:83], v5 offset:35840
v_mfma_f32_16x16x32_bf16 v[120:123], v[32:35], a[16:19], v[120:123]
ds_read_b128 v[84:87], v12 offset:5120
v_mfma_f32_16x16x32_bf16 v[124:127], v[32:35], a[88:91], v[124:127]
buffer_load_dwordx4 a[48:51], v3, s[8:11], s19 offen offset:0
buffer_load_dwordx4 a[120:123], v3, s[8:11], s15 offen offset:0
buffer_load_dwordx4 a[52:55], v3, s[8:11], s19 offen offset:1024
buffer_load_dwordx4 a[124:127], v3, s[8:11], s15 offen offset:1024
buffer_load_dwordx4 a[56:59], v3, s[8:11], s19 offen offset:2048
buffer_load_dwordx4 a[128:131], v3, s[8:11], s15 offen offset:2048
s_add_u32 s25, s25, 21504
s_add_u32 s26, s26, 21504
s_add_u32 s27, s27, s29
s_add_u32 s28, s28, s29
s_add_u32 s19, s19, 3072
s_add_u32 s15, s15, 3072
v_mfma_f32_16x16x32_bf16 v[128:131], v[36:39], a[16:19], v[128:131]
v_mfma_f32_16x16x32_bf16 v[132:135], v[36:39], a[88:91], v[132:135]
v_mfma_f32_16x16x32_bf16 v[136:139], v[40:43], a[16:19], v[136:139]
v_mfma_f32_16x16x32_bf16 v[140:143], v[40:43], a[88:91], v[140:143]
v_mfma_f32_16x16x32_bf16 v[144:147], v[44:47], v[48:51], v[144:147]
v_mfma_f32_16x16x32_bf16 v[148:151], v[40:43], v[48:51], v[148:151]
s_waitcnt lgkmcnt(0)
s_waitcnt vmcnt(24)
s_barrier
v_mfma_f32_16x16x32_bf16 v[88:91], v[52:55], a[20:23], v[88:91]
ds_read_b128 v[16:19], v3 offset:43008
v_mfma_f32_16x16x32_bf16 v[92:95], v[52:55], a[92:95], v[92:95]
ds_read_b128 v[20:23], v3 offset:44032
v_mfma_f32_16x16x32_bf16 v[96:99], v[56:59], a[20:23], v[96:99]
ds_read_b128 v[24:27], v3 offset:45056
v_mfma_f32_16x16x32_bf16 v[100:103], v[56:59], a[92:95], v[100:103]
ds_read_b128 v[28:31], v3 offset:46080
v_mfma_f32_16x16x32_bf16 v[104:107], v[60:63], a[20:23], v[104:107]
ds_read_b128 v[32:35], v3 offset:47104
v_mfma_f32_16x16x32_bf16 v[108:111], v[60:63], a[92:95], v[108:111]
ds_read_b128 v[36:39], v3 offset:48128
v_mfma_f32_16x16x32_bf16 v[112:115], v[64:67], a[20:23], v[112:115]
ds_read_b128 v[40:43], v3 offset:49152
v_mfma_f32_16x16x32_bf16 v[116:119], v[64:67], a[92:95], v[116:119]
ds_read_b128 v[44:47], v5 offset:43008
v_mfma_f32_16x16x32_bf16 v[120:123], v[68:71], a[20:23], v[120:123]
ds_read_b128 v[48:51], v12 offset:6144
v_mfma_f32_16x16x32_bf16 v[124:127], v[68:71], a[92:95], v[124:127]
v_mfma_f32_16x16x32_bf16 v[128:131], v[72:75], a[20:23], v[128:131]
v_mfma_f32_16x16x32_bf16 v[132:135], v[72:75], a[92:95], v[132:135]
v_mfma_f32_16x16x32_bf16 v[136:139], v[76:79], a[20:23], v[136:139]
v_mfma_f32_16x16x32_bf16 v[140:143], v[76:79], a[92:95], v[140:143]
v_mfma_f32_16x16x32_bf16 v[144:147], v[80:83], v[84:87], v[144:147]
v_mfma_f32_16x16x32_bf16 v[148:151], v[76:79], v[84:87], v[148:151]
s_waitcnt lgkmcnt(0)
v_mfma_f32_16x16x32_bf16 v[88:91], v[16:19], a[24:27], v[88:91]
ds_read_b128 v[52:55], v3 offset:50176
v_mfma_f32_16x16x32_bf16 v[92:95], v[16:19], a[96:99], v[92:95]
ds_read_b128 v[56:59], v3 offset:51200
v_mfma_f32_16x16x32_bf16 v[96:99], v[20:23], a[24:27], v[96:99]
ds_read_b128 v[60:63], v3 offset:52224
v_mfma_f32_16x16x32_bf16 v[100:103], v[20:23], a[96:99], v[100:103]
ds_read_b128 v[64:67], v3 offset:53248
v_mfma_f32_16x16x32_bf16 v[104:107], v[24:27], a[24:27], v[104:107]
ds_read_b128 v[68:71], v3 offset:54272
v_mfma_f32_16x16x32_bf16 v[108:111], v[24:27], a[96:99], v[108:111]
ds_read_b128 v[72:75], v3 offset:55296
v_mfma_f32_16x16x32_bf16 v[112:115], v[28:31], a[24:27], v[112:115]
ds_read_b128 v[76:79], v3 offset:56320
v_mfma_f32_16x16x32_bf16 v[116:119], v[28:31], a[96:99], v[116:119]
ds_read_b128 v[80:83], v5 offset:50176
v_mfma_f32_16x16x32_bf16 v[120:123], v[32:35], a[24:27], v[120:123]
ds_read_b128 v[84:87], v12 offset:7168
v_mfma_f32_16x16x32_bf16 v[124:127], v[32:35], a[96:99], v[124:127]
s_mov_b32 m0, s26
s_nop 0
buffer_load_dwordx4 v3, s[8:11], s25 offen offset:0 lds
buffer_load_dwordx4 v3, s[8:11], s25 offen offset:1024 lds
v_mfma_f32_16x16x32_bf16 v[128:131], v[36:39], a[24:27], v[128:131]
buffer_load_dwordx4 v3, s[8:11], s25 offen offset:2048 lds
s_mov_b32 m0, s28
s_nop 0
v_mfma_f32_16x16x32_bf16 v[132:135], v[36:39], a[96:99], v[132:135]
buffer_load_dwordx4 v3, s[8:11], s27 offen offset:0 lds
v_mfma_f32_16x16x32_bf16 v[136:139], v[40:43], a[24:27], v[136:139]
buffer_load_dwordx4 v3, s[8:11], s27 offen offset:1024 lds
v_mfma_f32_16x16x32_bf16 v[140:143], v[40:43], a[96:99], v[140:143]
buffer_load_dwordx4 v3, s[8:11], s27 offen offset:2048 lds
v_mfma_f32_16x16x32_bf16 v[144:147], v[44:47], v[48:51], v[144:147]
v_mfma_f32_16x16x32_bf16 v[148:151], v[40:43], v[48:51], v[148:151]
s_waitcnt lgkmcnt(0)
v_mfma_f32_16x16x32_bf16 v[88:91], v[52:55], a[28:31], v[88:91]
ds_read_b128 v[16:19], v3 offset:57344
v_mfma_f32_16x16x32_bf16 v[92:95], v[52:55], a[100:103], v[92:95]
ds_read_b128 v[20:23], v3 offset:58368
v_mfma_f32_16x16x32_bf16 v[96:99], v[56:59], a[28:31], v[96:99]
ds_read_b128 v[24:27], v3 offset:59392
v_mfma_f32_16x16x32_bf16 v[100:103], v[56:59], a[100:103], v[100:103]
ds_read_b128 v[28:31], v3 offset:60416
v_mfma_f32_16x16x32_bf16 v[104:107], v[60:63], a[28:31], v[104:107]
ds_read_b128 v[32:35], v3 offset:61440
v_mfma_f32_16x16x32_bf16 v[108:111], v[60:63], a[100:103], v[108:111]
ds_read_b128 v[36:39], v3 offset:62464
v_mfma_f32_16x16x32_bf16 v[112:115], v[64:67], a[28:31], v[112:115]
ds_read_b128 v[40:43], v3 offset:63488
v_mfma_f32_16x16x32_bf16 v[116:119], v[64:67], a[100:103], v[116:119]
ds_read_b128 v[44:47], v5 offset:57344
v_mfma_f32_16x16x32_bf16 v[120:123], v[68:71], a[28:31], v[120:123]
ds_read_b128 v[48:51], v12 offset:8192
v_mfma_f32_16x16x32_bf16 v[124:127], v[68:71], a[100:103], v[124:127]
buffer_load_dwordx4 a[60:63], v3, s[8:11], s19 offen offset:0
buffer_load_dwordx4 a[132:135], v3, s[8:11], s15 offen offset:0
buffer_load_dwordx4 a[64:67], v3, s[8:11], s19 offen offset:1024
buffer_load_dwordx4 a[136:139], v3, s[8:11], s15 offen offset:1024
buffer_load_dwordx4 a[68:71], v3, s[8:11], s19 offen offset:2048
buffer_load_dwordx4 a[140:143], v3, s[8:11], s15 offen offset:2048
s_add_u32 s25, s25, 21504
s_add_u32 s26, s26, 21504
s_add_u32 s27, s27, s29
s_add_u32 s28, s28, s29
s_add_u32 s19, s19, 3072
s_add_u32 s15, s15, 3072
v_mfma_f32_16x16x32_bf16 v[128:131], v[72:75], a[28:31], v[128:131]
v_mfma_f32_16x16x32_bf16 v[132:135], v[72:75], a[100:103], v[132:135]
v_mfma_f32_16x16x32_bf16 v[136:139], v[76:79], a[28:31], v[136:139]
v_mfma_f32_16x16x32_bf16 v[140:143], v[76:79], a[100:103], v[140:143]
v_mfma_f32_16x16x32_bf16 v[144:147], v[80:83], v[84:87], v[144:147]
v_mfma_f32_16x16x32_bf16 v[148:151], v[76:79], v[84:87], v[148:151]
s_waitcnt lgkmcnt(0)
s_waitcnt vmcnt(24)
s_barrier
v_mfma_f32_16x16x32_bf16 v[88:91], v[16:19], a[32:35], v[88:91]
ds_read_b128 v[52:55], v4 offset:0
v_mfma_f32_16x16x32_bf16 v[92:95], v[16:19], a[104:107], v[92:95]
ds_read_b128 v[56:59], v4 offset:1024
v_mfma_f32_16x16x32_bf16 v[96:99], v[20:23], a[32:35], v[96:99]
ds_read_b128 v[60:63], v4 offset:2048
v_mfma_f32_16x16x32_bf16 v[100:103], v[20:23], a[104:107], v[100:103]
ds_read_b128 v[64:67], v4 offset:3072
v_mfma_f32_16x16x32_bf16 v[104:107], v[24:27], a[32:35], v[104:107]
ds_read_b128 v[68:71], v4 offset:4096
v_mfma_f32_16x16x32_bf16 v[108:111], v[24:27], a[104:107], v[108:111]
ds_read_b128 v[72:75], v4 offset:5120
v_mfma_f32_16x16x32_bf16 v[112:115], v[28:31], a[32:35], v[112:115]
ds_read_b128 v[76:79], v4 offset:6144
v_mfma_f32_16x16x32_bf16 v[116:119], v[28:31], a[104:107], v[116:119]
ds_read_b128 v[80:83], v6 offset:0
v_mfma_f32_16x16x32_bf16 v[120:123], v[32:35], a[32:35], v[120:123]
ds_read_b128 v[84:87], v12 offset:9216
v_mfma_f32_16x16x32_bf16 v[124:127], v[32:35], a[104:107], v[124:127]
v_mfma_f32_16x16x32_bf16 v[128:131], v[36:39], a[32:35], v[128:131]
v_mfma_f32_16x16x32_bf16 v[132:135], v[36:39], a[104:107], v[132:135]
v_mfma_f32_16x16x32_bf16 v[136:139], v[40:43], a[32:35], v[136:139]
v_mfma_f32_16x16x32_bf16 v[140:143], v[40:43], a[104:107], v[140:143]
v_mfma_f32_16x16x32_bf16 v[144:147], v[44:47], v[48:51], v[144:147]
v_mfma_f32_16x16x32_bf16 v[148:151], v[40:43], v[48:51], v[148:151]
s_waitcnt lgkmcnt(0)
v_mfma_f32_16x16x32_bf16 v[88:91], v[52:55], a[36:39], v[88:91]
ds_read_b128 v[16:19], v4 offset:7168
v_mfma_f32_16x16x32_bf16 v[92:95], v[52:55], a[108:111], v[92:95]
ds_read_b128 v[20:23], v4 offset:8192
v_mfma_f32_16x16x32_bf16 v[96:99], v[56:59], a[36:39], v[96:99]
ds_read_b128 v[24:27], v4 offset:9216
v_mfma_f32_16x16x32_bf16 v[100:103], v[56:59], a[108:111], v[100:103]
ds_read_b128 v[28:31], v4 offset:10240
v_mfma_f32_16x16x32_bf16 v[104:107], v[60:63], a[36:39], v[104:107]
ds_read_b128 v[32:35], v4 offset:11264
v_mfma_f32_16x16x32_bf16 v[108:111], v[60:63], a[108:111], v[108:111]
ds_read_b128 v[36:39], v4 offset:12288
v_mfma_f32_16x16x32_bf16 v[112:115], v[64:67], a[36:39], v[112:115]
ds_read_b128 v[40:43], v4 offset:13312
v_mfma_f32_16x16x32_bf16 v[116:119], v[64:67], a[108:111], v[116:119]
ds_read_b128 v[44:47], v6 offset:7168
v_mfma_f32_16x16x32_bf16 v[120:123], v[68:71], a[36:39], v[120:123]
ds_read_b128 v[48:51], v12 offset:10240
v_mfma_f32_16x16x32_bf16 v[124:127], v[68:71], a[108:111], v[124:127]
buffer_load_dword a144, v13, s[32:35], s30 offen
v_mfma_f32_16x16x32_bf16 v[128:131], v[72:75], a[36:39], v[128:131]
buffer_load_dword a146, v13, s[36:39], s30 offen
v_mfma_f32_16x16x32_bf16 v[132:135], v[72:75], a[108:111], v[132:135]
buffer_load_dword a148, v13, s[40:43], s30 offen
v_mfma_f32_16x16x32_bf16 v[136:139], v[76:79], a[36:39], v[136:139]
v_mfma_f32_16x16x32_bf16 v[140:143], v[76:79], a[108:111], v[140:143]
v_mfma_f32_16x16x32_bf16 v[144:147], v[80:83], v[84:87], v[144:147]
v_mfma_f32_16x16x32_bf16 v[148:151], v[76:79], v[84:87], v[148:151]
s_waitcnt lgkmcnt(0)
v_mfma_f32_16x16x32_bf16 v[88:91], v[16:19], a[40:43], v[88:91]
ds_read_b128 v[52:55], v4 offset:14336
v_mfma_f32_16x16x32_bf16 v[92:95], v[16:19], a[112:115], v[92:95]
ds_read_b128 v[56:59], v4 offset:15360
v_mfma_f32_16x16x32_bf16 v[96:99], v[20:23], a[40:43], v[96:99]
ds_read_b128 v[60:63], v4 offset:16384
v_mfma_f32_16x16x32_bf16 v[100:103], v[20:23], a[112:115], v[100:103]
ds_read_b128 v[64:67], v4 offset:17408
v_mfma_f32_16x16x32_bf16 v[104:107], v[24:27], a[40:43], v[104:107]
ds_read_b128 v[68:71], v4 offset:18432
v_mfma_f32_16x16x32_bf16 v[108:111], v[24:27], a[112:115], v[108:111]
ds_read_b128 v[72:75], v4 offset:19456
v_mfma_f32_16x16x32_bf16 v[112:115], v[28:31], a[40:43], v[112:115]
ds_read_b128 v[76:79], v4 offset:20480
v_mfma_f32_16x16x32_bf16 v[116:119], v[28:31], a[112:115], v[116:119]
ds_read_b128 v[80:83], v6 offset:14336
v_mfma_f32_16x16x32_bf16 v[120:123], v[32:35], a[40:43], v[120:123]
ds_read_b128 v[84:87], v12 offset:11264
v_mfma_f32_16x16x32_bf16 v[124:127], v[32:35], a[112:115], v[124:127]
v_mfma_f32_16x16x32_bf16 v[128:131], v[36:39], a[40:43], v[128:131]
v_mfma_f32_16x16x32_bf16 v[132:135], v[36:39], a[112:115], v[132:135]
v_mfma_f32_16x16x32_bf16 v[136:139], v[40:43], a[40:43], v[136:139]
v_mfma_f32_16x16x32_bf16 v[140:143], v[40:43], a[112:115], v[140:143]
v_mfma_f32_16x16x32_bf16 v[144:147], v[44:47], v[48:51], v[144:147]
v_mfma_f32_16x16x32_bf16 v[148:151], v[40:43], v[48:51], v[148:151]
s_waitcnt lgkmcnt(0)
s_waitcnt vmcnt(15)
s_barrier
v_mfma_f32_16x16x32_bf16 v[88:91], v[52:55], a[44:47], v[88:91]
ds_read_b128 v[16:19], v4 offset:21504
v_mfma_f32_16x16x32_bf16 v[92:95], v[52:55], a[116:119], v[92:95]
ds_read_b128 v[20:23], v4 offset:22528
v_mfma_f32_16x16x32_bf16 v[96:99], v[56:59], a[44:47], v[96:99]
ds_read_b128 v[24:27], v4 offset:23552
v_mfma_f32_16x16x32_bf16 v[100:103], v[56:59], a[116:119], v[100:103]
ds_read_b128 v[28:31], v4 offset:24576
v_mfma_f32_16x16x32_bf16 v[104:107], v[60:63], a[44:47], v[104:107]
ds_read_b128 v[32:35], v4 offset:25600
v_mfma_f32_16x16x32_bf16 v[108:111], v[60:63], a[116:119], v[108:111]
ds_read_b128 v[36:39], v4 offset:26624
v_mfma_f32_16x16x32_bf16 v[112:115], v[64:67], a[44:47], v[112:115]
ds_read_b128 v[40:43], v4 offset:27648
v_mfma_f32_16x16x32_bf16 v[116:119], v[64:67], a[116:119], v[116:119]
ds_read_b128 v[44:47], v6 offset:21504
v_mfma_f32_16x16x32_bf16 v[120:123], v[68:71], a[44:47], v[120:123]
ds_read_b128 v[48:51], v12 offset:12288
v_mfma_f32_16x16x32_bf16 v[124:127], v[68:71], a[116:119], v[124:127]
v_mfma_f32_16x16x32_bf16 v[128:131], v[72:75], a[44:47], v[128:131]
v_mfma_f32_16x16x32_bf16 v[132:135], v[72:75], a[116:119], v[132:135]
v_mfma_f32_16x16x32_bf16 v[136:139], v[76:79], a[44:47], v[136:139]
v_mfma_f32_16x16x32_bf16 v[140:143], v[76:79], a[116:119], v[140:143]
v_mfma_f32_16x16x32_bf16 v[144:147], v[80:83], v[84:87], v[144:147]
v_mfma_f32_16x16x32_bf16 v[148:151], v[76:79], v[84:87], v[148:151]
s_waitcnt lgkmcnt(0)
v_mfma_f32_16x16x32_bf16 v[88:91], v[16:19], a[48:51], v[88:91]
ds_read_b128 v[52:55], v4 offset:28672
v_mfma_f32_16x16x32_bf16 v[92:95], v[16:19], a[120:123], v[92:95]
ds_read_b128 v[56:59], v4 offset:29696
v_mfma_f32_16x16x32_bf16 v[96:99], v[20:23], a[48:51], v[96:99]
ds_read_b128 v[60:63], v4 offset:30720
v_mfma_f32_16x16x32_bf16 v[100:103], v[20:23], a[120:123], v[100:103]
ds_read_b128 v[64:67], v4 offset:31744
v_mfma_f32_16x16x32_bf16 v[104:107], v[24:27], a[48:51], v[104:107]
ds_read_b128 v[68:71], v4 offset:32768
v_mfma_f32_16x16x32_bf16 v[108:111], v[24:27], a[120:123], v[108:111]
ds_read_b128 v[72:75], v4 offset:33792
v_mfma_f32_16x16x32_bf16 v[112:115], v[28:31], a[48:51], v[112:115]
ds_read_b128 v[76:79], v4 offset:34816
v_mfma_f32_16x16x32_bf16 v[116:119], v[28:31], a[120:123], v[116:119]
ds_read_b128 v[80:83], v6 offset:28672
v_mfma_f32_16x16x32_bf16 v[120:123], v[32:35], a[48:51], v[120:123]
ds_read_b128 v[84:87], v12 offset:13312
v_mfma_f32_16x16x32_bf16 v[124:127], v[32:35], a[120:123], v[124:127]
buffer_load_dword a145, v14, s[32:35], s30 offen
v_mfma_f32_16x16x32_bf16 v[128:131], v[36:39], a[48:51], v[128:131]
buffer_load_dword a147, v14, s[36:39], s30 offen
v_mfma_f32_16x16x32_bf16 v[132:135], v[36:39], a[120:123], v[132:135]
buffer_load_dword a149, v14, s[40:43], s30 offen
v_mfma_f32_16x16x32_bf16 v[136:139], v[40:43], a[48:51], v[136:139]
v_mfma_f32_16x16x32_bf16 v[140:143], v[40:43], a[120:123], v[140:143]
v_mfma_f32_16x16x32_bf16 v[144:147], v[44:47], v[48:51], v[144:147]
v_mfma_f32_16x16x32_bf16 v[148:151], v[40:43], v[48:51], v[148:151]
s_waitcnt lgkmcnt(0)
v_mfma_f32_16x16x32_bf16 v[88:91], v[52:55], a[52:55], v[88:91]
ds_read_b128 v[16:19], v4 offset:35840
v_mfma_f32_16x16x32_bf16 v[92:95], v[52:55], a[124:127], v[92:95]
ds_read_b128 v[20:23], v4 offset:36864
v_mfma_f32_16x16x32_bf16 v[96:99], v[56:59], a[52:55], v[96:99]
ds_read_b128 v[24:27], v4 offset:37888
v_mfma_f32_16x16x32_bf16 v[100:103], v[56:59], a[124:127], v[100:103]
ds_read_b128 v[28:31], v4 offset:38912
v_mfma_f32_16x16x32_bf16 v[104:107], v[60:63], a[52:55], v[104:107]
ds_read_b128 v[32:35], v4 offset:39936
v_mfma_f32_16x16x32_bf16 v[108:111], v[60:63], a[124:127], v[108:111]
ds_read_b128 v[36:39], v4 offset:40960
v_mfma_f32_16x16x32_bf16 v[112:115], v[64:67], a[52:55], v[112:115]
ds_read_b128 v[40:43], v4 offset:41984
v_mfma_f32_16x16x32_bf16 v[116:119], v[64:67], a[124:127], v[116:119]
ds_read_b128 v[44:47], v6 offset:35840
v_mfma_f32_16x16x32_bf16 v[120:123], v[68:71], a[52:55], v[120:123]
ds_read_b128 v[48:51], v12 offset:14336
v_mfma_f32_16x16x32_bf16 v[124:127], v[68:71], a[124:127], v[124:127]
v_mfma_f32_16x16x32_bf16 v[128:131], v[72:75], a[52:55], v[128:131]
v_mfma_f32_16x16x32_bf16 v[132:135], v[72:75], a[124:127], v[132:135]
v_mfma_f32_16x16x32_bf16 v[136:139], v[76:79], a[52:55], v[136:139]
v_mfma_f32_16x16x32_bf16 v[140:143], v[76:79], a[124:127], v[140:143]
v_mfma_f32_16x16x32_bf16 v[144:147], v[80:83], v[84:87], v[144:147]
v_mfma_f32_16x16x32_bf16 v[148:151], v[76:79], v[84:87], v[148:151]
s_waitcnt lgkmcnt(0)
s_waitcnt vmcnt(6)
s_barrier
v_mfma_f32_16x16x32_bf16 v[88:91], v[16:19], a[56:59], v[88:91]
ds_read_b128 v[52:55], v4 offset:43008
v_mfma_f32_16x16x32_bf16 v[92:95], v[16:19], a[128:131], v[92:95]
ds_read_b128 v[56:59], v4 offset:44032
v_mfma_f32_16x16x32_bf16 v[96:99], v[20:23], a[56:59], v[96:99]
ds_read_b128 v[60:63], v4 offset:45056
v_mfma_f32_16x16x32_bf16 v[100:103], v[20:23], a[128:131], v[100:103]
ds_read_b128 v[64:67], v4 offset:46080
v_mfma_f32_16x16x32_bf16 v[104:107], v[24:27], a[56:59], v[104:107]
ds_read_b128 v[68:71], v4 offset:47104
v_mfma_f32_16x16x32_bf16 v[108:111], v[24:27], a[128:131], v[108:111]
ds_read_b128 v[72:75], v4 offset:48128
v_mfma_f32_16x16x32_bf16 v[112:115], v[28:31], a[56:59], v[112:115]
ds_read_b128 v[76:79], v4 offset:49152
v_mfma_f32_16x16x32_bf16 v[116:119], v[28:31], a[128:131], v[116:119]
ds_read_b128 v[80:83], v6 offset:43008
v_mfma_f32_16x16x32_bf16 v[120:123], v[32:35], a[56:59], v[120:123]
ds_read_b128 v[84:87], v12 offset:15360
v_mfma_f32_16x16x32_bf16 v[124:127], v[32:35], a[128:131], v[124:127]
v_mfma_f32_16x16x32_bf16 v[128:131], v[36:39], a[56:59], v[128:131]
v_mfma_f32_16x16x32_bf16 v[132:135], v[36:39], a[128:131], v[132:135]
v_mfma_f32_16x16x32_bf16 v[136:139], v[40:43], a[56:59], v[136:139]
v_mfma_f32_16x16x32_bf16 v[140:143], v[40:43], a[128:131], v[140:143]
v_mfma_f32_16x16x32_bf16 v[144:147], v[44:47], v[48:51], v[144:147]
v_mfma_f32_16x16x32_bf16 v[148:151], v[40:43], v[48:51], v[148:151]
s_waitcnt lgkmcnt(0)
v_mfma_f32_16x16x32_bf16 v[88:91], v[52:55], a[60:63], v[88:91]
ds_read_b128 v[16:19], v4 offset:50176
v_mfma_f32_16x16x32_bf16 v[92:95], v[52:55], a[132:135], v[92:95]
ds_read_b128 v[20:23], v4 offset:51200
v_mfma_f32_16x16x32_bf16 v[96:99], v[56:59], a[60:63], v[96:99]
ds_read_b128 v[24:27], v4 offset:52224
v_mfma_f32_16x16x32_bf16 v[100:103], v[56:59], a[132:135], v[100:103]
ds_read_b128 v[28:31], v4 offset:53248
v_mfma_f32_16x16x32_bf16 v[104:107], v[60:63], a[60:63], v[104:107]
ds_read_b128 v[32:35], v4 offset:54272
v_mfma_f32_16x16x32_bf16 v[108:111], v[60:63], a[132:135], v[108:111]
ds_read_b128 v[36:39], v4 offset:55296
v_mfma_f32_16x16x32_bf16 v[112:115], v[64:67], a[60:63], v[112:115]
ds_read_b128 v[40:43], v4 offset:56320
v_mfma_f32_16x16x32_bf16 v[116:119], v[64:67], a[132:135], v[116:119]
ds_read_b128 v[44:47], v6 offset:50176
v_mfma_f32_16x16x32_bf16 v[120:123], v[68:71], a[60:63], v[120:123]
ds_read_b128 v[48:51], v12 offset:16384
v_mfma_f32_16x16x32_bf16 v[124:127], v[68:71], a[132:135], v[124:127]
v_mfma_f32_16x16x32_bf16 v[128:131], v[72:75], a[60:63], v[128:131]
v_mfma_f32_16x16x32_bf16 v[132:135], v[72:75], a[132:135], v[132:135]
v_mfma_f32_16x16x32_bf16 v[136:139], v[76:79], a[60:63], v[136:139]
v_mfma_f32_16x16x32_bf16 v[140:143], v[76:79], a[132:135], v[140:143]
v_mfma_f32_16x16x32_bf16 v[144:147], v[80:83], v[84:87], v[144:147]
v_mfma_f32_16x16x32_bf16 v[148:151], v[76:79], v[84:87], v[148:151]
s_waitcnt lgkmcnt(0)
v_mfma_f32_16x16x32_bf16 v[88:91], v[16:19], a[64:67], v[88:91]
ds_read_b128 v[52:55], v4 offset:57344
v_mfma_f32_16x16x32_bf16 v[92:95], v[16:19], a[136:139], v[92:95]
ds_read_b128 v[56:59], v4 offset:58368
v_mfma_f32_16x16x32_bf16 v[96:99], v[20:23], a[64:67], v[96:99]
ds_read_b128 v[60:63], v4 offset:59392
v_mfma_f32_16x16x32_bf16 v[100:103], v[20:23], a[136:139], v[100:103]
ds_read_b128 v[64:67], v4 offset:60416
v_mfma_f32_16x16x32_bf16 v[104:107], v[24:27], a[64:67], v[104:107]
ds_read_b128 v[68:71], v4 offset:61440
v_mfma_f32_16x16x32_bf16 v[108:111], v[24:27], a[136:139], v[108:111]
ds_read_b128 v[72:75], v4 offset:62464
v_mfma_f32_16x16x32_bf16 v[112:115], v[28:31], a[64:67], v[112:115]
ds_read_b128 v[76:79], v4 offset:63488
v_mfma_f32_16x16x32_bf16 v[116:119], v[28:31], a[136:139], v[116:119]
ds_read_b128 v[80:83], v6 offset:57344
v_mfma_f32_16x16x32_bf16 v[120:123], v[32:35], a[64:67], v[120:123]
ds_read_b128 v[84:87], v12 offset:17408
v_mfma_f32_16x16x32_bf16 v[124:127], v[32:35], a[136:139], v[124:127]
v_mfma_f32_16x16x32_bf16 v[128:131], v[36:39], a[64:67], v[128:131]
v_mfma_f32_16x16x32_bf16 v[132:135], v[36:39], a[136:139], v[132:135]
v_mfma_f32_16x16x32_bf16 v[136:139], v[40:43], a[64:67], v[136:139]
v_mfma_f32_16x16x32_bf16 v[140:143], v[40:43], a[136:139], v[140:143]
v_mfma_f32_16x16x32_bf16 v[144:147], v[44:47], v[48:51], v[144:147]
v_mfma_f32_16x16x32_bf16 v[148:151], v[40:43], v[48:51], v[148:151]
s_waitcnt lgkmcnt(0)
v_mfma_f32_16x16x32_bf16 v[88:91], v[52:55], a[68:71], v[88:91]
L_qkv_pad1:
s_cbranch_execz L_qkv_padret
v_mfma_f32_16x16x32_bf16 v[92:95], v[52:55], a[140:143], v[92:95]
v_mfma_f32_16x16x32_bf16 v[96:99], v[56:59], a[68:71], v[96:99]
v_mfma_f32_16x16x32_bf16 v[100:103], v[56:59], a[140:143], v[100:103]
v_mfma_f32_16x16x32_bf16 v[104:107], v[60:63], a[68:71], v[104:107]
v_mfma_f32_16x16x32_bf16 v[108:111], v[60:63], a[140:143], v[108:111]
v_mfma_f32_16x16x32_bf16 v[112:115], v[64:67], a[68:71], v[112:115]
v_mfma_f32_16x16x32_bf16 v[116:119], v[64:67], a[140:143], v[116:119]
v_mfma_f32_16x16x32_bf16 v[120:123], v[68:71], a[68:71], v[120:123]
v_mfma_f32_16x16x32_bf16 v[124:127], v[68:71], a[140:143], v[124:127]
v_mfma_f32_16x16x32_bf16 v[128:131], v[72:75], a[68:71], v[128:131]
v_mfma_f32_16x16x32_bf16 v[132:135], v[72:75], a[140:143], v[132:135]
v_mfma_f32_16x16x32_bf16 v[136:139], v[76:79], a[68:71], v[136:139]
v_mfma_f32_16x16x32_bf16 v[140:143], v[76:79], a[140:143], v[140:143]
v_mfma_f32_16x16x32_bf16 v[144:147], v[80:83], v[84:87], v[144:147]
v_mfma_f32_16x16x32_bf16 v[148:151], v[76:79], v[84:87], v[148:151]
s_barrier
v_and_b32 v7, 15, v2
v_lshrrev_b32 v8, 4, v2
v_lshl_add_u32 v9, v1, 5, v7
v_add_u32 v9, 16, v9
v_mul_u32_u24 v9, 240, v9
v_lshl_add_u32 v9, v8, 3, v9
v_add_u32 v9, 129024, v9
v_mul_u32_u24 v10, 240, v7
v_lshl_add_u32 v10, v8, 3, v10
v_add_u32 v10, 129024, v10
s_add_u32 s22, s3, 2
s_lshl_b32 s22, s22, 5
v_add_u32 v11, s22, v10
s_nop 7
v_cvt_pk_bf16_f32 v16, v88, v89
v_cvt_pk_bf16_f32 v17, v90, v91
ds_write_b64 v9, v[16:17] offset:0
v_cvt_pk_bf16_f32 v18, v92, v93
v_cvt_pk_bf16_f32 v19, v94, v95
ds_write_b64 v9, v[18:19] offset:3840
v_cvt_pk_bf16_f32 v20, v96, v97
v_cvt_pk_bf16_f32 v21, v98, v99
ds_write_b64 v9, v[20:21] offset:32
v_cvt_pk_bf16_f32 v22, v100, v101
v_cvt_pk_bf16_f32 v23, v102, v103
ds_write_b64 v9, v[22:23] offset:3872
v_cvt_pk_bf16_f32 v24, v104, v105
v_cvt_pk_bf16_f32 v25, v106, v107
ds_write_b64 v9, v[24:25] offset:64
v_cvt_pk_bf16_f32 v26, v108, v109
v_cvt_pk_bf16_f32 v27, v110, v111
ds_write_b64 v9, v[26:27] offset:3904
v_cvt_pk_bf16_f32 v28, v112, v113
v_cvt_pk_bf16_f32 v29, v114, v115
ds_write_b64 v9, v[28:29] offset:96
v_cvt_pk_bf16_f32 v30, v116, v117
v_cvt_pk_bf16_f32 v31, v118, v119
ds_write_b64 v9, v[30:31] offset:3936
v_cvt_pk_bf16_f32 v16, v120, v121
v_cvt_pk_bf16_f32 v17, v122, v123
ds_write_b64 v9, v[16:17] offset:128
v_cvt_pk_bf16_f32 v18, v124, v125
v_cvt_pk_bf16_f32 v19, v126, v127
ds_write_b64 v9, v[18:19] offset:3968
v_cvt_pk_bf16_f32 v20, v128, v129
v_cvt_pk_bf16_f32 v21, v130, v131
ds_write_b64 v9, v[20:21] offset:160
v_cvt_pk_bf16_f32 v22, v132, v133
v_cvt_pk_bf16_f32 v23, v134, v135
ds_write_b64 v9, v[22:23] offset:4000
v_cvt_pk_bf16_f32 v24, v136, v137
v_cvt_pk_bf16_f32 v25, v138, v139
ds_write_b64 v9, v[24:25] offset:192
v_cvt_pk_bf16_f32 v26, v140, v141
v_cvt_pk_bf16_f32 v27, v142, v143
ds_write_b64 v9, v[26:27] offset:4032
v_cvt_pk_bf16_f32 v32, v144, v145
v_cvt_pk_bf16_f32 v33, v146, v147
v_cvt_pk_bf16_f32 v34, v148, v149
v_cvt_pk_bf16_f32 v35, v150, v151
ds_write_b64 v11, v[32:33]
ds_write_b64 v10, v[34:35] offset:192
s_waitcnt lgkmcnt(0)
s_barrier
v_and_b32 v7, 31, v2
v_lshrrev_b32 v8, 5, v2
v_lshl_add_u32 v9, v1, 5, v7
v_add_u32 v10, 2, v9
v_mul_u32_u24 v10, 240, v10
v_add_u32 v10, 129024, v10
v_lshl_add_u32 v11, v8, 2, v10
v_lshl_add_u32 v10, v8, 5, v10
ds_read_b128 v[16:19], v10 offset:3360
ds_read_b128 v[20:23], v10 offset:3376
ds_read_b32 v24, v11 offset:3552
ds_read_b128 v[28:31], v10 offset:3424
ds_read_b128 v[32:35], v10 offset:3440
ds_read_b32 v36, v11 offset:3560
ds_read_b128 v[38:41], v10 offset:2944
ds_read_b128 v[42:45], v10 offset:2960
ds_read_b32 v46, v11 offset:3080
ds_read_b128 v[48:51], v10 offset:2464
ds_read_b128 v[52:55], v10 offset:2480
ds_read_b32 v56, v11 offset:2600
ds_read_b128 v[58:61], v10 offset:1984
ds_read_b128 v[62:65], v10 offset:2000
ds_read_b32 v66, v11 offset:2120
s_waitcnt lgkmcnt(6)
v_mov_b32 v188, 0
v_dot2c_f32_bf16 v188, v16, v28
v_dot2c_f32_bf16 v188, v17, v29
v_dot2c_f32_bf16 v188, v18, v30
v_dot2c_f32_bf16 v188, v19, v31
v_dot2c_f32_bf16 v188, v20, v32
v_dot2c_f32_bf16 v188, v21, v33
v_dot2c_f32_bf16 v188, v22, v34
v_dot2c_f32_bf16 v188, v23, v35
v_dot2c_f32_bf16 v188, v24, v36
s_waitcnt lgkmcnt(6)
v_mov_b32 v189, 0
v_dot2c_f32_bf16 v189, v16, v38
v_dot2c_f32_bf16 v189, v17, v39
v_dot2c_f32_bf16 v189, v18, v40
v_dot2c_f32_bf16 v189, v19, v41
v_dot2c_f32_bf16 v189, v20, v42
v_dot2c_f32_bf16 v189, v21, v43
v_dot2c_f32_bf16 v189, v22, v44
v_dot2c_f32_bf16 v189, v23, v45
v_dot2c_f32_bf16 v189, v24, v46
ds_read_b128 v[68:71], v10 offset:1504
ds_read_b128 v[72:75], v10 offset:1520
ds_read_b32 v76, v11 offset:1640
s_waitcnt lgkmcnt(6)
v_mov_b32 v190, 0
v_dot2c_f32_bf16 v190, v16, v48
v_dot2c_f32_bf16 v190, v17, v49
v_dot2c_f32_bf16 v190, v18, v50
v_dot2c_f32_bf16 v190, v19, v51
v_dot2c_f32_bf16 v190, v20, v52
v_dot2c_f32_bf16 v190, v21, v53
v_dot2c_f32_bf16 v190, v22, v54
v_dot2c_f32_bf16 v190, v23, v55
v_dot2c_f32_bf16 v190, v24, v56
ds_read_b128 v[78:81], v10 offset:1024
ds_read_b128 v[82:85], v10 offset:1040
ds_read_b32 v86, v11 offset:1160
s_waitcnt lgkmcnt(6)
v_mov_b32 v191, 0
v_dot2c_f32_bf16 v191, v16, v58
v_dot2c_f32_bf16 v191, v17, v59
v_dot2c_f32_bf16 v191, v18, v60
v_dot2c_f32_bf16 v191, v19, v61
v_dot2c_f32_bf16 v191, v20, v62
v_dot2c_f32_bf16 v191, v21, v63
v_dot2c_f32_bf16 v191, v22, v64
v_dot2c_f32_bf16 v191, v23, v65
v_dot2c_f32_bf16 v191, v24, v66
ds_read_b128 v[88:91], v10 offset:544
ds_read_b128 v[92:95], v10 offset:560
ds_read_b32 v96, v11 offset:680
s_waitcnt lgkmcnt(6)
v_mov_b32 v192, 0
v_dot2c_f32_bf16 v192, v16, v68
v_dot2c_f32_bf16 v192, v17, v69
v_dot2c_f32_bf16 v192, v18, v70
v_dot2c_f32_bf16 v192, v19, v71
v_dot2c_f32_bf16 v192, v20, v72
v_dot2c_f32_bf16 v192, v21, v73
v_dot2c_f32_bf16 v192, v22, v74
v_dot2c_f32_bf16 v192, v23, v75
v_dot2c_f32_bf16 v192, v24, v76
ds_read_b128 v[98:101], v10 offset:64
ds_read_b128 v[102:105], v10 offset:80
ds_read_b32 v106, v11 offset:200
s_waitcnt lgkmcnt(6)
v_mov_b32 v193, 0
v_dot2c_f32_bf16 v193, v16, v78
v_dot2c_f32_bf16 v193, v17, v79
v_dot2c_f32_bf16 v193, v18, v80
v_dot2c_f32_bf16 v193, v19, v81
v_dot2c_f32_bf16 v193, v20, v82
v_dot2c_f32_bf16 v193, v21, v83
v_dot2c_f32_bf16 v193, v22, v84
v_dot2c_f32_bf16 v193, v23, v85
v_dot2c_f32_bf16 v193, v24, v86
s_waitcnt lgkmcnt(3)
v_mov_b32 v194, 0
v_dot2c_f32_bf16 v194, v16, v88
v_dot2c_f32_bf16 v194, v17, v89
v_dot2c_f32_bf16 v194, v18, v90
v_dot2c_f32_bf16 v194, v19, v91
v_dot2c_f32_bf16 v194, v20, v92
v_dot2c_f32_bf16 v194, v21, v93
v_dot2c_f32_bf16 v194, v22, v94
v_dot2c_f32_bf16 v194, v23, v95
v_dot2c_f32_bf16 v194, v24, v96
s_waitcnt lgkmcnt(0)
v_mov_b32 v195, 0
v_dot2c_f32_bf16 v195, v16, v98
v_dot2c_f32_bf16 v195, v17, v99
v_dot2c_f32_bf16 v195, v18, v100
v_dot2c_f32_bf16 v195, v19, v101
v_dot2c_f32_bf16 v195, v20, v102
v_dot2c_f32_bf16 v195, v21, v103
v_dot2c_f32_bf16 v195, v22, v104
v_dot2c_f32_bf16 v195, v23, v105
v_dot2c_f32_bf16 v195, v24, v106
ds_read_b128 v[108:111], v10 offset:3488
ds_read_b128 v[112:115], v10 offset:3504
ds_read_b32 v116, v11 offset:3568
ds_read_b128 v[118:121], v10 offset:3008
ds_read_b128 v[122:125], v10 offset:3024
ds_read_b32 v126, v11 offset:3088
ds_read_b128 v[128:131], v10 offset:2528
ds_read_b128 v[132:135], v10 offset:2544
ds_read_b32 v136, v11 offset:2608
ds_read_b128 v[138:141], v10 offset:2048
ds_read_b128 v[142:145], v10 offset:2064
ds_read_b32 v146, v11 offset:2128
ds_read_b128 v[148:151], v10 offset:1568
ds_read_b128 v[152:155], v10 offset:1584
ds_read_b32 v156, v11 offset:1648
s_waitcnt lgkmcnt(6)
ds_read_b128 v[158:161], v10 offset:1088
ds_read_b128 v[162:165], v10 offset:1104
ds_read_b32 v166, v11 offset:1168
ds_read_b128 v[168:171], v10 offset:608
ds_read_b128 v[172:175], v10 offset:624
ds_read_b32 v176, v11 offset:688
ds_read_b128 v[178:181], v10 offset:128
ds_read_b128 v[182:185], v10 offset:144
ds_read_b32 v186, v11 offset:208
s_lshl_b32 s22, s13, 7
v_add_u32 v12, s22, v9
v_mov_b32 v13, 0xce6e6b28
v_cmp_le_u32 vcc, 2, v12
s_nop 1
v_cndmask_b32 v189, v13, v189, vcc
v_cmp_le_u32 vcc, 4, v12
s_nop 1
v_cndmask_b32 v190, v13, v190, vcc
v_cmp_le_u32 vcc, 6, v12
s_nop 1
v_cndmask_b32 v191, v13, v191, vcc
v_cmp_le_u32 vcc, 8, v12
s_nop 1
v_cndmask_b32 v192, v13, v192, vcc
v_cmp_le_u32 vcc, 10, v12
s_nop 1
v_cndmask_b32 v193, v13, v193, vcc
v_cmp_le_u32 vcc, 12, v12
s_nop 1
v_cndmask_b32 v194, v13, v194, vcc
v_cmp_le_u32 vcc, 14, v12
s_nop 1
v_cndmask_b32 v195, v13, v195, vcc
v_max3_f32 v12, v188, v189, v190
v_max3_f32 v12, v12, v191, v192
v_max3_f32 v12, v12, v193, v194
v_max_f32 v12, v12, v195
s_mov_b32 s22, 0x3eae1a3b
v_mul_f32 v12, s22, v12
v_fma_f32 v188, v188, s22, -v12
v_fma_f32 v189, v189, s22, -v12
v_fma_f32 v190, v190, s22, -v12
v_fma_f32 v191, v191, s22, -v12
v_fma_f32 v192, v192, s22, -v12
v_fma_f32 v193, v193, s22, -v12
v_fma_f32 v194, v194, s22, -v12
v_fma_f32 v195, v195, s22, -v12
v_exp_f32 v188, v188
v_exp_f32 v189, v189
v_exp_f32 v190, v190
v_exp_f32 v191, v191
v_exp_f32 v192, v192
v_exp_f32 v193, v193
v_exp_f32 v194, v194
v_exp_f32 v195, v195
s_nop 0
v_add_f32 v12, v188, v189
v_add_f32 v13, v190, v191
v_add_f32 v14, v192, v193
v_add_f32 v15, v194, v195
v_add_f32 v12, v12, v13
v_add_f32 v14, v14, v15
v_add_f32 v12, v12, v14
v_rcp_f32 v12, v12
s_nop 0
v_mul_f32 v188, v188, v12
v_cvt_pk_bf16_f32 v188, v188, 0
v_mul_f32 v189, v189, v12
v_cvt_pk_bf16_f32 v189, v189, 0
v_mul_f32 v190, v190, v12
v_cvt_pk_bf16_f32 v190, v190, 0
v_mul_f32 v191, v191, v12
v_cvt_pk_bf16_f32 v191, v191, 0
v_mul_f32 v192, v192, v12
v_cvt_pk_bf16_f32 v192, v192, 0
v_mul_f32 v193, v193, v12
v_cvt_pk_bf16_f32 v193, v193, 0
v_mul_f32 v194, v194, v12
v_cvt_pk_bf16_f32 v194, v194, 0
v_mul_f32 v195, v195, v12
v_cvt_pk_bf16_f32 v195, v195, 0
v_mov_b32 v200, 0
v_mov_b32 v201, 0
v_mov_b32 v202, 0
v_mov_b32 v203, 0
v_mov_b32 v204, 0
v_mov_b32 v205, 0
v_mov_b32 v206, 0
v_mov_b32 v207, 0
v_mov_b32 v208, 0
v_mov_b32 v209, 0
v_mov_b32 v210, 0
v_mov_b32 v211, 0
v_mov_b32 v212, 0
v_mov_b32 v213, 0
v_mov_b32 v214, 0
v_mov_b32 v215, 0
v_mov_b32 v216, 0
v_mov_b32 v217, 0
s_waitcnt lgkmcnt(0)
v_lshlrev_b32 v12, 16, v188
v_dot2c_f32_bf16 v200, v108, v188
v_dot2c_f32_bf16 v201, v108, v12
v_dot2c_f32_bf16 v202, v109, v188
v_dot2c_f32_bf16 v203, v109, v12
v_dot2c_f32_bf16 v204, v110, v188
v_dot2c_f32_bf16 v205, v110, v12
v_dot2c_f32_bf16 v206, v111, v188
v_dot2c_f32_bf16 v207, v111, v12
v_dot2c_f32_bf16 v208, v112, v188
v_dot2c_f32_bf16 v209, v112, v12
v_dot2c_f32_bf16 v210, v113, v188
v_dot2c_f32_bf16 v211, v113, v12
v_dot2c_f32_bf16 v212, v114, v188
v_dot2c_f32_bf16 v213, v114, v12
v_dot2c_f32_bf16 v214, v115, v188
v_dot2c_f32_bf16 v215, v115, v12
v_dot2c_f32_bf16 v216, v116, v188
v_dot2c_f32_bf16 v217, v116, v12
v_lshlrev_b32 v12, 16, v189
v_dot2c_f32_bf16 v200, v118, v189
v_dot2c_f32_bf16 v201, v118, v12
v_dot2c_f32_bf16 v202, v119, v189
v_dot2c_f32_bf16 v203, v119, v12
v_dot2c_f32_bf16 v204, v120, v189
v_dot2c_f32_bf16 v205, v120, v12
v_dot2c_f32_bf16 v206, v121, v189
v_dot2c_f32_bf16 v207, v121, v12
v_dot2c_f32_bf16 v208, v122, v189
v_dot2c_f32_bf16 v209, v122, v12
v_dot2c_f32_bf16 v210, v123, v189
v_dot2c_f32_bf16 v211, v123, v12
v_dot2c_f32_bf16 v212, v124, v189
v_dot2c_f32_bf16 v213, v124, v12
v_dot2c_f32_bf16 v214, v125, v189
v_dot2c_f32_bf16 v215, v125, v12
v_dot2c_f32_bf16 v216, v126, v189
v_dot2c_f32_bf16 v217, v126, v12
v_lshlrev_b32 v12, 16, v190
v_dot2c_f32_bf16 v200, v128, v190
v_dot2c_f32_bf16 v201, v128, v12
v_dot2c_f32_bf16 v202, v129, v190
v_dot2c_f32_bf16 v203, v129, v12
v_dot2c_f32_bf16 v204, v130, v190
v_dot2c_f32_bf16 v205, v130, v12
v_dot2c_f32_bf16 v206, v131, v190
v_dot2c_f32_bf16 v207, v131, v12
v_dot2c_f32_bf16 v208, v132, v190
v_dot2c_f32_bf16 v209, v132, v12
v_dot2c_f32_bf16 v210, v133, v190
v_dot2c_f32_bf16 v211, v133, v12
v_dot2c_f32_bf16 v212, v134, v190
v_dot2c_f32_bf16 v213, v134, v12
v_dot2c_f32_bf16 v214, v135, v190
v_dot2c_f32_bf16 v215, v135, v12
v_dot2c_f32_bf16 v216, v136, v190
v_dot2c_f32_bf16 v217, v136, v12
v_lshlrev_b32 v12, 16, v191
v_dot2c_f32_bf16 v200, v138, v191
v_dot2c_f32_bf16 v201, v138, v12
v_dot2c_f32_bf16 v202, v139, v191
v_dot2c_f32_bf16 v203, v139, v12
v_dot2c_f32_bf16 v204, v140, v191
v_dot2c_f32_bf16 v205, v140, v12
v_dot2c_f32_bf16 v206, v141, v191
v_dot2c_f32_bf16 v207, v141, v12
v_dot2c_f32_bf16 v208, v142, v191
v_dot2c_f32_bf16 v209, v142, v12
v_dot2c_f32_bf16 v210, v143, v191
v_dot2c_f32_bf16 v211, v143, v12
v_dot2c_f32_bf16 v212, v144, v191
v_dot2c_f32_bf16 v213, v144, v12
v_dot2c_f32_bf16 v214, v145, v191
v_dot2c_f32_bf16 v215, v145, v12
v_dot2c_f32_bf16 v216, v146, v191
v_dot2c_f32_bf16 v217, v146, v12
v_lshlrev_b32 v12, 16, v192
v_dot2c_f32_bf16 v200, v148, v192
v_dot2c_f32_bf16 v201, v148, v12
v_dot2c_f32_bf16 v202, v149, v192
v_dot2c_f32_bf16 v203, v149, v12
v_dot2c_f32_bf16 v204, v150, v192
v_dot2c_f32_bf16 v205, v150, v12
v_dot2c_f32_bf16 v206, v151, v192
v_dot2c_f32_bf16 v207, v151, v12
v_dot2c_f32_bf16 v208, v152, v192
v_dot2c_f32_bf16 v209, v152, v12
v_dot2c_f32_bf16 v210, v153, v192
v_dot2c_f32_bf16 v211, v153, v12
v_dot2c_f32_bf16 v212, v154, v192
v_dot2c_f32_bf16 v213, v154, v12
v_dot2c_f32_bf16 v214, v155, v192
v_dot2c_f32_bf16 v215, v155, v12
v_dot2c_f32_bf16 v216, v156, v192
v_dot2c_f32_bf16 v217, v156, v12
v_lshlrev_b32 v12, 16, v193
v_dot2c_f32_bf16 v200, v158, v193
v_dot2c_f32_bf16 v201, v158, v12
v_dot2c_f32_bf16 v202, v159, v193
v_dot2c_f32_bf16 v203, v159, v12
v_dot2c_f32_bf16 v204, v160, v193
v_dot2c_f32_bf16 v205, v160, v12
v_dot2c_f32_bf16 v206, v161, v193
v_dot2c_f32_bf16 v207, v161, v12
v_dot2c_f32_bf16 v208, v162, v193
v_dot2c_f32_bf16 v209, v162, v12
v_dot2c_f32_bf16 v210, v163, v193
v_dot2c_f32_bf16 v211, v163, v12
v_dot2c_f32_bf16 v212, v164, v193
v_dot2c_f32_bf16 v213, v164, v12
v_dot2c_f32_bf16 v214, v165, v193
v_dot2c_f32_bf16 v215, v165, v12
v_dot2c_f32_bf16 v216, v166, v193
v_dot2c_f32_bf16 v217, v166, v12
v_lshlrev_b32 v12, 16, v194
v_dot2c_f32_bf16 v200, v168, v194
v_dot2c_f32_bf16 v201, v168, v12
v_dot2c_f32_bf16 v202, v169, v194
v_dot2c_f32_bf16 v203, v169, v12
v_dot2c_f32_bf16 v204, v170, v194
v_dot2c_f32_bf16 v205, v170, v12
v_dot2c_f32_bf16 v206, v171, v194
v_dot2c_f32_bf16 v207, v171, v12
v_dot2c_f32_bf16 v208, v172, v194
v_dot2c_f32_bf16 v209, v172, v12
v_dot2c_f32_bf16 v210, v173, v194
v_dot2c_f32_bf16 v211, v173, v12
v_dot2c_f32_bf16 v212, v174, v194
v_dot2c_f32_bf16 v213, v174, v12
v_dot2c_f32_bf16 v214, v175, v194
v_dot2c_f32_bf16 v215, v175, v12
v_dot2c_f32_bf16 v216, v176, v194
v_dot2c_f32_bf16 v217, v176, v12
v_lshlrev_b32 v12, 16, v195
v_dot2c_f32_bf16 v200, v178, v195
v_dot2c_f32_bf16 v201, v178, v12
v_dot2c_f32_bf16 v202, v179, v195
v_dot2c_f32_bf16 v203, v179, v12
v_dot2c_f32_bf16 v204, v180, v195
v_dot2c_f32_bf16 v205, v180, v12
v_dot2c_f32_bf16 v206, v181, v195
v_dot2c_f32_bf16 v207, v181, v12
v_dot2c_f32_bf16 v208, v182, v195
v_dot2c_f32_bf16 v209, v182, v12
v_dot2c_f32_bf16 v210, v183, v195
v_dot2c_f32_bf16 v211, v183, v12
v_dot2c_f32_bf16 v212, v184, v195
v_dot2c_f32_bf16 v213, v184, v12
v_dot2c_f32_bf16 v214, v185, v195
v_dot2c_f32_bf16 v215, v185, v12
v_dot2c_f32_bf16 v216, v186, v195
v_dot2c_f32_bf16 v217, v186, v12
v_cvt_pk_bf16_f32 v16, v200, v201
v_cvt_pk_bf16_f32 v17, v202, v203
v_cvt_pk_bf16_f32 v18, v208, v209
v_cvt_pk_bf16_f32 v19, v210, v211
v_cvt_pk_bf16_f32 v20, v204, v205
v_cvt_pk_bf16_f32 v21, v206, v207
v_cvt_pk_bf16_f32 v22, v212, v213
v_cvt_pk_bf16_f32 v23, v214, v215
v_cvt_pk_bf16_f32 v24, v216, v217
v_lshrrev_b32 v12, 4, v7
v_add_u32 v12, s18, v12
v_mul_u32_u24 v12, 18432, v12
v_and_b32 v13, 15, v2
v_lshl_add_u32 v12, v13, 4, v12
v_permlane32_swap_b32 v16, v18
v_permlane32_swap_b32 v17, v19
v_permlane32_swap_b32 v20, v22
v_permlane32_swap_b32 v21, v23
v_lshl_add_u32 v13, v8, 9, v12
s_lshl_b32 s22, s12, 10
s_add_u32 s22, s22, 7864320
buffer_store_dwordx4 v[16:19], v13, s[8:11], s22 offen
buffer_store_dwordx4 v[20:23], v13, s[8:11], s22 offen offset:256
v_lshl_add_u32 v14, v8, 2, v12
s_lshr_b32 s23, s12, 3
s_add_u32 s23, s23, 16
s_lshl_b32 s23, s23, 10
s_and_b32 s24, s12, 3
s_lshl_b32 s24, s24, 8
s_add_u32 s23, s23, s24
s_bfe_u32 s24, s12, 0x10002
s_lshl_b32 s24, s24, 3
s_add_u32 s23, s23, s24
s_add_u32 s23, s23, 7864320
buffer_store_dword v24, v14, s[8:11], s23 offen
L_qkv_alend:
L_qkv_end:
s_endpgm
.globl wo_kernel
.p2align 8
.type wo_kernel,@function
wo_kernel:
s_cmp_ge_u32 s2, 256
s_cbranch_scc1 L_wo_end
s_load_dwordx2 s[4:5], s[0:1], 88
s_load_dwordx2 s[6:7], s[0:1], 0
v_lshrrev_b32 v1, 6, v0
v_and_b32 v2, 63, v0
s_nop 0
v_readfirstlane_b32 s3, v1
s_waitcnt lgkmcnt(0)
s_mov_b32 s8, s4
s_and_b32 s9, s5, 0xffff
s_mov_b32 s10, 268435456
s_mov_b32 s11, 0x00020000
s_mov_b32 s12, s6
s_and_b32 s13, s7, 0xffff
s_mov_b32 s14, 2359296
s_mov_b32 s15, 0x00020000
s_and_b32 s16, s2, 7
s_lshl_b32 s16, s16, 3
s_lshr_b32 s17, s2, 5
s_add_u32 s16, s16, s17
s_bfe_u32 s17, s2, 0x20003
s_mul_i32 s20, s17, 9
s_and_b32 s21, s17, 1
s_add_u32 s18, s20, s21
s_lshl_b32 s22, s3, 1
s_add_u32 s18, s18, s22
s_add_u32 s19, s20, 8
s_cmp_eq_u32 s21, 1
s_cselect_b32 s19, s20, s19
v_lshlrev_b32 v3, 4, v2
s_mul_i32 s23, s16, 36864
s_mul_i32 s24, s3, 9216
s_add_u32 s23, s23, s24
s_add_u32 s23, s23, 7864320
s_mov_b32 m0, s24
s_nop 0
buffer_load_dwordx4 v3, s[8:11], s23 offen offset:0 lds
buffer_load_dwordx4 v3, s[8:11], s23 offen offset:1024 lds
buffer_load_dwordx4 v3, s[8:11], s23 offen offset:2048 lds
buffer_load_dwordx4 v3, s[8:11], s23 offen offset:3072 lds
s_add_u32 s23, s23, 4096
s_add_u32 m0, m0, 4096
s_nop 0
buffer_load_dwordx4 v3, s[8:11], s23 offen offset:0 lds
buffer_load_dwordx4 v3, s[8:11], s23 offen offset:1024 lds
buffer_load_dwordx4 v3, s[8:11], s23 offen offset:2048 lds
buffer_load_dwordx4 v3, s[8:11], s23 offen offset:3072 lds
s_add_u32 s23, s23, 4096
s_add_u32 m0, m0, 4096
s_nop 0
buffer_load_dwordx4 v3, s[8:11], s23 offen offset:0 lds
s_barrier
s_mul_i32 s25, s18, 18432
s_add_u32 s25, s25, 14680064
s_add_u32 s26, s25, 18432
s_mul_i32 s27, s19, 18432
s_add_u32 s27, s27, 14680064
v_and_b32 v4, 15, v2
v_lshrrev_b32 v5, 4, v2
v_mul_u32_u24 v6, 1152, v4
v_lshl_add_u32 v6, v5, 3, v6
v_lshlrev_b32 v7, 4, v5
s_mul_i32 s28, s16, 36864
s_cmp_eq_u32 s3, 0
s_cbranch_scc1 L_wo_three
buffer_load_dwordx4 v[16:19], v3, s[8:11], s25 offen offset:0
buffer_load_dwordx4 v[88:91], v3, s[8:11], s26 offen offset:0
buffer_load_dwordx4 v[20:23], v3, s[8:11], s25 offen offset:1024
buffer_load_dwordx4 v[92:95], v3, s[8:11], s26 offen offset:1024
buffer_load_dwordx4 v[24:27], v3, s[8:11], s25 offen offset:2048
buffer_load_dwordx4 v[96:99], v3, s[8:11], s26 offen offset:2048
buffer_load_dwordx4 v[28:31], v3, s[8:11], s25 offen offset:3072
buffer_load_dwordx4 v[100:103], v3, s[8:11], s26 offen offset:3072
s_add_u32 s25, s25, 4096
s_add_u32 s26, s26, 4096
buffer_load_dwordx4 v[32:35], v3, s[8:11], s25 offen offset:0
buffer_load_dwordx4 v[104:107], v3, s[8:11], s26 offen offset:0
buffer_load_dwordx4 v[36:39], v3, s[8:11], s25 offen offset:1024
buffer_load_dwordx4 v[108:111], v3, s[8:11], s26 offen offset:1024
buffer_load_dwordx4 v[40:43], v3, s[8:11], s25 offen offset:2048
buffer_load_dwordx4 v[112:115], v3, s[8:11], s26 offen offset:2048
buffer_load_dwordx4 v[44:47], v3, s[8:11], s25 offen offset:3072
buffer_load_dwordx4 v[116:119], v3, s[8:11], s26 offen offset:3072
s_add_u32 s25, s25, 4096
s_add_u32 s26, s26, 4096
buffer_load_dwordx4 v[48:51], v3, s[8:11], s25 offen offset:0
buffer_load_dwordx4 v[120:123], v3, s[8:11], s26 offen offset:0
buffer_load_dwordx4 v[52:55], v3, s[8:11], s25 offen offset:1024
buffer_load_dwordx4 v[124:127], v3, s[8:11], s26 offen offset:1024
buffer_load_dwordx4 v[56:59], v3, s[8:11], s25 offen offset:2048
buffer_load_dwordx4 v[128:131], v3, s[8:11], s26 offen offset:2048
buffer_load_dwordx4 v[60:63], v3, s[8:11], s25 offen offset:3072
buffer_load_dwordx4 v[132:135], v3, s[8:11], s26 offen offset:3072
s_add_u32 s25, s25, 4096
s_add_u32 s26, s26, 4096
buffer_load_dwordx4 v[64:67], v3, s[8:11], s25 offen offset:0
buffer_load_dwordx4 v[136:139], v3, s[8:11], s26 offen offset:0
buffer_load_dwordx4 v[68:71], v3, s[8:11], s25 offen offset:1024
buffer_load_dwordx4 v[140:143], v3, s[8:11], s26 offen offset:1024
buffer_load_dwordx4 v[72:75], v3, s[8:11], s25 offen offset:2048
buffer_load_dwordx4 v[144:147], v3, s[8:11], s26 offen offset:2048
buffer_load_dwordx4 v[76:79], v3, s[8:11], s25 offen offset:3072
buffer_load_dwordx4 v[148:151], v3, s[8:11], s26 offen offset:3072
s_add_u32 s25, s25, 4096
s_add_u32 s26, s26, 4096
buffer_load_dwordx4 v[80:83], v3, s[8:11], s25 offen offset:0
buffer_load_dwordx4 v[152:155], v3, s[8:11], s26 offen offset:0
buffer_load_dwordx4 v[84:87], v3, s[8:11], s25 offen offset:1024
buffer_load_dwordx4 v[156:159], v3, s[8:11], s26 offen offset:1024
s_bfe_u32 s44, s2, 0x10003
s_lshl_b32 s44, s44, 2
s_add_u32 s44, s44, s3
s_getpc_b64 s[46:47]
L_pc_k2_2:
v_lshlrev_b32 v8, 6, v2
s_lshl_b32 s44, s44, 12
v_add_u32 v8, s44, v8
v_min_u32 v8, L_wo_end-L_pc_k2_2-4, v8
global_load_dword v9, v8, s[46:47]
s_add_u32 s30, s18, 1
s_waitcnt vmcnt(37)
s_barrier
ds_read_b128 a[0:3], v3 offset:0
ds_read_b128 a[72:75], v3 offset:18432
ds_read_b128 a[4:7], v3 offset:1024
ds_read_b128 a[76:79], v3 offset:19456
ds_read_b128 a[8:11], v3 offset:2048
ds_read_b128 a[80:83], v3 offset:20480
ds_read_b128 a[12:15], v3 offset:3072
ds_read_b128 a[84:87], v3 offset:21504
ds_read_b128 a[16:19], v3 offset:4096
ds_read_b128 a[88:91], v3 offset:22528
ds_read_b128 a[20:23], v3 offset:5120
ds_read_b128 a[92:95], v3 offset:23552
ds_read_b128 a[24:27], v3 offset:6144
ds_read_b128 a[96:99], v3 offset:24576
s_waitcnt vmcnt(35) lgkmcnt(12)
v_mfma_f32_16x16x32_bf16 v[232:235], v[16:19], a[0:3], 0
ds_read_b128 a[28:31], v3 offset:7168
ds_read_b128 a[100:103], v3 offset:25600
v_mfma_f32_16x16x32_bf16 v[236:239], v[16:19], a[72:75], 0
s_lshl_b32 s31, s18, 5
s_add_u32 s31, s31, s28
v_mfma_f32_16x16x32_bf16 v[240:243], v[88:91], a[0:3], 0
s_add_u32 s32, s31, 18432
buffer_load_dwordx2 a[144:145], v6, s[12:15], s31 offen
v_mfma_f32_16x16x32_bf16 v[244:247], v[88:91], a[72:75], 0
buffer_load_dwordx2 a[146:147], v6, s[12:15], s32 offen
s_waitcnt vmcnt(35) lgkmcnt(12)
v_mfma_f32_16x16x32_bf16 v[232:235], v[20:23], a[4:7], v[232:235]
ds_read_b128 a[32:35], v3 offset:8192
ds_read_b128 a[104:107], v3 offset:26624
v_mfma_f32_16x16x32_bf16 v[236:239], v[20:23], a[76:79], v[236:239]
s_lshl_b32 s31, s18, 6
s_add_u32 s31, s31, 10485760
v_mfma_f32_16x16x32_bf16 v[240:243], v[92:95], a[4:7], v[240:243]
s_add_u32 s32, s31, 4608
buffer_load_dwordx4 a[156:159], v7, s[8:11], s31 offen
v_mfma_f32_16x16x32_bf16 v[244:247], v[92:95], a[76:79], v[244:247]
buffer_load_dwordx4 a[168:171], v7, s[8:11], s31 offen offset:2304
buffer_load_dwordx4 a[180:183], v7, s[8:11], s32 offen
s_waitcnt vmcnt(36) lgkmcnt(12)
v_mfma_f32_16x16x32_bf16 v[232:235], v[24:27], a[8:11], v[232:235]
ds_read_b128 a[36:39], v3 offset:9216
ds_read_b128 a[108:111], v3 offset:27648
v_mfma_f32_16x16x32_bf16 v[236:239], v[24:27], a[80:83], v[236:239]
s_lshl_b32 s31, s30, 5
s_add_u32 s31, s31, s28
v_mfma_f32_16x16x32_bf16 v[240:243], v[96:99], a[8:11], v[240:243]
s_add_u32 s32, s31, 18432
buffer_load_dwordx2 a[148:149], v6, s[12:15], s31 offen
v_mfma_f32_16x16x32_bf16 v[244:247], v[96:99], a[80:83], v[244:247]
buffer_load_dwordx2 a[150:151], v6, s[12:15], s32 offen
s_waitcnt vmcnt(36) lgkmcnt(12)
v_mfma_f32_16x16x32_bf16 v[232:235], v[28:31], a[12:15], v[232:235]
ds_read_b128 a[40:43], v3 offset:10240
ds_read_b128 a[112:115], v3 offset:28672
v_mfma_f32_16x16x32_bf16 v[236:239], v[28:31], a[84:87], v[236:239]
s_lshl_b32 s31, s30, 6
s_add_u32 s31, s31, 10485760
v_mfma_f32_16x16x32_bf16 v[240:243], v[100:103], a[12:15], v[240:243]
s_add_u32 s32, s31, 4608
buffer_load_dwordx4 a[160:163], v7, s[8:11], s31 offen
v_mfma_f32_16x16x32_bf16 v[244:247], v[100:103], a[84:87], v[244:247]
buffer_load_dwordx4 a[172:175], v7, s[8:11], s31 offen offset:2304
buffer_load_dwordx4 a[184:187], v7, s[8:11], s32 offen
s_waitcnt vmcnt(37) lgkmcnt(12)
v_mfma_f32_16x16x32_bf16 v[232:235], v[32:35], a[16:19], v[232:235]
ds_read_b128 a[44:47], v3 offset:11264
v_mfma_f32_16x16x32_bf16 v[236:239], v[32:35], a[88:91], v[236:239]
ds_read_b128 a[116:119], v3 offset:29696
v_mfma_f32_16x16x32_bf16 v[240:243], v[104:107], a[16:19], v[240:243]
v_mfma_f32_16x16x32_bf16 v[244:247], v[104:107], a[88:91], v[244:247]
s_waitcnt vmcnt(35) lgkmcnt(12)
v_mfma_f32_16x16x32_bf16 v[232:235], v[36:39], a[20:23], v[232:235]
ds_read_b128 a[48:51], v3 offset:12288
v_mfma_f32_16x16x32_bf16 v[236:239], v[36:39], a[92:95], v[236:239]
ds_read_b128 a[120:123], v3 offset:30720
v_mfma_f32_16x16x32_bf16 v[240:243], v[108:111], a[20:23], v[240:243]
v_mfma_f32_16x16x32_bf16 v[244:247], v[108:111], a[92:95], v[244:247]
s_waitcnt vmcnt(33) lgkmcnt(12)
v_mfma_f32_16x16x32_bf16 v[232:235], v[40:43], a[24:27], v[232:235]
ds_read_b128 a[52:55], v3 offset:13312
v_mfma_f32_16x16x32_bf16 v[236:239], v[40:43], a[96:99], v[236:239]
ds_read_b128 a[124:127], v3 offset:31744
v_mfma_f32_16x16x32_bf16 v[240:243], v[112:115], a[24:27], v[240:243]
v_mfma_f32_16x16x32_bf16 v[244:247], v[112:115], a[96:99], v[244:247]
s_waitcnt vmcnt(31) lgkmcnt(12)
v_mfma_f32_16x16x32_bf16 v[232:235], v[44:47], a[28:31], v[232:235]
ds_read_b128 a[56:59], v3 offset:14336
v_mfma_f32_16x16x32_bf16 v[236:239], v[44:47], a[100:103], v[236:239]
ds_read_b128 a[128:131], v3 offset:32768
v_mfma_f32_16x16x32_bf16 v[240:243], v[116:119], a[28:31], v[240:243]
v_mfma_f32_16x16x32_bf16 v[244:247], v[116:119], a[100:103], v[244:247]
s_waitcnt vmcnt(29) lgkmcnt(12)
v_mfma_f32_16x16x32_bf16 v[232:235], v[48:51], a[32:35], v[232:235]
ds_read_b128 a[60:63], v3 offset:15360
v_mfma_f32_16x16x32_bf16 v[236:239], v[48:51], a[104:107], v[236:239]
ds_read_b128 a[132:135], v3 offset:33792
v_mfma_f32_16x16x32_bf16 v[240:243], v[120:123], a[32:35], v[240:243]
v_mfma_f32_16x16x32_bf16 v[244:247], v[120:123], a[104:107], v[244:247]
s_waitcnt vmcnt(27) lgkmcnt(12)
v_mfma_f32_16x16x32_bf16 v[232:235], v[52:55], a[36:39], v[232:235]
ds_read_b128 a[64:67], v3 offset:16384
v_mfma_f32_16x16x32_bf16 v[236:239], v[52:55], a[108:111], v[236:239]
ds_read_b128 a[136:139], v3 offset:34816
v_mfma_f32_16x16x32_bf16 v[240:243], v[124:127], a[36:39], v[240:243]
v_mfma_f32_16x16x32_bf16 v[244:247], v[124:127], a[108:111], v[244:247]
s_waitcnt vmcnt(25) lgkmcnt(12)
v_mfma_f32_16x16x32_bf16 v[232:235], v[56:59], a[40:43], v[232:235]
ds_read_b128 a[68:71], v3 offset:17408
v_mfma_f32_16x16x32_bf16 v[236:239], v[56:59], a[112:115], v[236:239]
ds_read_b128 a[140:143], v3 offset:35840
v_mfma_f32_16x16x32_bf16 v[240:243], v[128:131], a[40:43], v[240:243]
v_mfma_f32_16x16x32_bf16 v[244:247], v[128:131], a[112:115], v[244:247]
s_waitcnt vmcnt(23) lgkmcnt(12)
v_mfma_f32_16x16x32_bf16 v[232:235], v[60:63], a[44:47], v[232:235]
v_mfma_f32_16x16x32_bf16 v[236:239], v[60:63], a[116:119], v[236:239]
v_mfma_f32_16x16x32_bf16 v[240:243], v[132:135], a[44:47], v[240:243]
v_mfma_f32_16x16x32_bf16 v[244:247], v[132:135], a[116:119], v[244:247]
s_waitcnt vmcnt(21) lgkmcnt(10)
v_mfma_f32_16x16x32_bf16 v[232:235], v[64:67], a[48:51], v[232:235]
v_mfma_f32_16x16x32_bf16 v[236:239], v[64:67], a[120:123], v[236:239]
v_mfma_f32_16x16x32_bf16 v[240:243], v[136:139], a[48:51], v[240:243]
v_mfma_f32_16x16x32_bf16 v[244:247], v[136:139], a[120:123], v[244:247]
s_waitcnt vmcnt(19) lgkmcnt(8)
v_mfma_f32_16x16x32_bf16 v[232:235], v[68:71], a[52:55], v[232:235]
v_mfma_f32_16x16x32_bf16 v[236:239], v[68:71], a[124:127], v[236:239]
v_mfma_f32_16x16x32_bf16 v[240:243], v[140:143], a[52:55], v[240:243]
v_mfma_f32_16x16x32_bf16 v[244:247], v[140:143], a[124:127], v[244:247]
s_waitcnt vmcnt(17) lgkmcnt(6)
v_mfma_f32_16x16x32_bf16 v[232:235], v[72:75], a[56:59], v[232:235]
v_mfma_f32_16x16x32_bf16 v[236:239], v[72:75], a[128:131], v[236:239]
v_mfma_f32_16x16x32_bf16 v[240:243], v[144:147], a[56:59], v[240:243]
v_mfma_f32_16x16x32_bf16 v[244:247], v[144:147], a[128:131], v[244:247]
s_waitcnt vmcnt(15) lgkmcnt(4)
v_mfma_f32_16x16x32_bf16 v[232:235], v[76:79], a[60:63], v[232:235]
v_mfma_f32_16x16x32_bf16 v[236:239], v[76:79], a[132:135], v[236:239]
v_mfma_f32_16x16x32_bf16 v[240:243], v[148:151], a[60:63], v[240:243]
v_mfma_f32_16x16x32_bf16 v[244:247], v[148:151], a[132:135], v[244:247]
s_waitcnt vmcnt(13) lgkmcnt(2)
v_mfma_f32_16x16x32_bf16 v[232:235], v[80:83], a[64:67], v[232:235]
v_mfma_f32_16x16x32_bf16 v[236:239], v[80:83], a[136:139], v[236:239]
v_mfma_f32_16x16x32_bf16 v[240:243], v[152:155], a[64:67], v[240:243]
v_mfma_f32_16x16x32_bf16 v[244:247], v[152:155], a[136:139], v[244:247]
s_waitcnt vmcnt(11) lgkmcnt(0)
v_mfma_f32_16x16x32_bf16 v[232:235], v[84:87], a[68:71], v[232:235]
v_mfma_f32_16x16x32_bf16 v[236:239], v[84:87], a[140:143], v[236:239]
v_mfma_f32_16x16x32_bf16 v[240:243], v[156:159], a[68:71], v[240:243]
v_mfma_f32_16x16x32_bf16 v[244:247], v[156:159], a[140:143], v[244:247]
s_waitcnt vmcnt(0)
v_accvgpr_read_b32 v48, a144
v_accvgpr_read_b32 v64, a156
v_accvgpr_read_b32 v49, a145
v_accvgpr_read_b32 v65, a157
v_accvgpr_read_b32 v50, a146
v_accvgpr_read_b32 v66, a158
v_accvgpr_read_b32 v51, a147
v_accvgpr_read_b32 v67, a159
v_accvgpr_read_b32 v52, a148
v_accvgpr_read_b32 v68, a160
v_accvgpr_read_b32 v53, a149
v_accvgpr_read_b32 v69, a161
v_accvgpr_read_b32 v54, a150
v_accvgpr_read_b32 v70, a162
v_accvgpr_read_b32 v55, a151
v_accvgpr_read_b32 v71, a163
v_mov_b32 v8, 0
v_mov_b32 v9, 0
v_mov_b32 v10, 0
v_mov_b32 v11, 0
s_nop 4
v_lshlrev_b32 v12, 16, v48
v_and_b32 v13, 0xffff0000, v48
v_fma_f32 v12, v232, v64, v12
v_fma_f32 v13, v233, v65, v13
v_cvt_pk_bf16_f32 v16, v12, v13
v_lshlrev_b32 v232, 16, v16
v_and_b32 v233, 0xffff0000, v16
v_add_f32 v8, v8, v232
v_fma_f32 v9, v232, v232, v9
v_add_f32 v8, v8, v233
v_fma_f32 v9, v233, v233, v9
v_lshlrev_b32 v12, 16, v49
v_and_b32 v13, 0xffff0000, v49
v_fma_f32 v12, v234, v66, v12
v_fma_f32 v13, v235, v67, v13
v_cvt_pk_bf16_f32 v17, v12, v13
v_lshlrev_b32 v234, 16, v17
v_and_b32 v235, 0xffff0000, v17
v_add_f32 v8, v8, v234
v_fma_f32 v9, v234, v234, v9
v_add_f32 v8, v8, v235
v_fma_f32 v9, v235, v235, v9
v_lshlrev_b32 v12, 16, v50
v_and_b32 v13, 0xffff0000, v50
v_fma_f32 v12, v236, v64, v12
v_fma_f32 v13, v237, v65, v13
v_cvt_pk_bf16_f32 v18, v12, v13
v_lshlrev_b32 v236, 16, v18
v_and_b32 v237, 0xffff0000, v18
v_add_f32 v10, v10, v236
v_fma_f32 v11, v236, v236, v11
v_add_f32 v10, v10, v237
v_fma_f32 v11, v237, v237, v11
v_lshlrev_b32 v12, 16, v51
v_and_b32 v13, 0xffff0000, v51
v_fma_f32 v12, v238, v66, v12
v_fma_f32 v13, v239, v67, v13
v_cvt_pk_bf16_f32 v19, v12, v13
v_lshlrev_b32 v238, 16, v19
v_and_b32 v239, 0xffff0000, v19
v_add_f32 v10, v10, v238
v_fma_f32 v11, v238, v238, v11
v_add_f32 v10, v10, v239
v_fma_f32 v11, v239, v239, v11
v_lshlrev_b32 v12, 16, v52
v_and_b32 v13, 0xffff0000, v52
v_fma_f32 v12, v240, v68, v12
v_fma_f32 v13, v241, v69, v13
v_cvt_pk_bf16_f32 v20, v12, v13
v_lshlrev_b32 v240, 16, v20
v_and_b32 v241, 0xffff0000, v20
v_add_f32 v8, v8, v240
v_fma_f32 v9, v240, v240, v9
v_add_f32 v8, v8, v241
v_fma_f32 v9, v241, v241, v9
v_lshlrev_b32 v12, 16, v53
v_and_b32 v13, 0xffff0000, v53
v_fma_f32 v12, v242, v70, v12
v_fma_f32 v13, v243, v71, v13
v_cvt_pk_bf16_f32 v21, v12, v13
v_lshlrev_b32 v242, 16, v21
v_and_b32 v243, 0xffff0000, v21
v_add_f32 v8, v8, v242
v_fma_f32 v9, v242, v242, v9
v_add_f32 v8, v8, v243
v_fma_f32 v9, v243, v243, v9
v_lshlrev_b32 v12, 16, v54
v_and_b32 v13, 0xffff0000, v54
v_fma_f32 v12, v244, v68, v12
v_fma_f32 v13, v245, v69, v13
v_cvt_pk_bf16_f32 v22, v12, v13
v_lshlrev_b32 v244, 16, v22
v_and_b32 v245, 0xffff0000, v22
v_add_f32 v10, v10, v244
v_fma_f32 v11, v244, v244, v11
v_add_f32 v10, v10, v245
v_fma_f32 v11, v245, v245, v11
v_lshlrev_b32 v12, 16, v55
v_and_b32 v13, 0xffff0000, v55
v_fma_f32 v12, v246, v70, v12
v_fma_f32 v13, v247, v71, v13
v_cvt_pk_bf16_f32 v23, v12, v13
v_lshlrev_b32 v246, 16, v23
v_and_b32 v247, 0xffff0000, v23
v_add_f32 v10, v10, v246
v_fma_f32 v11, v246, v246, v11
v_add_f32 v10, v10, v247
v_fma_f32 v11, v247, v247, v11
v_lshlrev_b32 v12, 3, v0
ds_write_b64 v12, v[8:9] offset:36864
ds_write_b64 v12, v[10:11] offset:38912
s_mul_i32 s31, s16, 36
s_add_u32 s31, s31, s18
s_lshl_b32 s31, s31, 10
s_add_u32 s31, s31, 2621440
buffer_store_dwordx4 v[16:19], v3, s[8:11], s31 offen sc1
s_mul_i32 s31, s16, 36
s_add_u32 s31, s31, s30
s_lshl_b32 s31, s31, 10
s_add_u32 s31, s31, 2621440
buffer_store_dwordx4 v[20:23], v3, s[8:11], s31 offen sc1
s_waitcnt lgkmcnt(0)
s_barrier
s_lshl_b32 s33, s16, 10
s_add_u32 s33, s33, 10551296
s_cmp_lg_u32 s3, 1
s_cbranch_scc1 L_wo_nopub
v_and_b32 v12, 31, v2
v_lshrrev_b32 v13, 4, v12
v_lshlrev_b32 v13, 11, v13
v_lshl_add_u32 v13, v4, 3, v13
ds_read_b64 v[80:81], v13 offset:36864
ds_read_b64 v[82:83], v13 offset:36992
ds_read_b64 v[84:85], v13 offset:37120
ds_read_b64 v[86:87], v13 offset:37248
ds_read_b64 v[88:89], v13 offset:37376
ds_read_b64 v[90:91], v13 offset:37504
ds_read_b64 v[92:93], v13 offset:37632
ds_read_b64 v[94:95], v13 offset:37760
ds_read_b64 v[96:97], v13 offset:37888
ds_read_b64 v[98:99], v13 offset:38016
ds_read_b64 v[100:101], v13 offset:38144
ds_read_b64 v[102:103], v13 offset:38272
ds_read_b64 v[104:105], v13 offset:38400
ds_read_b64 v[106:107], v13 offset:38528
s_waitcnt lgkmcnt(8)
ds_read_b64 v[108:109], v13 offset:38656
ds_read_b64 v[110:111], v13 offset:38784
s_waitcnt lgkmcnt(0)
v_add_f32 v80, v80, v96
v_add_f32 v81, v81, v97
v_add_f32 v82, v82, v98
v_add_f32 v83, v83, v99
v_add_f32 v84, v84, v100
v_add_f32 v85, v85, v101
v_add_f32 v86, v86, v102
v_add_f32 v87, v87, v103
v_add_f32 v88, v88, v104
v_add_f32 v89, v89, v105
v_add_f32 v90, v90, v106
v_add_f32 v91, v91, v107
v_add_f32 v92, v92, v108
v_add_f32 v93, v93, v109
v_add_f32 v94, v94, v110
v_add_f32 v95, v95, v111
v_add_f32 v80, v80, v88
v_add_f32 v81, v81, v89
v_add_f32 v82, v82, v90
v_add_f32 v83, v83, v91
v_add_f32 v84, v84, v92
v_add_f32 v85, v85, v93
v_add_f32 v86, v86, v94
v_add_f32 v87, v87, v95
v_add_f32 v80, v80, v84
v_add_f32 v81, v81, v85
v_add_f32 v82, v82, v86
v_add_f32 v83, v83, v87
v_add_f32 v80, v80, v82
v_add_f32 v81, v81, v83
v_lshlrev_b32 v12, 5, v12
s_lshl_b32 s34, s17, 3
s_add_u32 s34, s34, s33
v_cmp_gt_u32 vcc, 32, v2
s_and_saveexec_b64 s[36:37], vcc
buffer_store_dwordx2 v[80:81], v12, s[8:11], s34 offen sc1
s_mov_b64 exec, s[36:37]
L_wo_nopub:
v_accvgpr_read_b32 v116, a168
v_accvgpr_read_b32 v128, a180
v_accvgpr_read_b32 v117, a169
v_accvgpr_read_b32 v129, a181
v_accvgpr_read_b32 v118, a170
v_accvgpr_read_b32 v130, a182
v_accvgpr_read_b32 v119, a171
v_accvgpr_read_b32 v131, a183
v_accvgpr_read_b32 v120, a172
v_accvgpr_read_b32 v132, a184
v_accvgpr_read_b32 v121, a173
v_accvgpr_read_b32 v133, a185
v_accvgpr_read_b32 v122, a174
v_accvgpr_read_b32 v134, a186
v_accvgpr_read_b32 v123, a175
v_accvgpr_read_b32 v135, a187
v_add_f32 v128, 1.0, v128
v_add_f32 v129, 1.0, v129
v_add_f32 v130, 1.0, v130
v_add_f32 v131, 1.0, v131
v_add_f32 v132, 1.0, v132
v_add_f32 v133, 1.0, v133
v_add_f32 v134, 1.0, v134
v_add_f32 v135, 1.0, v135
v_lshlrev_b32 v12, 5, v4
s_mov_b32 s35, 0x40000
L_wo_polla:
buffer_load_dwordx4 v[144:147], v12, s[8:11], s33 offen sc1
buffer_load_dwordx4 v[148:151], v12, s[8:11], s33 offen offset:16 sc1
buffer_load_dwordx4 v[152:155], v12, s[8:11], s33 offen offset:512 sc1
buffer_load_dwordx4 v[156:159], v12, s[8:11], s33 offen offset:528 sc1
s_sub_u32 s35, s35, 1
s_cmp_eq_u32 s35, 0
s_cbranch_scc1 L_wo_gota
s_waitcnt vmcnt(0)
v_max3_u32 v13, v145, v147, v149
v_max3_u32 v13, v13, v151, v153
v_max3_u32 v13, v13, v155, v157
v_max_u32 v13, v13, v159
v_cmp_eq_u32 vcc, -1, v13
s_cbranch_vccnz L_wo_polla
L_wo_gota:
s_waitcnt vmcnt(0)
s_mov_b32 s35, 0x3ae38e39
v_add_f32 v144, v144, v146
v_add_f32 v148, v148, v150
v_add_f32 v145, v145, v147
v_add_f32 v149, v149, v151
v_add_f32 v144, v144, v148
v_add_f32 v145, v145, v149
v_mul_f32 v144, s35, v144
v_mul_f32 v145, s35, v145
v_fma_f32 v145, -v144, v144, v145
v_max_f32 v145, 0, v145
v_add_f32 v145, 0x3727c5ac, v145
v_rsq_f32 v145, v145
s_nop 0
v_mul_f32 v144, v144, v145
v_add_f32 v152, v152, v154
v_add_f32 v156, v156, v158
v_add_f32 v153, v153, v155
v_add_f32 v157, v157, v159
v_add_f32 v152, v152, v156
v_add_f32 v153, v153, v157
v_mul_f32 v152, s35, v152
v_mul_f32 v153, s35, v153
v_fma_f32 v153, -v152, v152, v153
v_max_f32 v153, 0, v153
v_add_f32 v153, 0x3727c5ac, v153
v_rsq_f32 v153, v153
s_nop 0
v_mul_f32 v152, v152, v153
v_fma_f32 v232, v232, v145, -v144
v_fma_f32 v232, v232, v128, v116
v_fma_f32 v233, v233, v145, -v144
v_fma_f32 v233, v233, v129, v117
v_fma_f32 v234, v234, v145, -v144
v_fma_f32 v234, v234, v130, v118
v_fma_f32 v235, v235, v145, -v144
v_fma_f32 v235, v235, v131, v119
v_cvt_pk_bf16_f32 v160, v232, v233
v_cvt_pk_bf16_f32 v161, v234, v235
v_fma_f32 v240, v240, v145, -v144
v_fma_f32 v240, v240, v132, v120
v_fma_f32 v241, v241, v145, -v144
v_fma_f32 v241, v241, v133, v121
v_fma_f32 v242, v242, v145, -v144
v_fma_f32 v242, v242, v134, v122
v_fma_f32 v243, v243, v145, -v144
v_fma_f32 v243, v243, v135, v123
v_cvt_pk_bf16_f32 v162, v240, v241
v_cvt_pk_bf16_f32 v163, v242, v243
v_fma_f32 v236, v236, v153, -v152
v_fma_f32 v236, v236, v128, v116
v_fma_f32 v237, v237, v153, -v152
v_fma_f32 v237, v237, v129, v117
v_fma_f32 v238, v238, v153, -v152
v_fma_f32 v238, v238, v130, v118
v_fma_f32 v239, v239, v153, -v152
v_fma_f32 v239, v239, v131, v119
v_cvt_pk_bf16_f32 v168, v236, v237
v_cvt_pk_bf16_f32 v169, v238, v239
v_fma_f32 v244, v244, v153, -v152
v_fma_f32 v244, v244, v132, v120
v_fma_f32 v245, v245, v153, -v152
v_fma_f32 v245, v245, v133, v121
v_fma_f32 v246, v246, v153, -v152
v_fma_f32 v246, v246, v134, v122
v_fma_f32 v247, v247, v153, -v152
v_fma_f32 v247, v247, v135, v123
v_cvt_pk_bf16_f32 v170, v244, v245
v_cvt_pk_bf16_f32 v171, v246, v247
s_mul_i32 s31, s16, 36864
s_add_u32 s31, s31, 0
s_lshr_b32 s32, s18, 1
s_lshl_b32 s32, s32, 10
s_add_u32 s32, s32, s31
s_add_u32 s34, s32, 18432
buffer_store_dwordx4 v[160:163], v3, s[8:11], s32 offen sc1
buffer_store_dwordx4 v[168:171], v3, s[8:11], s34 offen sc1
s_branch L_wo_done
.p2align 12
L_wo_three:
buffer_load_dwordx4 v[16:19], v3, s[8:11], s25 offen offset:0
buffer_load_dwordx4 v[88:91], v3, s[8:11], s26 offen offset:0
buffer_load_dwordx4 v[160:163], v3, s[8:11], s27 offen offset:0
buffer_load_dwordx4 v[20:23], v3, s[8:11], s25 offen offset:1024
buffer_load_dwordx4 v[92:95], v3, s[8:11], s26 offen offset:1024
buffer_load_dwordx4 v[164:167], v3, s[8:11], s27 offen offset:1024
buffer_load_dwordx4 v[24:27], v3, s[8:11], s25 offen offset:2048
buffer_load_dwordx4 v[96:99], v3, s[8:11], s26 offen offset:2048
buffer_load_dwordx4 v[168:171], v3, s[8:11], s27 offen offset:2048
buffer_load_dwordx4 v[28:31], v3, s[8:11], s25 offen offset:3072
buffer_load_dwordx4 v[100:103], v3, s[8:11], s26 offen offset:3072
buffer_load_dwordx4 v[172:175], v3, s[8:11], s27 offen offset:3072
s_add_u32 s25, s25, 4096
s_add_u32 s26, s26, 4096
s_add_u32 s27, s27, 4096
buffer_load_dwordx4 v[32:35], v3, s[8:11], s25 offen offset:0
buffer_load_dwordx4 v[104:107], v3, s[8:11], s26 offen offset:0
buffer_load_dwordx4 v[176:179], v3, s[8:11], s27 offen offset:0
buffer_load_dwordx4 v[36:39], v3, s[8:11], s25 offen offset:1024
buffer_load_dwordx4 v[108:111], v3, s[8:11], s26 offen offset:1024
buffer_load_dwordx4 v[180:183], v3, s[8:11], s27 offen offset:1024
buffer_load_dwordx4 v[40:43], v3, s[8:11], s25 offen offset:2048
buffer_load_dwordx4 v[112:115], v3, s[8:11], s26 offen offset:2048
buffer_load_dwordx4 v[184:187], v3, s[8:11], s27 offen offset:2048
buffer_load_dwordx4 v[44:47], v3, s[8:11], s25 offen offset:3072
buffer_load_dwordx4 v[116:119], v3, s[8:11], s26 offen offset:3072
buffer_load_dwordx4 v[188:191], v3, s[8:11], s27 offen offset:3072
s_add_u32 s25, s25, 4096
s_add_u32 s26, s26, 4096
s_add_u32 s27, s27, 4096
buffer_load_dwordx4 v[48:51], v3, s[8:11], s25 offen offset:0
buffer_load_dwordx4 v[120:123], v3, s[8:11], s26 offen offset:0
buffer_load_dwordx4 v[192:195], v3, s[8:11], s27 offen offset:0
buffer_load_dwordx4 v[52:55], v3, s[8:11], s25 offen offset:1024
buffer_load_dwordx4 v[124:127], v3, s[8:11], s26 offen offset:1024
buffer_load_dwordx4 v[196:199], v3, s[8:11], s27 offen offset:1024
buffer_load_dwordx4 v[56:59], v3, s[8:11], s25 offen offset:2048
buffer_load_dwordx4 v[128:131], v3, s[8:11], s26 offen offset:2048
buffer_load_dwordx4 v[200:203], v3, s[8:11], s27 offen offset:2048
buffer_load_dwordx4 v[60:63], v3, s[8:11], s25 offen offset:3072
buffer_load_dwordx4 v[132:135], v3, s[8:11], s26 offen offset:3072
buffer_load_dwordx4 v[204:207], v3, s[8:11], s27 offen offset:3072
s_add_u32 s25, s25, 4096
s_add_u32 s26, s26, 4096
s_add_u32 s27, s27, 4096
buffer_load_dwordx4 v[64:67], v3, s[8:11], s25 offen offset:0
buffer_load_dwordx4 v[136:139], v3, s[8:11], s26 offen offset:0
buffer_load_dwordx4 v[208:211], v3, s[8:11], s27 offen offset:0
buffer_load_dwordx4 v[68:71], v3, s[8:11], s25 offen offset:1024
buffer_load_dwordx4 v[140:143], v3, s[8:11], s26 offen offset:1024
buffer_load_dwordx4 v[212:215], v3, s[8:11], s27 offen offset:1024
buffer_load_dwordx4 v[72:75], v3, s[8:11], s25 offen offset:2048
buffer_load_dwordx4 v[144:147], v3, s[8:11], s26 offen offset:2048
buffer_load_dwordx4 v[216:219], v3, s[8:11], s27 offen offset:2048
buffer_load_dwordx4 v[76:79], v3, s[8:11], s25 offen offset:3072
buffer_load_dwordx4 v[148:151], v3, s[8:11], s26 offen offset:3072
buffer_load_dwordx4 v[220:223], v3, s[8:11], s27 offen offset:3072
s_add_u32 s25, s25, 4096
s_add_u32 s26, s26, 4096
s_add_u32 s27, s27, 4096
buffer_load_dwordx4 v[80:83], v3, s[8:11], s25 offen offset:0
buffer_load_dwordx4 v[152:155], v3, s[8:11], s26 offen offset:0
buffer_load_dwordx4 v[224:227], v3, s[8:11], s27 offen offset:0
buffer_load_dwordx4 v[84:87], v3, s[8:11], s25 offen offset:1024
buffer_load_dwordx4 v[156:159], v3, s[8:11], s26 offen offset:1024
buffer_load_dwordx4 v[228:231], v3, s[8:11], s27 offen offset:1024
s_bfe_u32 s44, s2, 0x10003
s_lshl_b32 s44, s44, 2
s_add_u32 s44, s44, s3
s_getpc_b64 s[46:47]
L_pc_k2_3:
v_lshlrev_b32 v8, 6, v2
s_lshl_b32 s44, s44, 12
v_add_u32 v8, s44, v8
v_min_u32 v8, L_wo_end-L_pc_k2_3-4, v8
global_load_dword v9, v8, s[46:47]
s_add_u32 s30, s18, 1
s_waitcnt vmcnt(55)
s_barrier
ds_read_b128 a[0:3], v3 offset:0
ds_read_b128 a[72:75], v3 offset:18432
ds_read_b128 a[4:7], v3 offset:1024
ds_read_b128 a[76:79], v3 offset:19456
ds_read_b128 a[8:11], v3 offset:2048
ds_read_b128 a[80:83], v3 offset:20480
ds_read_b128 a[12:15], v3 offset:3072
ds_read_b128 a[84:87], v3 offset:21504
ds_read_b128 a[16:19], v3 offset:4096
ds_read_b128 a[88:91], v3 offset:22528
ds_read_b128 a[20:23], v3 offset:5120
ds_read_b128 a[92:95], v3 offset:23552
ds_read_b128 a[24:27], v3 offset:6144
ds_read_b128 a[96:99], v3 offset:24576
s_waitcnt vmcnt(52) lgkmcnt(12)
v_mfma_f32_16x16x32_bf16 v[232:235], v[16:19], a[0:3], 0
ds_read_b128 a[28:31], v3 offset:7168
ds_read_b128 a[100:103], v3 offset:25600
v_mfma_f32_16x16x32_bf16 v[236:239], v[16:19], a[72:75], 0
s_lshl_b32 s31, s18, 5
s_add_u32 s31, s31, s28
v_mfma_f32_16x16x32_bf16 v[240:243], v[88:91], a[0:3], 0
s_add_u32 s32, s31, 18432
buffer_load_dwordx2 a[144:145], v6, s[12:15], s31 offen
v_mfma_f32_16x16x32_bf16 v[244:247], v[88:91], a[72:75], 0
buffer_load_dwordx2 a[146:147], v6, s[12:15], s32 offen
v_mfma_f32_16x16x32_bf16 v[248:251], v[160:163], a[0:3], 0
v_mfma_f32_16x16x32_bf16 v[252:255], v[160:163], a[72:75], 0
s_waitcnt vmcnt(51) lgkmcnt(12)
v_mfma_f32_16x16x32_bf16 v[232:235], v[20:23], a[4:7], v[232:235]
ds_read_b128 a[32:35], v3 offset:8192
ds_read_b128 a[104:107], v3 offset:26624
v_mfma_f32_16x16x32_bf16 v[236:239], v[20:23], a[76:79], v[236:239]
s_lshl_b32 s31, s18, 6
s_add_u32 s31, s31, 10485760
v_mfma_f32_16x16x32_bf16 v[240:243], v[92:95], a[4:7], v[240:243]
s_add_u32 s32, s31, 4608
buffer_load_dwordx4 a[156:159], v7, s[8:11], s31 offen
v_mfma_f32_16x16x32_bf16 v[244:247], v[92:95], a[76:79], v[244:247]
buffer_load_dwordx4 a[168:171], v7, s[8:11], s31 offen offset:2304
buffer_load_dwordx4 a[180:183], v7, s[8:11], s32 offen
v_mfma_f32_16x16x32_bf16 v[248:251], v[164:167], a[4:7], v[248:251]
v_mfma_f32_16x16x32_bf16 v[252:255], v[164:167], a[76:79], v[252:255]
s_waitcnt vmcnt(51) lgkmcnt(12)
v_mfma_f32_16x16x32_bf16 v[232:235], v[24:27], a[8:11], v[232:235]
ds_read_b128 a[36:39], v3 offset:9216
ds_read_b128 a[108:111], v3 offset:27648
v_mfma_f32_16x16x32_bf16 v[236:239], v[24:27], a[80:83], v[236:239]
s_lshl_b32 s31, s30, 5
s_add_u32 s31, s31, s28
v_mfma_f32_16x16x32_bf16 v[240:243], v[96:99], a[8:11], v[240:243]
s_add_u32 s32, s31, 18432
buffer_load_dwordx2 a[148:149], v6, s[12:15], s31 offen
v_mfma_f32_16x16x32_bf16 v[244:247], v[96:99], a[80:83], v[244:247]
buffer_load_dwordx2 a[150:151], v6, s[12:15], s32 offen
v_mfma_f32_16x16x32_bf16 v[248:251], v[168:171], a[8:11], v[248:251]
v_mfma_f32_16x16x32_bf16 v[252:255], v[168:171], a[80:83], v[252:255]
s_waitcnt vmcnt(50) lgkmcnt(12)
v_mfma_f32_16x16x32_bf16 v[232:235], v[28:31], a[12:15], v[232:235]
ds_read_b128 a[40:43], v3 offset:10240
ds_read_b128 a[112:115], v3 offset:28672
v_mfma_f32_16x16x32_bf16 v[236:239], v[28:31], a[84:87], v[236:239]
s_lshl_b32 s31, s30, 6
s_add_u32 s31, s31, 10485760
v_mfma_f32_16x16x32_bf16 v[240:243], v[100:103], a[12:15], v[240:243]
s_add_u32 s32, s31, 4608
buffer_load_dwordx4 a[160:163], v7, s[8:11], s31 offen
v_mfma_f32_16x16x32_bf16 v[244:247], v[100:103], a[84:87], v[244:247]
buffer_load_dwordx4 a[172:175], v7, s[8:11], s31 offen offset:2304
buffer_load_dwordx4 a[184:187], v7, s[8:11], s32 offen
v_mfma_f32_16x16x32_bf16 v[248:251], v[172:175], a[12:15], v[248:251]
v_mfma_f32_16x16x32_bf16 v[252:255], v[172:175], a[84:87], v[252:255]
s_waitcnt vmcnt(50) lgkmcnt(12)
v_mfma_f32_16x16x32_bf16 v[232:235], v[32:35], a[16:19], v[232:235]
ds_read_b128 a[44:47], v3 offset:11264
ds_read_b128 a[116:119], v3 offset:29696
v_mfma_f32_16x16x32_bf16 v[236:239], v[32:35], a[88:91], v[236:239]
s_lshl_b32 s31, s19, 5
s_add_u32 s31, s31, s28
v_mfma_f32_16x16x32_bf16 v[240:243], v[104:107], a[16:19], v[240:243]
s_add_u32 s32, s31, 18432
buffer_load_dwordx2 a[152:153], v6, s[12:15], s31 offen
v_mfma_f32_16x16x32_bf16 v[244:247], v[104:107], a[88:91], v[244:247]
buffer_load_dwordx2 a[154:155], v6, s[12:15], s32 offen
v_mfma_f32_16x16x32_bf16 v[248:251], v[176:179], a[16:19], v[248:251]
v_mfma_f32_16x16x32_bf16 v[252:255], v[176:179], a[88:91], v[252:255]
s_waitcnt vmcnt(49) lgkmcnt(12)
v_mfma_f32_16x16x32_bf16 v[232:235], v[36:39], a[20:23], v[232:235]
ds_read_b128 a[48:51], v3 offset:12288
ds_read_b128 a[120:123], v3 offset:30720
v_mfma_f32_16x16x32_bf16 v[236:239], v[36:39], a[92:95], v[236:239]
s_lshl_b32 s31, s19, 6
s_add_u32 s31, s31, 10485760
v_mfma_f32_16x16x32_bf16 v[240:243], v[108:111], a[20:23], v[240:243]
s_add_u32 s32, s31, 4608
buffer_load_dwordx4 a[164:167], v7, s[8:11], s31 offen
v_mfma_f32_16x16x32_bf16 v[244:247], v[108:111], a[92:95], v[244:247]
buffer_load_dwordx4 a[176:179], v7, s[8:11], s31 offen offset:2304
buffer_load_dwordx4 a[188:191], v7, s[8:11], s32 offen
v_mfma_f32_16x16x32_bf16 v[248:251], v[180:183], a[20:23], v[248:251]
v_mfma_f32_16x16x32_bf16 v[252:255], v[180:183], a[92:95], v[252:255]
s_waitcnt vmcnt(49) lgkmcnt(12)
v_mfma_f32_16x16x32_bf16 v[232:235], v[40:43], a[24:27], v[232:235]
ds_read_b128 a[52:55], v3 offset:13312
v_mfma_f32_16x16x32_bf16 v[236:239], v[40:43], a[96:99], v[236:239]
ds_read_b128 a[124:127], v3 offset:31744
v_mfma_f32_16x16x32_bf16 v[240:243], v[112:115], a[24:27], v[240:243]
v_mfma_f32_16x16x32_bf16 v[244:247], v[112:115], a[96:99], v[244:247]
v_mfma_f32_16x16x32_bf16 v[248:251], v[184:187], a[24:27], v[248:251]
v_mfma_f32_16x16x32_bf16 v[252:255], v[184:187], a[96:99], v[252:255]
s_waitcnt vmcnt(46) lgkmcnt(12)
v_mfma_f32_16x16x32_bf16 v[232:235], v[44:47], a[28:31], v[232:235]
ds_read_b128 a[56:59], v3 offset:14336
v_mfma_f32_16x16x32_bf16 v[236:239], v[44:47], a[100:103], v[236:239]
ds_read_b128 a[128:131], v3 offset:32768
v_mfma_f32_16x16x32_bf16 v[240:243], v[116:119], a[28:31], v[240:243]
v_mfma_f32_16x16x32_bf16 v[244:247], v[116:119], a[100:103], v[244:247]
v_mfma_f32_16x16x32_bf16 v[248:251], v[188:191], a[28:31], v[248:251]
v_mfma_f32_16x16x32_bf16 v[252:255], v[188:191], a[100:103], v[252:255]
s_waitcnt vmcnt(43) lgkmcnt(12)
v_mfma_f32_16x16x32_bf16 v[232:235], v[48:51], a[32:35], v[232:235]
ds_read_b128 a[60:63], v3 offset:15360
v_mfma_f32_16x16x32_bf16 v[236:239], v[48:51], a[104:107], v[236:239]
ds_read_b128 a[132:135], v3 offset:33792
v_mfma_f32_16x16x32_bf16 v[240:243], v[120:123], a[32:35], v[240:243]
v_mfma_f32_16x16x32_bf16 v[244:247], v[120:123], a[104:107], v[244:247]
v_mfma_f32_16x16x32_bf16 v[248:251], v[192:195], a[32:35], v[248:251]
v_mfma_f32_16x16x32_bf16 v[252:255], v[192:195], a[104:107], v[252:255]
s_waitcnt vmcnt(40) lgkmcnt(12)
v_mfma_f32_16x16x32_bf16 v[232:235], v[52:55], a[36:39], v[232:235]
ds_read_b128 a[64:67], v3 offset:16384
v_mfma_f32_16x16x32_bf16 v[236:239], v[52:55], a[108:111], v[236:239]
ds_read_b128 a[136:139], v3 offset:34816
v_mfma_f32_16x16x32_bf16 v[240:243], v[124:127], a[36:39], v[240:243]
v_mfma_f32_16x16x32_bf16 v[244:247], v[124:127], a[108:111], v[244:247]
v_mfma_f32_16x16x32_bf16 v[248:251], v[196:199], a[36:39], v[248:251]
v_mfma_f32_16x16x32_bf16 v[252:255], v[196:199], a[108:111], v[252:255]
s_waitcnt vmcnt(37) lgkmcnt(12)
v_mfma_f32_16x16x32_bf16 v[232:235], v[56:59], a[40:43], v[232:235]
ds_read_b128 a[68:71], v3 offset:17408
v_mfma_f32_16x16x32_bf16 v[236:239], v[56:59], a[112:115], v[236:239]
ds_read_b128 a[140:143], v3 offset:35840
v_mfma_f32_16x16x32_bf16 v[240:243], v[128:131], a[40:43], v[240:243]
v_mfma_f32_16x16x32_bf16 v[244:247], v[128:131], a[112:115], v[244:247]
v_mfma_f32_16x16x32_bf16 v[248:251], v[200:203], a[40:43], v[248:251]
v_mfma_f32_16x16x32_bf16 v[252:255], v[200:203], a[112:115], v[252:255]
s_waitcnt vmcnt(34) lgkmcnt(12)
v_mfma_f32_16x16x32_bf16 v[232:235], v[60:63], a[44:47], v[232:235]
v_mfma_f32_16x16x32_bf16 v[236:239], v[60:63], a[116:119], v[236:239]
v_mfma_f32_16x16x32_bf16 v[240:243], v[132:135], a[44:47], v[240:243]
v_mfma_f32_16x16x32_bf16 v[244:247], v[132:135], a[116:119], v[244:247]
v_mfma_f32_16x16x32_bf16 v[248:251], v[204:207], a[44:47], v[248:251]
v_mfma_f32_16x16x32_bf16 v[252:255], v[204:207], a[116:119], v[252:255]
s_waitcnt vmcnt(31) lgkmcnt(10)
v_mfma_f32_16x16x32_bf16 v[232:235], v[64:67], a[48:51], v[232:235]
v_mfma_f32_16x16x32_bf16 v[236:239], v[64:67], a[120:123], v[236:239]
v_mfma_f32_16x16x32_bf16 v[240:243], v[136:139], a[48:51], v[240:243]
v_mfma_f32_16x16x32_bf16 v[244:247], v[136:139], a[120:123], v[244:247]
v_mfma_f32_16x16x32_bf16 v[248:251], v[208:211], a[48:51], v[248:251]
v_mfma_f32_16x16x32_bf16 v[252:255], v[208:211], a[120:123], v[252:255]
s_waitcnt vmcnt(28) lgkmcnt(8)
v_mfma_f32_16x16x32_bf16 v[232:235], v[68:71], a[52:55], v[232:235]
v_mfma_f32_16x16x32_bf16 v[236:239], v[68:71], a[124:127], v[236:239]
v_mfma_f32_16x16x32_bf16 v[240:243], v[140:143], a[52:55], v[240:243]
v_mfma_f32_16x16x32_bf16 v[244:247], v[140:143], a[124:127], v[244:247]
v_mfma_f32_16x16x32_bf16 v[248:251], v[212:215], a[52:55], v[248:251]
v_mfma_f32_16x16x32_bf16 v[252:255], v[212:215], a[124:127], v[252:255]
s_waitcnt vmcnt(25) lgkmcnt(6)
v_mfma_f32_16x16x32_bf16 v[232:235], v[72:75], a[56:59], v[232:235]
v_mfma_f32_16x16x32_bf16 v[236:239], v[72:75], a[128:131], v[236:239]
v_mfma_f32_16x16x32_bf16 v[240:243], v[144:147], a[56:59], v[240:243]
v_mfma_f32_16x16x32_bf16 v[244:247], v[144:147], a[128:131], v[244:247]
v_mfma_f32_16x16x32_bf16 v[248:251], v[216:219], a[56:59], v[248:251]
v_mfma_f32_16x16x32_bf16 v[252:255], v[216:219], a[128:131], v[252:255]
s_waitcnt vmcnt(22) lgkmcnt(4)
v_mfma_f32_16x16x32_bf16 v[232:235], v[76:79], a[60:63], v[232:235]
v_mfma_f32_16x16x32_bf16 v[236:239], v[76:79], a[132:135], v[236:239]
v_mfma_f32_16x16x32_bf16 v[240:243], v[148:151], a[60:63], v[240:243]
v_mfma_f32_16x16x32_bf16 v[244:247], v[148:151], a[132:135], v[244:247]
v_mfma_f32_16x16x32_bf16 v[248:251], v[220:223], a[60:63], v[248:251]
v_mfma_f32_16x16x32_bf16 v[252:255], v[220:223], a[132:135], v[252:255]
s_waitcnt vmcnt(19) lgkmcnt(2)
v_mfma_f32_16x16x32_bf16 v[232:235], v[80:83], a[64:67], v[232:235]
v_mfma_f32_16x16x32_bf16 v[236:239], v[80:83], a[136:139], v[236:239]
v_mfma_f32_16x16x32_bf16 v[240:243], v[152:155], a[64:67], v[240:243]
v_mfma_f32_16x16x32_bf16 v[244:247], v[152:155], a[136:139], v[244:247]
v_mfma_f32_16x16x32_bf16 v[248:251], v[224:227], a[64:67], v[248:251]
v_mfma_f32_16x16x32_bf16 v[252:255], v[224:227], a[136:139], v[252:255]
s_waitcnt vmcnt(16) lgkmcnt(0)
v_mfma_f32_16x16x32_bf16 v[232:235], v[84:87], a[68:71], v[232:235]
v_mfma_f32_16x16x32_bf16 v[236:239], v[84:87], a[140:143], v[236:239]
v_mfma_f32_16x16x32_bf16 v[240:243], v[156:159], a[68:71], v[240:243]
v_mfma_f32_16x16x32_bf16 v[244:247], v[156:159], a[140:143], v[244:247]
v_mfma_f32_16x16x32_bf16 v[248:251], v[228:231], a[68:71], v[248:251]
v_mfma_f32_16x16x32_bf16 v[252:255], v[228:231], a[140:143], v[252:255]
s_waitcnt vmcnt(0)
v_accvgpr_read_b32 v48, a144
v_accvgpr_read_b32 v64, a156
v_accvgpr_read_b32 v49, a145
v_accvgpr_read_b32 v65, a157
v_accvgpr_read_b32 v50, a146
v_accvgpr_read_b32 v66, a158
v_accvgpr_read_b32 v51, a147
v_accvgpr_read_b32 v67, a159
v_accvgpr_read_b32 v52, a148
v_accvgpr_read_b32 v68, a160
v_accvgpr_read_b32 v53, a149
v_accvgpr_read_b32 v69, a161
v_accvgpr_read_b32 v54, a150
v_accvgpr_read_b32 v70, a162
v_accvgpr_read_b32 v55, a151
v_accvgpr_read_b32 v71, a163
v_accvgpr_read_b32 v56, a152
v_accvgpr_read_b32 v72, a164
v_accvgpr_read_b32 v57, a153
v_accvgpr_read_b32 v73, a165
v_accvgpr_read_b32 v58, a154
v_accvgpr_read_b32 v74, a166
v_accvgpr_read_b32 v59, a155
v_accvgpr_read_b32 v75, a167
v_mov_b32 v8, 0
v_mov_b32 v9, 0
v_mov_b32 v10, 0
v_mov_b32 v11, 0
s_nop 4
v_lshlrev_b32 v12, 16, v48
v_and_b32 v13, 0xffff0000, v48
v_fma_f32 v12, v232, v64, v12
v_fma_f32 v13, v233, v65, v13
v_cvt_pk_bf16_f32 v16, v12, v13
v_lshlrev_b32 v232, 16, v16
v_and_b32 v233, 0xffff0000, v16
v_add_f32 v8, v8, v232
v_fma_f32 v9, v232, v232, v9
v_add_f32 v8, v8, v233
v_fma_f32 v9, v233, v233, v9
v_lshlrev_b32 v12, 16, v49
v_and_b32 v13, 0xffff0000, v49
v_fma_f32 v12, v234, v66, v12
v_fma_f32 v13, v235, v67, v13
v_cvt_pk_bf16_f32 v17, v12, v13
v_lshlrev_b32 v234, 16, v17
v_and_b32 v235, 0xffff0000, v17
v_add_f32 v8, v8, v234
v_fma_f32 v9, v234, v234, v9
v_add_f32 v8, v8, v235
v_fma_f32 v9, v235, v235, v9
v_lshlrev_b32 v12, 16, v50
v_and_b32 v13, 0xffff0000, v50
v_fma_f32 v12, v236, v64, v12
v_fma_f32 v13, v237, v65, v13
v_cvt_pk_bf16_f32 v18, v12, v13
v_lshlrev_b32 v236, 16, v18
v_and_b32 v237, 0xffff0000, v18
v_add_f32 v10, v10, v236
v_fma_f32 v11, v236, v236, v11
v_add_f32 v10, v10, v237
v_fma_f32 v11, v237, v237, v11
v_lshlrev_b32 v12, 16, v51
v_and_b32 v13, 0xffff0000, v51
v_fma_f32 v12, v238, v66, v12
v_fma_f32 v13, v239, v67, v13
v_cvt_pk_bf16_f32 v19, v12, v13
v_lshlrev_b32 v238, 16, v19
v_and_b32 v239, 0xffff0000, v19
v_add_f32 v10, v10, v238
v_fma_f32 v11, v238, v238, v11
v_add_f32 v10, v10, v239
v_fma_f32 v11, v239, v239, v11
v_lshlrev_b32 v12, 16, v52
v_and_b32 v13, 0xffff0000, v52
v_fma_f32 v12, v240, v68, v12
v_fma_f32 v13, v241, v69, v13
v_cvt_pk_bf16_f32 v20, v12, v13
v_lshlrev_b32 v240, 16, v20
v_and_b32 v241, 0xffff0000, v20
v_add_f32 v8, v8, v240
v_fma_f32 v9, v240, v240, v9
v_add_f32 v8, v8, v241
v_fma_f32 v9, v241, v241, v9
v_lshlrev_b32 v12, 16, v53
v_and_b32 v13, 0xffff0000, v53
v_fma_f32 v12, v242, v70, v12
v_fma_f32 v13, v243, v71, v13
v_cvt_pk_bf16_f32 v21, v12, v13
v_lshlrev_b32 v242, 16, v21
v_and_b32 v243, 0xffff0000, v21
v_add_f32 v8, v8, v242
v_fma_f32 v9, v242, v242, v9
v_add_f32 v8, v8, v243
v_fma_f32 v9, v243, v243, v9
v_lshlrev_b32 v12, 16, v54
v_and_b32 v13, 0xffff0000, v54
v_fma_f32 v12, v244, v68, v12
v_fma_f32 v13, v245, v69, v13
v_cvt_pk_bf16_f32 v22, v12, v13
v_lshlrev_b32 v244, 16, v22
v_and_b32 v245, 0xffff0000, v22
v_add_f32 v10, v10, v244
v_fma_f32 v11, v244, v244, v11
v_add_f32 v10, v10, v245
v_fma_f32 v11, v245, v245, v11
v_lshlrev_b32 v12, 16, v55
v_and_b32 v13, 0xffff0000, v55
v_fma_f32 v12, v246, v70, v12
v_fma_f32 v13, v247, v71, v13
v_cvt_pk_bf16_f32 v23, v12, v13
v_lshlrev_b32 v246, 16, v23
v_and_b32 v247, 0xffff0000, v23
v_add_f32 v10, v10, v246
v_fma_f32 v11, v246, v246, v11
v_add_f32 v10, v10, v247
v_fma_f32 v11, v247, v247, v11
v_lshlrev_b32 v12, 16, v56
v_and_b32 v13, 0xffff0000, v56
v_fma_f32 v12, v248, v72, v12
v_fma_f32 v13, v249, v73, v13
v_cvt_pk_bf16_f32 v24, v12, v13
v_lshlrev_b32 v248, 16, v24
v_and_b32 v249, 0xffff0000, v24
v_add_f32 v8, v8, v248
v_fma_f32 v9, v248, v248, v9
v_add_f32 v8, v8, v249
v_fma_f32 v9, v249, v249, v9
v_lshlrev_b32 v12, 16, v57
v_and_b32 v13, 0xffff0000, v57
v_fma_f32 v12, v250, v74, v12
v_fma_f32 v13, v251, v75, v13
v_cvt_pk_bf16_f32 v25, v12, v13
v_lshlrev_b32 v250, 16, v25
v_and_b32 v251, 0xffff0000, v25
v_add_f32 v8, v8, v250
v_fma_f32 v9, v250, v250, v9
v_add_f32 v8, v8, v251
v_fma_f32 v9, v251, v251, v9
v_lshlrev_b32 v12, 16, v58
v_and_b32 v13, 0xffff0000, v58
v_fma_f32 v12, v252, v72, v12
v_fma_f32 v13, v253, v73, v13
v_cvt_pk_bf16_f32 v26, v12, v13
v_lshlrev_b32 v252, 16, v26
v_and_b32 v253, 0xffff0000, v26
v_add_f32 v10, v10, v252
v_fma_f32 v11, v252, v252, v11
v_add_f32 v10, v10, v253
v_fma_f32 v11, v253, v253, v11
v_lshlrev_b32 v12, 16, v59
v_and_b32 v13, 0xffff0000, v59
v_fma_f32 v12, v254, v74, v12
v_fma_f32 v13, v255, v75, v13
v_cvt_pk_bf16_f32 v27, v12, v13
v_lshlrev_b32 v254, 16, v27
v_and_b32 v255, 0xffff0000, v27
v_add_f32 v10, v10, v254
v_fma_f32 v11, v254, v254, v11
v_add_f32 v10, v10, v255
v_fma_f32 v11, v255, v255, v11
v_lshlrev_b32 v12, 3, v0
ds_write_b64 v12, v[8:9] offset:36864
ds_write_b64 v12, v[10:11] offset:38912
s_mul_i32 s31, s16, 36
s_add_u32 s31, s31, s18
s_lshl_b32 s31, s31, 10
s_add_u32 s31, s31, 2621440
buffer_store_dwordx4 v[16:19], v3, s[8:11], s31 offen sc1
s_mul_i32 s31, s16, 36
s_add_u32 s31, s31, s30
s_lshl_b32 s31, s31, 10
s_add_u32 s31, s31, 2621440
buffer_store_dwordx4 v[20:23], v3, s[8:11], s31 offen sc1
s_mul_i32 s31, s16, 36
s_add_u32 s31, s31, s19
s_lshl_b32 s31, s31, 10
s_add_u32 s31, s31, 2621440
buffer_store_dwordx4 v[24:27], v3, s[8:11], s31 offen sc1
s_waitcnt lgkmcnt(0)
s_barrier
s_lshl_b32 s33, s16, 10
s_add_u32 s33, s33, 10551296
v_accvgpr_read_b32 v116, a168
v_accvgpr_read_b32 v128, a180
v_accvgpr_read_b32 v117, a169
v_accvgpr_read_b32 v129, a181
v_accvgpr_read_b32 v118, a170
v_accvgpr_read_b32 v130, a182
v_accvgpr_read_b32 v119, a171
v_accvgpr_read_b32 v131, a183
v_accvgpr_read_b32 v120, a172
v_accvgpr_read_b32 v132, a184
v_accvgpr_read_b32 v121, a173
v_accvgpr_read_b32 v133, a185
v_accvgpr_read_b32 v122, a174
v_accvgpr_read_b32 v134, a186
v_accvgpr_read_b32 v123, a175
v_accvgpr_read_b32 v135, a187
v_accvgpr_read_b32 v124, a176
v_accvgpr_read_b32 v136, a188
v_accvgpr_read_b32 v125, a177
v_accvgpr_read_b32 v137, a189
v_accvgpr_read_b32 v126, a178
v_accvgpr_read_b32 v138, a190
v_accvgpr_read_b32 v127, a179
v_accvgpr_read_b32 v139, a191
v_add_f32 v128, 1.0, v128
v_add_f32 v129, 1.0, v129
v_add_f32 v130, 1.0, v130
v_add_f32 v131, 1.0, v131
v_add_f32 v132, 1.0, v132
v_add_f32 v133, 1.0, v133
v_add_f32 v134, 1.0, v134
v_add_f32 v135, 1.0, v135
v_add_f32 v136, 1.0, v136
v_add_f32 v137, 1.0, v137
v_add_f32 v138, 1.0, v138
v_add_f32 v139, 1.0, v139
v_lshlrev_b32 v12, 5, v4
s_mov_b32 s35, 0x40000
L_wo_pollb:
buffer_load_dwordx4 v[144:147], v12, s[8:11], s33 offen sc1
buffer_load_dwordx4 v[148:151], v12, s[8:11], s33 offen offset:16 sc1
buffer_load_dwordx4 v[152:155], v12, s[8:11], s33 offen offset:512 sc1
buffer_load_dwordx4 v[156:159], v12, s[8:11], s33 offen offset:528 sc1
s_sub_u32 s35, s35, 1
s_cmp_eq_u32 s35, 0
s_cbranch_scc1 L_wo_gotb
s_waitcnt vmcnt(0)
v_max3_u32 v13, v145, v147, v149
v_max3_u32 v13, v13, v151, v153
v_max3_u32 v13, v13, v155, v157
v_max_u32 v13, v13, v159
v_cmp_eq_u32 vcc, -1, v13
s_cbranch_vccnz L_wo_pollb
L_wo_gotb:
s_waitcnt vmcnt(0)
s_mov_b32 s35, 0x3ae38e39
v_add_f32 v144, v144, v146
v_add_f32 v148, v148, v150
v_add_f32 v145, v145, v147
v_add_f32 v149, v149, v151
v_add_f32 v144, v144, v148
v_add_f32 v145, v145, v149
v_mul_f32 v144, s35, v144
v_mul_f32 v145, s35, v145
v_fma_f32 v145, -v144, v144, v145
v_max_f32 v145, 0, v145
v_add_f32 v145, 0x3727c5ac, v145
v_rsq_f32 v145, v145
s_nop 0
v_mul_f32 v144, v144, v145
v_add_f32 v152, v152, v154
v_add_f32 v156, v156, v158
v_add_f32 v153, v153, v155
v_add_f32 v157, v157, v159
v_add_f32 v152, v152, v156
v_add_f32 v153, v153, v157
v_mul_f32 v152, s35, v152
v_mul_f32 v153, s35, v153
v_fma_f32 v153, -v152, v152, v153
v_max_f32 v153, 0, v153
v_add_f32 v153, 0x3727c5ac, v153
v_rsq_f32 v153, v153
s_nop 0
v_mul_f32 v152, v152, v153
v_fma_f32 v232, v232, v145, -v144
v_fma_f32 v232, v232, v128, v116
v_fma_f32 v233, v233, v145, -v144
v_fma_f32 v233, v233, v129, v117
v_fma_f32 v234, v234, v145, -v144
v_fma_f32 v234, v234, v130, v118
v_fma_f32 v235, v235, v145, -v144
v_fma_f32 v235, v235, v131, v119
v_cvt_pk_bf16_f32 v160, v232, v233
v_cvt_pk_bf16_f32 v161, v234, v235
v_fma_f32 v240, v240, v145, -v144
v_fma_f32 v240, v240, v132, v120
v_fma_f32 v241, v241, v145, -v144
v_fma_f32 v241, v241, v133, v121
v_fma_f32 v242, v242, v145, -v144
v_fma_f32 v242, v242, v134, v122
v_fma_f32 v243, v243, v145, -v144
v_fma_f32 v243, v243, v135, v123
v_cvt_pk_bf16_f32 v162, v240, v241
v_cvt_pk_bf16_f32 v163, v242, v243
v_fma_f32 v248, v248, v145, -v144
v_fma_f32 v248, v248, v136, v124
v_fma_f32 v249, v249, v145, -v144
v_fma_f32 v249, v249, v137, v125
v_fma_f32 v250, v250, v145, -v144
v_fma_f32 v250, v250, v138, v126
v_fma_f32 v251, v251, v145, -v144
v_fma_f32 v251, v251, v139, v127
v_cvt_pk_bf16_f32 v164, v248, v249
v_cvt_pk_bf16_f32 v165, v250, v251
v_fma_f32 v236, v236, v153, -v152
v_fma_f32 v236, v236, v128, v116
v_fma_f32 v237, v237, v153, -v152
v_fma_f32 v237, v237, v129, v117
v_fma_f32 v238, v238, v153, -v152
v_fma_f32 v238, v238, v130, v118
v_fma_f32 v239, v239, v153, -v152
v_fma_f32 v239, v239, v131, v119
v_cvt_pk_bf16_f32 v168, v236, v237
v_cvt_pk_bf16_f32 v169, v238, v239
v_fma_f32 v244, v244, v153, -v152
v_fma_f32 v244, v244, v132, v120
v_fma_f32 v245, v245, v153, -v152
v_fma_f32 v245, v245, v133, v121
v_fma_f32 v246, v246, v153, -v152
v_fma_f32 v246, v246, v134, v122
v_fma_f32 v247, v247, v153, -v152
v_fma_f32 v247, v247, v135, v123
v_cvt_pk_bf16_f32 v170, v244, v245
v_cvt_pk_bf16_f32 v171, v246, v247
v_fma_f32 v252, v252, v153, -v152
v_fma_f32 v252, v252, v136, v124
v_fma_f32 v253, v253, v153, -v152
v_fma_f32 v253, v253, v137, v125
v_fma_f32 v254, v254, v153, -v152
v_fma_f32 v254, v254, v138, v126
v_fma_f32 v255, v255, v153, -v152
v_fma_f32 v255, v255, v139, v127
v_cvt_pk_bf16_f32 v172, v252, v253
v_cvt_pk_bf16_f32 v173, v254, v255
s_mul_i32 s31, s16, 36864
s_add_u32 s31, s31, 0
s_lshr_b32 s32, s18, 1
s_lshl_b32 s32, s32, 10
s_add_u32 s32, s32, s31
s_add_u32 s34, s32, 18432
buffer_store_dwordx4 v[160:163], v3, s[8:11], s32 offen sc1
buffer_store_dwordx4 v[168:171], v3, s[8:11], s34 offen sc1
s_lshr_b32 s32, s19, 1
s_lshl_b32 s32, s32, 10
s_add_u32 s32, s32, s31
s_and_b32 s34, s19, 1
s_lshl_b32 s34, s34, 3
s_add_u32 s32, s32, s34
s_add_u32 s34, s32, 18432
buffer_store_dwordx2 v[164:165], v3, s[8:11], s32 offen sc1
buffer_store_dwordx2 v[172:173], v3, s[8:11], s34 offen sc1
L_wo_done:
L_wo_end:
s_endpgm
.globl mlp_kernel
.p2align 8
.type mlp_kernel,@function
mlp_kernel:
s_cmp_ge_u32 s2, 256
s_cbranch_scc1 L_mlp_end
s_load_dwordx4 s[40:43], s[0:1], 32
s_load_dwordx2 s[44:45], s[0:1], 48
s_load_dwordx2 s[46:47], s[0:1], 88
v_lshrrev_b32 v1, 6, v0
v_and_b32 v2, 63, v0
s_nop 0
v_readfirstlane_b32 s24, v1
s_waitcnt lgkmcnt(0)
s_mov_b32 s8, s40
s_and_b32 s9, s41, 0xffff
s_mov_b32 s10, 5308416
s_mov_b32 s11, 0x00020000
s_mov_b32 s12, s42
s_and_b32 s13, s43, 0xffff
s_mov_b32 s14, 5308416
s_mov_b32 s15, 0x00020000
s_mov_b32 s16, s44
s_and_b32 s17, s45, 0xffff
s_mov_b32 s18, 5308416
s_mov_b32 s19, 0x00020000
s_mov_b32 s20, s46
s_and_b32 s21, s47, 0xffff
s_mov_b32 s22, 268435456
s_mov_b32 s23, 0x00020000
s_and_b32 s26, s2, 3
s_lshl_b32 s26, s26, 2
s_bfe_u32 s27, s2, 0x20003
s_add_u32 s26, s26, s27
s_bfe_u32 s25, s2, 0x10002
s_lshl_b32 s25, s25, 3
s_lshr_b32 s27, s2, 5
s_add_u32 s25, s25, s27
s_and_b32 s27, s26, 1
s_nop 0
s_mul_i32 s36, s26, 288
s_lshl_b32 s37, s27, 5
s_add_u32 s37, s36, s37
s_xor_b32 s38, s27, 1
s_lshl_b32 s38, s38, 8
s_add_u32 s38, s36, s38
s_mul_i32 s28, s24, 663552
s_lshl_b32 s39, s37, 1
s_add_u32 s28, s28, s39
s_mul_i32 s29, s24, 1327104
s_lshl_b32 s39, s38, 1
s_add_u32 s29, s29, s39
s_mul_i32 s39, s24, 72
s_add_u32 s39, s39, s37
s_mul_i32 s30, s39, 1152
s_add_u32 s31, s30, 46080
s_mul_i32 s39, s38, 1152
s_cmp_eq_u32 s24, 3
s_cselect_b32 s31, s39, s31
s_mul_i32 s32, s24, 9216
s_lshl_b32 s39, s25, 2
s_add_u32 s39, s39, s24
s_mul_i32 s33, s39, 576
s_add_u32 s33, s33, s26
s_lshl_b32 s33, s33, 10
s_add_u32 s33, s33, 16777216
s_mul_i32 s35, s39, 36864
s_add_u32 s35, s35, 0
v_lshrrev_b32 v3, 3, v2
v_and_b32 v4, 7, v2
v_lshrrev_b32 v5, 4, v2
v_and_b32 v5, 3, v5
v_lshlrev_b32 v5, 1, v5
v_xor_b32 v4, v4, v5
v_lshlrev_b32 v4, 4, v4
v_mul_u32_u24 v5, 9216, v3
v_add_u32 v36, v5, v4
v_mul_u32_u24 v5, 1152, v3
v_add_u32 v44, v5, v4
v_lshrrev_b32 v3, 2, v2
v_and_b32 v4, 3, v2
v_lshrrev_b32 v5, 4, v2
v_and_b32 v5, 1, v5
v_lshlrev_b32 v5, 1, v5
v_xor_b32 v4, v4, v5
v_lshlrev_b32 v4, 4, v4
v_mul_u32_u24 v5, 9216, v3
v_add_u32 v40, v5, v4
v_lshlrev_b32 v240, 4, v2
v_add_u32 v37, 72704, v36
v_add_u32 v41, 146432, v40
v_add_u32 v45, 8192, v44
v_add_u32 v38, 145408, v36
v_add_u32 v42, 292864, v40
v_add_u32 v46, 16384, v44
v_add_u32 v39, 218112, v36
v_add_u32 v43, 439296, v40
v_add_u32 v47, 24576, v44
v_lshrrev_b32 v3, 2, v2
v_and_b32 v4, 3, v2
v_lshrrev_b32 v5, 1, v3
v_and_b32 v5, 3, v5
v_lshlrev_b32 v6, 7, v3
v_lshlrev_b32 v7, 3, v4
v_add_u32 v6, v6, v7
v_xor_b32 v7, 0, v5
v_lshlrev_b32 v7, 5, v7
v_add_u32 v16, v6, v7
v_add_u32 v20, 36864, v16
v_add_u32 v24, 73728, v16
v_add_u32 v28, 110592, v16
v_xor_b32 v7, 1, v5
v_lshlrev_b32 v7, 5, v7
v_add_u32 v17, v6, v7
v_add_u32 v21, 36864, v17
v_add_u32 v25, 73728, v17
v_add_u32 v29, 110592, v17
v_xor_b32 v7, 2, v5
v_lshlrev_b32 v7, 5, v7
v_add_u32 v18, v6, v7
v_add_u32 v22, 36864, v18
v_add_u32 v26, 73728, v18
v_add_u32 v30, 110592, v18
v_xor_b32 v7, 3, v5
v_lshlrev_b32 v7, 5, v7
v_add_u32 v19, v6, v7
v_add_u32 v23, 36864, v19
v_add_u32 v27, 73728, v19
v_add_u32 v31, 110592, v19
v_lshrrev_b32 v5, 2, v3
v_and_b32 v5, 1, v5
v_lshlrev_b32 v6, 6, v3
v_lshlrev_b32 v7, 3, v4
v_add_u32 v6, v6, v7
v_xor_b32 v7, 0, v5
v_lshlrev_b32 v7, 5, v7
v_add_u32 v32, v6, v7
v_add_u32 v34, 36864, v32
v_xor_b32 v7, 1, v5
v_lshlrev_b32 v7, 5, v7
v_add_u32 v33, v6, v7
v_add_u32 v35, 36864, v33
s_bfe_u32 s48, s2, 0x20003
s_lshl_b32 s48, s48, 2
s_add_u32 s48, s48, s24
s_getpc_b64 s[50:51]
L_pc_k3:
v_lshlrev_b32 v241, 6, v2
s_lshl_b32 s48, s48, 12
v_add_u32 v241, s48, v241
v_min_u32 v241, L_mlp_end-L_pc_k3-4, v241
global_load_dword v242, v241, s[50:51]
s_add_u32 m0, s32, 0
s_add_u32 s34, s28, 0
buffer_load_dwordx4 v36, s[8:11], s34 offen offset:0 lds
buffer_load_dwordx4 v37, s[8:11], s34 offen offset:1024 lds
buffer_load_dwordx4 v38, s[8:11], s34 offen offset:2048 lds
buffer_load_dwordx4 v39, s[8:11], s34 offen offset:3072 lds
s_add_u32 m0, s32, 4096
s_add_u32 s34, s28, 294912
buffer_load_dwordx4 v36, s[8:11], s34 offen offset:0 lds
buffer_load_dwordx4 v37, s[8:11], s34 offen offset:1024 lds
buffer_load_dwordx4 v38, s[8:11], s34 offen offset:2048 lds
buffer_load_dwordx4 v39, s[8:11], s34 offen offset:3072 lds
s_add_u32 m0, s32, 8192
s_add_u32 s34, s28, 589824
buffer_load_dwordx4 v36, s[8:11], s34 offen offset:0 lds
s_add_u32 s34, s35, 0
buffer_load_dwordx4 a[0:3], v240, s[20:23], s34 offen offset:0
buffer_load_dwordx4 a[4:7], v240, s[20:23], s34 offen offset:1024
buffer_load_dwordx4 a[8:11], v240, s[20:23], s34 offen offset:2048
buffer_load_dwordx4 a[12:15], v240, s[20:23], s34 offen offset:3072
s_add_u32 s34, s34, 4096
buffer_load_dwordx4 a[16:19], v240, s[20:23], s34 offen offset:0
buffer_load_dwordx4 a[20:23], v240, s[20:23], s34 offen offset:1024
buffer_load_dwordx4 a[24:27], v240, s[20:23], s34 offen offset:2048
buffer_load_dwordx4 a[28:31], v240, s[20:23], s34 offen offset:3072
s_add_u32 s34, s34, 4096
buffer_load_dwordx4 a[32:35], v240, s[20:23], s34 offen offset:0
s_add_u32 s34, s35, 18432
buffer_load_dwordx4 a[72:75], v240, s[20:23], s34 offen offset:0
buffer_load_dwordx4 a[76:79], v240, s[20:23], s34 offen offset:1024
buffer_load_dwordx4 a[80:83], v240, s[20:23], s34 offen offset:2048
buffer_load_dwordx4 a[84:87], v240, s[20:23], s34 offen offset:3072
s_add_u32 s34, s34, 4096
buffer_load_dwordx4 a[88:91], v240, s[20:23], s34 offen offset:0
buffer_load_dwordx4 a[92:95], v240, s[20:23], s34 offen offset:1024
buffer_load_dwordx4 a[96:99], v240, s[20:23], s34 offen offset:2048
buffer_load_dwordx4 a[100:103], v240, s[20:23], s34 offen offset:3072
s_add_u32 s34, s34, 4096
buffer_load_dwordx4 a[104:107], v240, s[20:23], s34 offen offset:0
s_barrier
s_add_u32 m0, s32, 36864
s_add_u32 s34, s28, 0
buffer_load_dwordx4 v36, s[12:15], s34 offen offset:0 lds
buffer_load_dwordx4 v37, s[12:15], s34 offen offset:1024 lds
buffer_load_dwordx4 v38, s[12:15], s34 offen offset:2048 lds
buffer_load_dwordx4 v39, s[12:15], s34 offen offset:3072 lds
s_add_u32 m0, s32, 40960
s_add_u32 s34, s28, 294912
buffer_load_dwordx4 v36, s[12:15], s34 offen offset:0 lds
buffer_load_dwordx4 v37, s[12:15], s34 offen offset:1024 lds
buffer_load_dwordx4 v38, s[12:15], s34 offen offset:2048 lds
buffer_load_dwordx4 v39, s[12:15], s34 offen offset:3072 lds
s_add_u32 m0, s32, 45056
s_add_u32 s34, s28, 589824
buffer_load_dwordx4 v36, s[12:15], s34 offen offset:0 lds
s_waitcnt vmcnt(36)
s_mov_b64 exec, 0
s_cmp_eq_u32 s24, 0
s_cbranch_scc1 L_mlp_pad0
s_cmp_eq_u32 s24, 1
s_cbranch_scc1 L_mlp_pad1
s_cmp_eq_u32 s24, 2
s_cbranch_scc1 L_mlp_pad2
s_cmp_eq_u32 s24, 3
s_cbranch_scc1 L_mlp_pad3
L_mlp_padret:
s_mov_b64 exec, -1
s_waitcnt vmcnt(9)
s_barrier
s_branch L_mlp_al
.p2align 12
L_mlp_al:
L_mlp_pad0:
s_cbranch_execz L_mlp_pad4
ds_read_b64_tr_b16 v[48:49], v16 offset:0
ds_read_b64_tr_b16 v[50:51], v16 offset:2048
ds_read_b64_tr_b16 v[52:53], v16 offset:4096
ds_read_b64_tr_b16 v[54:55], v16 offset:6144
ds_read_b64_tr_b16 v[56:57], v16 offset:8192
ds_read_b64_tr_b16 v[58:59], v16 offset:10240
ds_read_b64_tr_b16 v[60:61], v16 offset:12288
ds_read_b64_tr_b16 v[62:63], v16 offset:14336
ds_read_b64_tr_b16 v[64:65], v16 offset:16384
ds_read_b64_tr_b16 v[66:67], v16 offset:18432
ds_read_b64_tr_b16 v[68:69], v16 offset:20480
ds_read_b64_tr_b16 v[70:71], v16 offset:22528
ds_read_b64_tr_b16 v[72:73], v16 offset:24576
ds_read_b64_tr_b16 v[74:75], v16 offset:26624
ds_read_b64_tr_b16 v[76:77], v16 offset:28672
ds_read_b64_tr_b16 v[78:79], v16 offset:30720
s_waitcnt lgkmcnt(8)
v_mfma_f32_16x16x32_bf16 v[96:99], v[48:51], a[0:3], 0
ds_read_b64_tr_b16 v[80:81], v16 offset:32768
s_add_u32 s37, s35, 9216
v_mfma_f32_16x16x32_bf16 v[100:103], v[48:51], a[72:75], 0
ds_read_b64_tr_b16 v[82:83], v16 offset:34816
buffer_load_dwordx4 a[36:39], v240, s[20:23], s37 offen offset:0
v_mfma_f32_16x16x32_bf16 v[96:99], v[52:55], a[4:7], v[96:99]
ds_read_b64_tr_b16 v[84:85], v17 offset:0
buffer_load_dwordx4 a[40:43], v240, s[20:23], s37 offen offset:1024
v_mfma_f32_16x16x32_bf16 v[100:103], v[52:55], a[76:79], v[100:103]
ds_read_b64_tr_b16 v[86:87], v17 offset:2048
buffer_load_dwordx4 a[44:47], v240, s[20:23], s37 offen offset:2048
v_mfma_f32_16x16x32_bf16 v[96:99], v[56:59], a[8:11], v[96:99]
ds_read_b64_tr_b16 v[88:89], v17 offset:4096
buffer_load_dwordx4 a[48:51], v240, s[20:23], s37 offen offset:3072
v_mfma_f32_16x16x32_bf16 v[100:103], v[56:59], a[80:83], v[100:103]
ds_read_b64_tr_b16 v[90:91], v17 offset:6144
v_mfma_f32_16x16x32_bf16 v[96:99], v[60:63], a[12:15], v[96:99]
ds_read_b64_tr_b16 v[92:93], v17 offset:8192
s_add_u32 s37, s37, 4096
v_mfma_f32_16x16x32_bf16 v[100:103], v[60:63], a[84:87], v[100:103]
ds_read_b64_tr_b16 v[94:95], v17 offset:10240
s_waitcnt lgkmcnt(8)
v_mfma_f32_16x16x32_bf16 v[96:99], v[64:67], a[16:19], v[96:99]
ds_read_b64_tr_b16 v[48:49], v17 offset:12288
buffer_load_dwordx4 a[52:55], v240, s[20:23], s37 offen offset:0
v_mfma_f32_16x16x32_bf16 v[100:103], v[64:67], a[88:91], v[100:103]
ds_read_b64_tr_b16 v[50:51], v17 offset:14336
buffer_load_dwordx4 a[56:59], v240, s[20:23], s37 offen offset:1024
v_mfma_f32_16x16x32_bf16 v[96:99], v[68:71], a[20:23], v[96:99]
ds_read_b64_tr_b16 v[52:53], v17 offset:16384
buffer_load_dwordx4 a[60:63], v240, s[20:23], s37 offen offset:2048
v_mfma_f32_16x16x32_bf16 v[100:103], v[68:71], a[92:95], v[100:103]
ds_read_b64_tr_b16 v[54:55], v17 offset:18432
buffer_load_dwordx4 a[64:67], v240, s[20:23], s37 offen offset:3072
v_mfma_f32_16x16x32_bf16 v[96:99], v[72:75], a[24:27], v[96:99]
ds_read_b64_tr_b16 v[56:57], v17 offset:20480
v_mfma_f32_16x16x32_bf16 v[100:103], v[72:75], a[96:99], v[100:103]
ds_read_b64_tr_b16 v[58:59], v17 offset:22528
s_add_u32 s37, s37, 4096
v_mfma_f32_16x16x32_bf16 v[96:99], v[76:79], a[28:31], v[96:99]
ds_read_b64_tr_b16 v[60:61], v17 offset:24576
buffer_load_dwordx4 a[68:71], v240, s[20:23], s37 offen offset:0
v_mfma_f32_16x16x32_bf16 v[100:103], v[76:79], a[100:103], v[100:103]
ds_read_b64_tr_b16 v[62:63], v17 offset:26624
s_waitcnt lgkmcnt(8)
v_mfma_f32_16x16x32_bf16 v[96:99], v[80:83], a[32:35], v[96:99]
ds_read_b64_tr_b16 v[64:65], v17 offset:28672
s_add_u32 s37, s35, 27648
v_mfma_f32_16x16x32_bf16 v[100:103], v[80:83], a[104:107], v[100:103]
ds_read_b64_tr_b16 v[66:67], v17 offset:30720
buffer_load_dwordx4 a[108:111], v240, s[20:23], s37 offen offset:0
v_mfma_f32_16x16x32_bf16 v[104:107], v[84:87], a[0:3], 0
ds_read_b64_tr_b16 v[68:69], v17 offset:32768
buffer_load_dwordx4 a[112:115], v240, s[20:23], s37 offen offset:1024
v_mfma_f32_16x16x32_bf16 v[108:111], v[84:87], a[72:75], 0
ds_read_b64_tr_b16 v[70:71], v17 offset:34816
v_mfma_f32_16x16x32_bf16 v[104:107], v[88:91], a[4:7], v[104:107]
ds_read_b64_tr_b16 v[72:73], v18 offset:0
buffer_load_dwordx4 a[116:119], v240, s[20:23], s37 offen offset:2048
v_mfma_f32_16x16x32_bf16 v[108:111], v[88:91], a[76:79], v[108:111]
ds_read_b64_tr_b16 v[74:75], v18 offset:2048
buffer_load_dwordx4 a[120:123], v240, s[20:23], s37 offen offset:3072
v_mfma_f32_16x16x32_bf16 v[104:107], v[92:95], a[8:11], v[104:107]
ds_read_b64_tr_b16 v[76:77], v18 offset:4096
s_add_u32 s37, s37, 4096
v_mfma_f32_16x16x32_bf16 v[108:111], v[92:95], a[80:83], v[108:111]
ds_read_b64_tr_b16 v[78:79], v18 offset:6144
s_waitcnt lgkmcnt(8)
v_mfma_f32_16x16x32_bf16 v[104:107], v[48:51], a[12:15], v[104:107]
ds_read_b64_tr_b16 v[80:81], v18 offset:8192
buffer_load_dwordx4 a[124:127], v240, s[20:23], s37 offen offset:0
v_mfma_f32_16x16x32_bf16 v[108:111], v[48:51], a[84:87], v[108:111]
ds_read_b64_tr_b16 v[82:83], v18 offset:10240
buffer_load_dwordx4 a[128:131], v240, s[20:23], s37 offen offset:1024
v_mfma_f32_16x16x32_bf16 v[104:107], v[52:55], a[16:19], v[104:107]
ds_read_b64_tr_b16 v[84:85], v18 offset:12288
v_mfma_f32_16x16x32_bf16 v[108:111], v[52:55], a[88:91], v[108:111]
ds_read_b64_tr_b16 v[86:87], v18 offset:14336
buffer_load_dwordx4 a[132:135], v240, s[20:23], s37 offen offset:2048
v_mfma_f32_16x16x32_bf16 v[104:107], v[56:59], a[20:23], v[104:107]
ds_read_b64_tr_b16 v[88:89], v18 offset:16384
buffer_load_dwordx4 a[136:139], v240, s[20:23], s37 offen offset:3072
v_mfma_f32_16x16x32_bf16 v[108:111], v[56:59], a[92:95], v[108:111]
ds_read_b64_tr_b16 v[90:91], v18 offset:18432
s_add_u32 s37, s37, 4096
v_mfma_f32_16x16x32_bf16 v[104:107], v[60:63], a[24:27], v[104:107]
ds_read_b64_tr_b16 v[92:93], v18 offset:20480
buffer_load_dwordx4 a[140:143], v240, s[20:23], s37 offen offset:0
v_mfma_f32_16x16x32_bf16 v[108:111], v[60:63], a[96:99], v[108:111]
ds_read_b64_tr_b16 v[94:95], v18 offset:22528
s_waitcnt lgkmcnt(8)
v_mfma_f32_16x16x32_bf16 v[104:107], v[64:67], a[28:31], v[104:107]
ds_read_b64_tr_b16 v[48:49], v18 offset:24576
s_add_u32 m0, s32, 73728
v_mfma_f32_16x16x32_bf16 v[108:111], v[64:67], a[100:103], v[108:111]
ds_read_b64_tr_b16 v[50:51], v18 offset:26624
v_mfma_f32_16x16x32_bf16 v[104:107], v[68:71], a[32:35], v[104:107]
ds_read_b64_tr_b16 v[52:53], v18 offset:28672
s_add_u32 s34, s28, 2654208
v_mfma_f32_16x16x32_bf16 v[108:111], v[68:71], a[104:107], v[108:111]
ds_read_b64_tr_b16 v[54:55], v18 offset:30720
buffer_load_dwordx4 v36, s[8:11], s34 offen offset:0 lds
v_mfma_f32_16x16x32_bf16 v[112:115], v[72:75], a[0:3], 0
ds_read_b64_tr_b16 v[56:57], v18 offset:32768
buffer_load_dwordx4 v37, s[8:11], s34 offen offset:1024 lds
v_mfma_f32_16x16x32_bf16 v[116:119], v[72:75], a[72:75], 0
ds_read_b64_tr_b16 v[58:59], v18 offset:34816
buffer_load_dwordx4 v38, s[8:11], s34 offen offset:2048 lds
v_mfma_f32_16x16x32_bf16 v[112:115], v[76:79], a[4:7], v[112:115]
ds_read_b64_tr_b16 v[60:61], v19 offset:0
buffer_load_dwordx4 v39, s[8:11], s34 offen offset:3072 lds
v_mfma_f32_16x16x32_bf16 v[116:119], v[76:79], a[76:79], v[116:119]
ds_read_b64_tr_b16 v[62:63], v19 offset:2048
s_waitcnt lgkmcnt(8)
v_mfma_f32_16x16x32_bf16 v[112:115], v[80:83], a[8:11], v[112:115]
ds_read_b64_tr_b16 v[64:65], v19 offset:4096
v_mfma_f32_16x16x32_bf16 v[116:119], v[80:83], a[80:83], v[116:119]
ds_read_b64_tr_b16 v[66:67], v19 offset:6144
s_add_u32 m0, s32, 77824
v_mfma_f32_16x16x32_bf16 v[112:115], v[84:87], a[12:15], v[112:115]
ds_read_b64_tr_b16 v[68:69], v19 offset:8192
s_add_u32 s34, s28, 2949120
v_mfma_f32_16x16x32_bf16 v[116:119], v[84:87], a[84:87], v[116:119]
ds_read_b64_tr_b16 v[70:71], v19 offset:10240
buffer_load_dwordx4 v36, s[8:11], s34 offen offset:0 lds
v_mfma_f32_16x16x32_bf16 v[112:115], v[88:91], a[16:19], v[112:115]
ds_read_b64_tr_b16 v[72:73], v19 offset:12288
buffer_load_dwordx4 v37, s[8:11], s34 offen offset:1024 lds
v_mfma_f32_16x16x32_bf16 v[116:119], v[88:91], a[88:91], v[116:119]
ds_read_b64_tr_b16 v[74:75], v19 offset:14336
buffer_load_dwordx4 v38, s[8:11], s34 offen offset:2048 lds
v_mfma_f32_16x16x32_bf16 v[112:115], v[92:95], a[20:23], v[112:115]
ds_read_b64_tr_b16 v[76:77], v19 offset:16384
v_mfma_f32_16x16x32_bf16 v[116:119], v[92:95], a[92:95], v[116:119]
ds_read_b64_tr_b16 v[78:79], v19 offset:18432
s_waitcnt lgkmcnt(8)
v_mfma_f32_16x16x32_bf16 v[112:115], v[48:51], a[24:27], v[112:115]
ds_read_b64_tr_b16 v[80:81], v19 offset:20480
buffer_load_dwordx4 v39, s[8:11], s34 offen offset:3072 lds
v_mfma_f32_16x16x32_bf16 v[116:119], v[48:51], a[96:99], v[116:119]
ds_read_b64_tr_b16 v[82:83], v19 offset:22528
s_add_u32 m0, s32, 81920
v_mfma_f32_16x16x32_bf16 v[112:115], v[52:55], a[28:31], v[112:115]
ds_read_b64_tr_b16 v[84:85], v19 offset:24576
s_add_u32 s34, s28, 3244032
v_mfma_f32_16x16x32_bf16 v[116:119], v[52:55], a[100:103], v[116:119]
ds_read_b64_tr_b16 v[86:87], v19 offset:26624
buffer_load_dwordx4 v36, s[8:11], s34 offen offset:0 lds
v_mfma_f32_16x16x32_bf16 v[112:115], v[56:59], a[32:35], v[112:115]
ds_read_b64_tr_b16 v[88:89], v19 offset:28672
v_mfma_f32_16x16x32_bf16 v[116:119], v[56:59], a[104:107], v[116:119]
ds_read_b64_tr_b16 v[90:91], v19 offset:30720
s_waitcnt vmcnt(27)
v_mfma_f32_16x16x32_bf16 v[120:123], v[60:63], a[0:3], 0
ds_read_b64_tr_b16 v[92:93], v19 offset:32768
s_barrier
v_mfma_f32_16x16x32_bf16 v[124:127], v[60:63], a[72:75], 0
ds_read_b64_tr_b16 v[94:95], v19 offset:34816
s_waitcnt lgkmcnt(8)
v_mfma_f32_16x16x32_bf16 v[120:123], v[64:67], a[4:7], v[120:123]
ds_read_b64_tr_b16 v[48:49], v20 offset:0
v_mfma_f32_16x16x32_bf16 v[124:127], v[64:67], a[76:79], v[124:127]
ds_read_b64_tr_b16 v[50:51], v20 offset:2048
v_mfma_f32_16x16x32_bf16 v[120:123], v[68:71], a[8:11], v[120:123]
ds_read_b64_tr_b16 v[52:53], v20 offset:4096
v_mfma_f32_16x16x32_bf16 v[124:127], v[68:71], a[80:83], v[124:127]
ds_read_b64_tr_b16 v[54:55], v20 offset:6144
v_mfma_f32_16x16x32_bf16 v[120:123], v[72:75], a[12:15], v[120:123]
ds_read_b64_tr_b16 v[56:57], v20 offset:8192
v_mfma_f32_16x16x32_bf16 v[124:127], v[72:75], a[84:87], v[124:127]
ds_read_b64_tr_b16 v[58:59], v20 offset:10240
v_mfma_f32_16x16x32_bf16 v[120:123], v[76:79], a[16:19], v[120:123]
ds_read_b64_tr_b16 v[60:61], v20 offset:12288
v_mfma_f32_16x16x32_bf16 v[124:127], v[76:79], a[88:91], v[124:127]
ds_read_b64_tr_b16 v[62:63], v20 offset:14336
s_waitcnt lgkmcnt(8)
v_mfma_f32_16x16x32_bf16 v[120:123], v[80:83], a[20:23], v[120:123]
ds_read_b64_tr_b16 v[64:65], v20 offset:16384
v_mfma_f32_16x16x32_bf16 v[124:127], v[80:83], a[92:95], v[124:127]
ds_read_b64_tr_b16 v[66:67], v20 offset:18432
v_mfma_f32_16x16x32_bf16 v[120:123], v[84:87], a[24:27], v[120:123]
ds_read_b64_tr_b16 v[68:69], v20 offset:20480
v_mfma_f32_16x16x32_bf16 v[124:127], v[84:87], a[96:99], v[124:127]
ds_read_b64_tr_b16 v[70:71], v20 offset:22528
v_mfma_f32_16x16x32_bf16 v[120:123], v[88:91], a[28:31], v[120:123]
ds_read_b64_tr_b16 v[72:73], v20 offset:24576
v_mfma_f32_16x16x32_bf16 v[124:127], v[88:91], a[100:103], v[124:127]
ds_read_b64_tr_b16 v[74:75], v20 offset:26624
v_mfma_f32_16x16x32_bf16 v[120:123], v[92:95], a[32:35], v[120:123]
ds_read_b64_tr_b16 v[76:77], v20 offset:28672
v_mfma_f32_16x16x32_bf16 v[124:127], v[92:95], a[104:107], v[124:127]
ds_read_b64_tr_b16 v[78:79], v20 offset:30720
s_waitcnt lgkmcnt(8)
v_mfma_f32_16x16x32_bf16 v[128:131], v[48:51], a[0:3], 0
ds_read_b64_tr_b16 v[80:81], v20 offset:32768
s_add_u32 m0, s32, 110592
v_mfma_f32_16x16x32_bf16 v[132:135], v[48:51], a[72:75], 0
ds_read_b64_tr_b16 v[82:83], v20 offset:34816
v_mfma_f32_16x16x32_bf16 v[128:131], v[52:55], a[4:7], v[128:131]
ds_read_b64_tr_b16 v[84:85], v21 offset:0
v_mfma_f32_16x16x32_bf16 v[132:135], v[52:55], a[76:79], v[132:135]
ds_read_b64_tr_b16 v[86:87], v21 offset:2048
s_add_u32 s34, s28, 2654208
v_mfma_f32_16x16x32_bf16 v[128:131], v[56:59], a[8:11], v[128:131]
ds_read_b64_tr_b16 v[88:89], v21 offset:4096
v_mfma_f32_16x16x32_bf16 v[132:135], v[56:59], a[80:83], v[132:135]
ds_read_b64_tr_b16 v[90:91], v21 offset:6144
v_mfma_f32_16x16x32_bf16 v[128:131], v[60:63], a[12:15], v[128:131]
ds_read_b64_tr_b16 v[92:93], v21 offset:8192
buffer_load_dwordx4 v36, s[12:15], s34 offen offset:0 lds
v_mfma_f32_16x16x32_bf16 v[132:135], v[60:63], a[84:87], v[132:135]
ds_read_b64_tr_b16 v[94:95], v21 offset:10240
s_waitcnt lgkmcnt(8)
v_mfma_f32_16x16x32_bf16 v[128:131], v[64:67], a[16:19], v[128:131]
ds_read_b64_tr_b16 v[48:49], v21 offset:12288
v_mfma_f32_16x16x32_bf16 v[132:135], v[64:67], a[88:91], v[132:135]
ds_read_b64_tr_b16 v[50:51], v21 offset:14336
v_mfma_f32_16x16x32_bf16 v[128:131], v[68:71], a[20:23], v[128:131]
ds_read_b64_tr_b16 v[52:53], v21 offset:16384
buffer_load_dwordx4 v37, s[12:15], s34 offen offset:1024 lds
v_mfma_f32_16x16x32_bf16 v[132:135], v[68:71], a[92:95], v[132:135]
ds_read_b64_tr_b16 v[54:55], v21 offset:18432
v_mfma_f32_16x16x32_bf16 v[128:131], v[72:75], a[24:27], v[128:131]
ds_read_b64_tr_b16 v[56:57], v21 offset:20480
v_mfma_f32_16x16x32_bf16 v[132:135], v[72:75], a[96:99], v[132:135]
ds_read_b64_tr_b16 v[58:59], v21 offset:22528
buffer_load_dwordx4 v38, s[12:15], s34 offen offset:2048 lds
v_mfma_f32_16x16x32_bf16 v[128:131], v[76:79], a[28:31], v[128:131]
ds_read_b64_tr_b16 v[60:61], v21 offset:24576
v_mfma_f32_16x16x32_bf16 v[132:135], v[76:79], a[100:103], v[132:135]
ds_read_b64_tr_b16 v[62:63], v21 offset:26624
s_waitcnt lgkmcnt(8)
v_mfma_f32_16x16x32_bf16 v[128:131], v[80:83], a[32:35], v[128:131]
ds_read_b64_tr_b16 v[64:65], v21 offset:28672
v_mfma_f32_16x16x32_bf16 v[132:135], v[80:83], a[104:107], v[132:135]
ds_read_b64_tr_b16 v[66:67], v21 offset:30720
buffer_load_dwordx4 v39, s[12:15], s34 offen offset:3072 lds
v_mfma_f32_16x16x32_bf16 v[136:139], v[84:87], a[0:3], 0
ds_read_b64_tr_b16 v[68:69], v21 offset:32768
v_mfma_f32_16x16x32_bf16 v[140:143], v[84:87], a[72:75], 0
ds_read_b64_tr_b16 v[70:71], v21 offset:34816
v_mfma_f32_16x16x32_bf16 v[136:139], v[88:91], a[4:7], v[136:139]
ds_read_b64_tr_b16 v[72:73], v22 offset:0
s_add_u32 m0, s32, 114688
v_mfma_f32_16x16x32_bf16 v[140:143], v[88:91], a[76:79], v[140:143]
ds_read_b64_tr_b16 v[74:75], v22 offset:2048
v_mfma_f32_16x16x32_bf16 v[136:139], v[92:95], a[8:11], v[136:139]
ds_read_b64_tr_b16 v[76:77], v22 offset:4096
v_mfma_f32_16x16x32_bf16 v[140:143], v[92:95], a[80:83], v[140:143]
ds_read_b64_tr_b16 v[78:79], v22 offset:6144
s_waitcnt lgkmcnt(8)
v_mfma_f32_16x16x32_bf16 v[136:139], v[48:51], a[12:15], v[136:139]
ds_read_b64_tr_b16 v[80:81], v22 offset:8192
s_add_u32 s34, s28, 2949120
v_mfma_f32_16x16x32_bf16 v[140:143], v[48:51], a[84:87], v[140:143]
ds_read_b64_tr_b16 v[82:83], v22 offset:10240
v_mfma_f32_16x16x32_bf16 v[136:139], v[52:55], a[16:19], v[136:139]
ds_read_b64_tr_b16 v[84:85], v22 offset:12288
v_mfma_f32_16x16x32_bf16 v[140:143], v[52:55], a[88:91], v[140:143]
ds_read_b64_tr_b16 v[86:87], v22 offset:14336
v_mfma_f32_16x16x32_bf16 v[136:139], v[56:59], a[20:23], v[136:139]
ds_read_b64_tr_b16 v[88:89], v22 offset:16384
buffer_load_dwordx4 v36, s[12:15], s34 offen offset:0 lds
v_mfma_f32_16x16x32_bf16 v[140:143], v[56:59], a[92:95], v[140:143]
ds_read_b64_tr_b16 v[90:91], v22 offset:18432
v_mfma_f32_16x16x32_bf16 v[136:139], v[60:63], a[24:27], v[136:139]
ds_read_b64_tr_b16 v[92:93], v22 offset:20480
v_mfma_f32_16x16x32_bf16 v[140:143], v[60:63], a[96:99], v[140:143]
ds_read_b64_tr_b16 v[94:95], v22 offset:22528
s_waitcnt lgkmcnt(8)
v_mfma_f32_16x16x32_bf16 v[136:139], v[64:67], a[28:31], v[136:139]
ds_read_b64_tr_b16 v[48:49], v22 offset:24576
buffer_load_dwordx4 v37, s[12:15], s34 offen offset:1024 lds
v_mfma_f32_16x16x32_bf16 v[140:143], v[64:67], a[100:103], v[140:143]
ds_read_b64_tr_b16 v[50:51], v22 offset:26624
v_mfma_f32_16x16x32_bf16 v[136:139], v[68:71], a[32:35], v[136:139]
ds_read_b64_tr_b16 v[52:53], v22 offset:28672
v_mfma_f32_16x16x32_bf16 v[140:143], v[68:71], a[104:107], v[140:143]
ds_read_b64_tr_b16 v[54:55], v22 offset:30720
buffer_load_dwordx4 v38, s[12:15], s34 offen offset:2048 lds
v_mfma_f32_16x16x32_bf16 v[144:147], v[72:75], a[0:3], 0
ds_read_b64_tr_b16 v[56:57], v22 offset:32768
v_mfma_f32_16x16x32_bf16 v[148:151], v[72:75], a[72:75], 0
ds_read_b64_tr_b16 v[58:59], v22 offset:34816
v_mfma_f32_16x16x32_bf16 v[144:147], v[76:79], a[4:7], v[144:147]
ds_read_b64_tr_b16 v[60:61], v23 offset:0
buffer_load_dwordx4 v39, s[12:15], s34 offen offset:3072 lds
v_mfma_f32_16x16x32_bf16 v[148:151], v[76:79], a[76:79], v[148:151]
ds_read_b64_tr_b16 v[62:63], v23 offset:2048
s_waitcnt lgkmcnt(8)
v_mfma_f32_16x16x32_bf16 v[144:147], v[80:83], a[8:11], v[144:147]
ds_read_b64_tr_b16 v[64:65], v23 offset:4096
v_mfma_f32_16x16x32_bf16 v[148:151], v[80:83], a[80:83], v[148:151]
ds_read_b64_tr_b16 v[66:67], v23 offset:6144
v_mfma_f32_16x16x32_bf16 v[144:147], v[84:87], a[12:15], v[144:147]
ds_read_b64_tr_b16 v[68:69], v23 offset:8192
s_add_u32 m0, s32, 118784
v_mfma_f32_16x16x32_bf16 v[148:151], v[84:87], a[84:87], v[148:151]
ds_read_b64_tr_b16 v[70:71], v23 offset:10240
v_mfma_f32_16x16x32_bf16 v[144:147], v[88:91], a[16:19], v[144:147]
ds_read_b64_tr_b16 v[72:73], v23 offset:12288
v_mfma_f32_16x16x32_bf16 v[148:151], v[88:91], a[88:91], v[148:151]
ds_read_b64_tr_b16 v[74:75], v23 offset:14336
s_add_u32 s34, s28, 3244032
v_mfma_f32_16x16x32_bf16 v[144:147], v[92:95], a[20:23], v[144:147]
ds_read_b64_tr_b16 v[76:77], v23 offset:16384
v_mfma_f32_16x16x32_bf16 v[148:151], v[92:95], a[92:95], v[148:151]
ds_read_b64_tr_b16 v[78:79], v23 offset:18432
s_waitcnt lgkmcnt(8)
v_mfma_f32_16x16x32_bf16 v[144:147], v[48:51], a[24:27], v[144:147]
ds_read_b64_tr_b16 v[80:81], v23 offset:20480
v_mfma_f32_16x16x32_bf16 v[148:151], v[48:51], a[96:99], v[148:151]
ds_read_b64_tr_b16 v[82:83], v23 offset:22528
buffer_load_dwordx4 v36, s[12:15], s34 offen offset:0 lds
v_mfma_f32_16x16x32_bf16 v[144:147], v[52:55], a[28:31], v[144:147]
ds_read_b64_tr_b16 v[84:85], v23 offset:24576
v_mfma_f32_16x16x32_bf16 v[148:151], v[52:55], a[100:103], v[148:151]
ds_read_b64_tr_b16 v[86:87], v23 offset:26624
v_mfma_f32_16x16x32_bf16 v[144:147], v[56:59], a[32:35], v[144:147]
ds_read_b64_tr_b16 v[88:89], v23 offset:28672
v_mfma_f32_16x16x32_bf16 v[148:151], v[56:59], a[104:107], v[148:151]
ds_read_b64_tr_b16 v[90:91], v23 offset:30720
s_waitcnt vmcnt(9)
v_mfma_f32_16x16x32_bf16 v[152:155], v[60:63], a[0:3], 0
ds_read_b64_tr_b16 v[92:93], v23 offset:32768
s_barrier
v_mfma_f32_16x16x32_bf16 v[156:159], v[60:63], a[72:75], 0
ds_read_b64_tr_b16 v[94:95], v23 offset:34816
s_waitcnt lgkmcnt(8)
v_mfma_f32_16x16x32_bf16 v[152:155], v[64:67], a[4:7], v[152:155]
ds_read_b64_tr_b16 v[48:49], v24 offset:0
v_mfma_f32_16x16x32_bf16 v[156:159], v[64:67], a[76:79], v[156:159]
ds_read_b64_tr_b16 v[50:51], v24 offset:2048
v_mfma_f32_16x16x32_bf16 v[152:155], v[68:71], a[8:11], v[152:155]
ds_read_b64_tr_b16 v[52:53], v24 offset:4096
v_mfma_f32_16x16x32_bf16 v[156:159], v[68:71], a[80:83], v[156:159]
ds_read_b64_tr_b16 v[54:55], v24 offset:6144
v_mfma_f32_16x16x32_bf16 v[152:155], v[72:75], a[12:15], v[152:155]
ds_read_b64_tr_b16 v[56:57], v24 offset:8192
v_mfma_f32_16x16x32_bf16 v[156:159], v[72:75], a[84:87], v[156:159]
ds_read_b64_tr_b16 v[58:59], v24 offset:10240
v_mfma_f32_16x16x32_bf16 v[152:155], v[76:79], a[16:19], v[152:155]
ds_read_b64_tr_b16 v[60:61], v24 offset:12288
v_mfma_f32_16x16x32_bf16 v[156:159], v[76:79], a[88:91], v[156:159]
ds_read_b64_tr_b16 v[62:63], v24 offset:14336
s_waitcnt lgkmcnt(8)
v_mfma_f32_16x16x32_bf16 v[152:155], v[80:83], a[20:23], v[152:155]
ds_read_b64_tr_b16 v[64:65], v24 offset:16384
v_mfma_f32_16x16x32_bf16 v[156:159], v[80:83], a[92:95], v[156:159]
ds_read_b64_tr_b16 v[66:67], v24 offset:18432
v_mfma_f32_16x16x32_bf16 v[152:155], v[84:87], a[24:27], v[152:155]
ds_read_b64_tr_b16 v[68:69], v24 offset:20480
v_mfma_f32_16x16x32_bf16 v[156:159], v[84:87], a[96:99], v[156:159]
ds_read_b64_tr_b16 v[70:71], v24 offset:22528
v_mfma_f32_16x16x32_bf16 v[152:155], v[88:91], a[28:31], v[152:155]
ds_read_b64_tr_b16 v[72:73], v24 offset:24576
v_mfma_f32_16x16x32_bf16 v[156:159], v[88:91], a[100:103], v[156:159]
ds_read_b64_tr_b16 v[74:75], v24 offset:26624
v_mfma_f32_16x16x32_bf16 v[152:155], v[92:95], a[32:35], v[152:155]
ds_read_b64_tr_b16 v[76:77], v24 offset:28672
v_mfma_f32_16x16x32_bf16 v[156:159], v[92:95], a[104:107], v[156:159]
ds_read_b64_tr_b16 v[78:79], v24 offset:30720
s_waitcnt lgkmcnt(8)
v_mfma_f32_16x16x32_bf16 v[96:99], v[48:51], a[36:39], v[96:99]
ds_read_b64_tr_b16 v[80:81], v24 offset:32768
s_add_u32 m0, s32, 0
v_mfma_f32_16x16x32_bf16 v[100:103], v[48:51], a[108:111], v[100:103]
ds_read_b64_tr_b16 v[82:83], v24 offset:34816
v_mfma_f32_16x16x32_bf16 v[96:99], v[52:55], a[40:43], v[96:99]
ds_read_b64_tr_b16 v[84:85], v25 offset:0
v_mfma_f32_16x16x32_bf16 v[100:103], v[52:55], a[112:115], v[100:103]
ds_read_b64_tr_b16 v[86:87], v25 offset:2048
s_add_u32 s34, s28, 128
v_mfma_f32_16x16x32_bf16 v[96:99], v[56:59], a[44:47], v[96:99]
ds_read_b64_tr_b16 v[88:89], v25 offset:4096
v_mfma_f32_16x16x32_bf16 v[100:103], v[56:59], a[116:119], v[100:103]
ds_read_b64_tr_b16 v[90:91], v25 offset:6144
v_mfma_f32_16x16x32_bf16 v[96:99], v[60:63], a[48:51], v[96:99]
ds_read_b64_tr_b16 v[92:93], v25 offset:8192
buffer_load_dwordx4 v36, s[8:11], s34 offen offset:0 lds
v_mfma_f32_16x16x32_bf16 v[100:103], v[60:63], a[120:123], v[100:103]
ds_read_b64_tr_b16 v[94:95], v25 offset:10240
s_waitcnt lgkmcnt(8)
v_mfma_f32_16x16x32_bf16 v[96:99], v[64:67], a[52:55], v[96:99]
ds_read_b64_tr_b16 v[48:49], v25 offset:12288
v_mfma_f32_16x16x32_bf16 v[100:103], v[64:67], a[124:127], v[100:103]
ds_read_b64_tr_b16 v[50:51], v25 offset:14336
v_mfma_f32_16x16x32_bf16 v[96:99], v[68:71], a[56:59], v[96:99]
ds_read_b64_tr_b16 v[52:53], v25 offset:16384
buffer_load_dwordx4 v37, s[8:11], s34 offen offset:1024 lds
v_mfma_f32_16x16x32_bf16 v[100:103], v[68:71], a[128:131], v[100:103]
ds_read_b64_tr_b16 v[54:55], v25 offset:18432
v_mfma_f32_16x16x32_bf16 v[96:99], v[72:75], a[60:63], v[96:99]
ds_read_b64_tr_b16 v[56:57], v25 offset:20480
v_mfma_f32_16x16x32_bf16 v[100:103], v[72:75], a[132:135], v[100:103]
ds_read_b64_tr_b16 v[58:59], v25 offset:22528
buffer_load_dwordx4 v38, s[8:11], s34 offen offset:2048 lds
v_mfma_f32_16x16x32_bf16 v[96:99], v[76:79], a[64:67], v[96:99]
ds_read_b64_tr_b16 v[60:61], v25 offset:24576
v_mfma_f32_16x16x32_bf16 v[100:103], v[76:79], a[136:139], v[100:103]
ds_read_b64_tr_b16 v[62:63], v25 offset:26624
s_waitcnt lgkmcnt(8)
v_mfma_f32_16x16x32_bf16 v[96:99], v[80:83], a[68:71], v[96:99]
ds_read_b64_tr_b16 v[64:65], v25 offset:28672
v_mfma_f32_16x16x32_bf16 v[100:103], v[80:83], a[140:143], v[100:103]
ds_read_b64_tr_b16 v[66:67], v25 offset:30720
buffer_load_dwordx4 v39, s[8:11], s34 offen offset:3072 lds
v_mfma_f32_16x16x32_bf16 v[104:107], v[84:87], a[36:39], v[104:107]
ds_read_b64_tr_b16 v[68:69], v25 offset:32768
v_mfma_f32_16x16x32_bf16 v[108:111], v[84:87], a[108:111], v[108:111]
ds_read_b64_tr_b16 v[70:71], v25 offset:34816
v_mfma_f32_16x16x32_bf16 v[104:107], v[88:91], a[40:43], v[104:107]
ds_read_b64_tr_b16 v[72:73], v26 offset:0
s_add_u32 m0, s32, 4096
v_mfma_f32_16x16x32_bf16 v[108:111], v[88:91], a[112:115], v[108:111]
ds_read_b64_tr_b16 v[74:75], v26 offset:2048
v_mfma_f32_16x16x32_bf16 v[104:107], v[92:95], a[44:47], v[104:107]
ds_read_b64_tr_b16 v[76:77], v26 offset:4096
v_mfma_f32_16x16x32_bf16 v[108:111], v[92:95], a[116:119], v[108:111]
ds_read_b64_tr_b16 v[78:79], v26 offset:6144
s_waitcnt lgkmcnt(8)
v_mfma_f32_16x16x32_bf16 v[104:107], v[48:51], a[48:51], v[104:107]
ds_read_b64_tr_b16 v[80:81], v26 offset:8192
s_add_u32 s34, s28, 295040
v_mfma_f32_16x16x32_bf16 v[108:111], v[48:51], a[120:123], v[108:111]
ds_read_b64_tr_b16 v[82:83], v26 offset:10240
v_mfma_f32_16x16x32_bf16 v[104:107], v[52:55], a[52:55], v[104:107]
ds_read_b64_tr_b16 v[84:85], v26 offset:12288
v_mfma_f32_16x16x32_bf16 v[108:111], v[52:55], a[124:127], v[108:111]
ds_read_b64_tr_b16 v[86:87], v26 offset:14336
v_mfma_f32_16x16x32_bf16 v[104:107], v[56:59], a[56:59], v[104:107]
ds_read_b64_tr_b16 v[88:89], v26 offset:16384
buffer_load_dwordx4 v36, s[8:11], s34 offen offset:0 lds
v_mfma_f32_16x16x32_bf16 v[108:111], v[56:59], a[128:131], v[108:111]
ds_read_b64_tr_b16 v[90:91], v26 offset:18432
v_mfma_f32_16x16x32_bf16 v[104:107], v[60:63], a[60:63], v[104:107]
ds_read_b64_tr_b16 v[92:93], v26 offset:20480
v_mfma_f32_16x16x32_bf16 v[108:111], v[60:63], a[132:135], v[108:111]
ds_read_b64_tr_b16 v[94:95], v26 offset:22528
s_waitcnt lgkmcnt(8)
v_mfma_f32_16x16x32_bf16 v[104:107], v[64:67], a[64:67], v[104:107]
ds_read_b64_tr_b16 v[48:49], v26 offset:24576
buffer_load_dwordx4 v37, s[8:11], s34 offen offset:1024 lds
v_mfma_f32_16x16x32_bf16 v[108:111], v[64:67], a[136:139], v[108:111]
ds_read_b64_tr_b16 v[50:51], v26 offset:26624
v_mfma_f32_16x16x32_bf16 v[104:107], v[68:71], a[68:71], v[104:107]
ds_read_b64_tr_b16 v[52:53], v26 offset:28672
v_mfma_f32_16x16x32_bf16 v[108:111], v[68:71], a[140:143], v[108:111]
ds_read_b64_tr_b16 v[54:55], v26 offset:30720
buffer_load_dwordx4 v38, s[8:11], s34 offen offset:2048 lds
v_mfma_f32_16x16x32_bf16 v[112:115], v[72:75], a[36:39], v[112:115]
ds_read_b64_tr_b16 v[56:57], v26 offset:32768
v_mfma_f32_16x16x32_bf16 v[116:119], v[72:75], a[108:111], v[116:119]
ds_read_b64_tr_b16 v[58:59], v26 offset:34816
v_mfma_f32_16x16x32_bf16 v[112:115], v[76:79], a[40:43], v[112:115]
ds_read_b64_tr_b16 v[60:61], v27 offset:0
buffer_load_dwordx4 v39, s[8:11], s34 offen offset:3072 lds
v_mfma_f32_16x16x32_bf16 v[116:119], v[76:79], a[112:115], v[116:119]
ds_read_b64_tr_b16 v[62:63], v27 offset:2048
s_waitcnt lgkmcnt(8)
v_mfma_f32_16x16x32_bf16 v[112:115], v[80:83], a[44:47], v[112:115]
ds_read_b64_tr_b16 v[64:65], v27 offset:4096
v_mfma_f32_16x16x32_bf16 v[116:119], v[80:83], a[116:119], v[116:119]
ds_read_b64_tr_b16 v[66:67], v27 offset:6144
v_mfma_f32_16x16x32_bf16 v[112:115], v[84:87], a[48:51], v[112:115]
ds_read_b64_tr_b16 v[68:69], v27 offset:8192
s_add_u32 m0, s32, 8192
v_mfma_f32_16x16x32_bf16 v[116:119], v[84:87], a[120:123], v[116:119]
ds_read_b64_tr_b16 v[70:71], v27 offset:10240
v_mfma_f32_16x16x32_bf16 v[112:115], v[88:91], a[52:55], v[112:115]
ds_read_b64_tr_b16 v[72:73], v27 offset:12288
v_mfma_f32_16x16x32_bf16 v[116:119], v[88:91], a[124:127], v[116:119]
ds_read_b64_tr_b16 v[74:75], v27 offset:14336
s_add_u32 s34, s28, 589952
v_mfma_f32_16x16x32_bf16 v[112:115], v[92:95], a[56:59], v[112:115]
ds_read_b64_tr_b16 v[76:77], v27 offset:16384
v_mfma_f32_16x16x32_bf16 v[116:119], v[92:95], a[128:131], v[116:119]
ds_read_b64_tr_b16 v[78:79], v27 offset:18432
s_waitcnt lgkmcnt(8)
v_mfma_f32_16x16x32_bf16 v[112:115], v[48:51], a[60:63], v[112:115]
ds_read_b64_tr_b16 v[80:81], v27 offset:20480
v_mfma_f32_16x16x32_bf16 v[116:119], v[48:51], a[132:135], v[116:119]
ds_read_b64_tr_b16 v[82:83], v27 offset:22528
buffer_load_dwordx4 v36, s[8:11], s34 offen offset:0 lds
v_mfma_f32_16x16x32_bf16 v[112:115], v[52:55], a[64:67], v[112:115]
ds_read_b64_tr_b16 v[84:85], v27 offset:24576
v_mfma_f32_16x16x32_bf16 v[116:119], v[52:55], a[136:139], v[116:119]
ds_read_b64_tr_b16 v[86:87], v27 offset:26624
v_mfma_f32_16x16x32_bf16 v[112:115], v[56:59], a[68:71], v[112:115]
ds_read_b64_tr_b16 v[88:89], v27 offset:28672
v_mfma_f32_16x16x32_bf16 v[116:119], v[56:59], a[140:143], v[116:119]
ds_read_b64_tr_b16 v[90:91], v27 offset:30720
s_waitcnt vmcnt(9)
v_mfma_f32_16x16x32_bf16 v[120:123], v[60:63], a[36:39], v[120:123]
ds_read_b64_tr_b16 v[92:93], v27 offset:32768
s_barrier
v_mfma_f32_16x16x32_bf16 v[124:127], v[60:63], a[108:111], v[124:127]
ds_read_b64_tr_b16 v[94:95], v27 offset:34816
s_waitcnt lgkmcnt(8)
v_mfma_f32_16x16x32_bf16 v[120:123], v[64:67], a[40:43], v[120:123]
ds_read_b64_tr_b16 v[48:49], v28 offset:0
v_mfma_f32_16x16x32_bf16 v[124:127], v[64:67], a[112:115], v[124:127]
ds_read_b64_tr_b16 v[50:51], v28 offset:2048
v_mfma_f32_16x16x32_bf16 v[120:123], v[68:71], a[44:47], v[120:123]
ds_read_b64_tr_b16 v[52:53], v28 offset:4096
v_mfma_f32_16x16x32_bf16 v[124:127], v[68:71], a[116:119], v[124:127]
ds_read_b64_tr_b16 v[54:55], v28 offset:6144
v_mfma_f32_16x16x32_bf16 v[120:123], v[72:75], a[48:51], v[120:123]
ds_read_b64_tr_b16 v[56:57], v28 offset:8192
v_mfma_f32_16x16x32_bf16 v[124:127], v[72:75], a[120:123], v[124:127]
L_mlp_pad1:
s_cbranch_execz L_mlp_pad5
ds_read_b64_tr_b16 v[58:59], v28 offset:10240
v_mfma_f32_16x16x32_bf16 v[120:123], v[76:79], a[52:55], v[120:123]
ds_read_b64_tr_b16 v[60:61], v28 offset:12288
v_mfma_f32_16x16x32_bf16 v[124:127], v[76:79], a[124:127], v[124:127]
ds_read_b64_tr_b16 v[62:63], v28 offset:14336
s_waitcnt lgkmcnt(8)
v_mfma_f32_16x16x32_bf16 v[120:123], v[80:83], a[56:59], v[120:123]
ds_read_b64_tr_b16 v[64:65], v28 offset:16384
v_mfma_f32_16x16x32_bf16 v[124:127], v[80:83], a[128:131], v[124:127]
ds_read_b64_tr_b16 v[66:67], v28 offset:18432
v_mfma_f32_16x16x32_bf16 v[120:123], v[84:87], a[60:63], v[120:123]
ds_read_b64_tr_b16 v[68:69], v28 offset:20480
v_mfma_f32_16x16x32_bf16 v[124:127], v[84:87], a[132:135], v[124:127]
ds_read_b64_tr_b16 v[70:71], v28 offset:22528
v_mfma_f32_16x16x32_bf16 v[120:123], v[88:91], a[64:67], v[120:123]
ds_read_b64_tr_b16 v[72:73], v28 offset:24576
v_mfma_f32_16x16x32_bf16 v[124:127], v[88:91], a[136:139], v[124:127]
ds_read_b64_tr_b16 v[74:75], v28 offset:26624
v_mfma_f32_16x16x32_bf16 v[120:123], v[92:95], a[68:71], v[120:123]
ds_read_b64_tr_b16 v[76:77], v28 offset:28672
v_mfma_f32_16x16x32_bf16 v[124:127], v[92:95], a[140:143], v[124:127]
ds_read_b64_tr_b16 v[78:79], v28 offset:30720
s_waitcnt lgkmcnt(8)
v_mfma_f32_16x16x32_bf16 v[128:131], v[48:51], a[36:39], v[128:131]
ds_read_b64_tr_b16 v[80:81], v28 offset:32768
s_add_u32 m0, s32, 36864
v_mfma_f32_16x16x32_bf16 v[132:135], v[48:51], a[108:111], v[132:135]
ds_read_b64_tr_b16 v[82:83], v28 offset:34816
v_mfma_f32_16x16x32_bf16 v[128:131], v[52:55], a[40:43], v[128:131]
ds_read_b64_tr_b16 v[84:85], v29 offset:0
v_mfma_f32_16x16x32_bf16 v[132:135], v[52:55], a[112:115], v[132:135]
ds_read_b64_tr_b16 v[86:87], v29 offset:2048
s_add_u32 s34, s28, 128
v_mfma_f32_16x16x32_bf16 v[128:131], v[56:59], a[44:47], v[128:131]
ds_read_b64_tr_b16 v[88:89], v29 offset:4096
v_mfma_f32_16x16x32_bf16 v[132:135], v[56:59], a[116:119], v[132:135]
ds_read_b64_tr_b16 v[90:91], v29 offset:6144
v_mfma_f32_16x16x32_bf16 v[128:131], v[60:63], a[48:51], v[128:131]
ds_read_b64_tr_b16 v[92:93], v29 offset:8192
buffer_load_dwordx4 v36, s[12:15], s34 offen offset:0 lds
v_mfma_f32_16x16x32_bf16 v[132:135], v[60:63], a[120:123], v[132:135]
ds_read_b64_tr_b16 v[94:95], v29 offset:10240
s_waitcnt lgkmcnt(8)
v_mfma_f32_16x16x32_bf16 v[128:131], v[64:67], a[52:55], v[128:131]
ds_read_b64_tr_b16 v[48:49], v29 offset:12288
v_mfma_f32_16x16x32_bf16 v[132:135], v[64:67], a[124:127], v[132:135]
ds_read_b64_tr_b16 v[50:51], v29 offset:14336
v_mfma_f32_16x16x32_bf16 v[128:131], v[68:71], a[56:59], v[128:131]
ds_read_b64_tr_b16 v[52:53], v29 offset:16384
buffer_load_dwordx4 v37, s[12:15], s34 offen offset:1024 lds
v_mfma_f32_16x16x32_bf16 v[132:135], v[68:71], a[128:131], v[132:135]
ds_read_b64_tr_b16 v[54:55], v29 offset:18432
v_mfma_f32_16x16x32_bf16 v[128:131], v[72:75], a[60:63], v[128:131]
ds_read_b64_tr_b16 v[56:57], v29 offset:20480
v_mfma_f32_16x16x32_bf16 v[132:135], v[72:75], a[132:135], v[132:135]
ds_read_b64_tr_b16 v[58:59], v29 offset:22528
buffer_load_dwordx4 v38, s[12:15], s34 offen offset:2048 lds
v_mfma_f32_16x16x32_bf16 v[128:131], v[76:79], a[64:67], v[128:131]
ds_read_b64_tr_b16 v[60:61], v29 offset:24576
v_mfma_f32_16x16x32_bf16 v[132:135], v[76:79], a[136:139], v[132:135]
ds_read_b64_tr_b16 v[62:63], v29 offset:26624
s_waitcnt lgkmcnt(8)
v_mfma_f32_16x16x32_bf16 v[128:131], v[80:83], a[68:71], v[128:131]
ds_read_b64_tr_b16 v[64:65], v29 offset:28672
v_mfma_f32_16x16x32_bf16 v[132:135], v[80:83], a[140:143], v[132:135]
ds_read_b64_tr_b16 v[66:67], v29 offset:30720
buffer_load_dwordx4 v39, s[12:15], s34 offen offset:3072 lds
v_mfma_f32_16x16x32_bf16 v[136:139], v[84:87], a[36:39], v[136:139]
ds_read_b64_tr_b16 v[68:69], v29 offset:32768
v_mfma_f32_16x16x32_bf16 v[140:143], v[84:87], a[108:111], v[140:143]
ds_read_b64_tr_b16 v[70:71], v29 offset:34816
v_mfma_f32_16x16x32_bf16 v[136:139], v[88:91], a[40:43], v[136:139]
ds_read_b64_tr_b16 v[72:73], v30 offset:0
s_add_u32 m0, s32, 40960
v_mfma_f32_16x16x32_bf16 v[140:143], v[88:91], a[112:115], v[140:143]
ds_read_b64_tr_b16 v[74:75], v30 offset:2048
v_mfma_f32_16x16x32_bf16 v[136:139], v[92:95], a[44:47], v[136:139]
ds_read_b64_tr_b16 v[76:77], v30 offset:4096
v_mul_f32 v96, v96, v128
v_mfma_f32_16x16x32_bf16 v[140:143], v[92:95], a[116:119], v[140:143]
ds_read_b64_tr_b16 v[78:79], v30 offset:6144
s_waitcnt lgkmcnt(8)
v_mfma_f32_16x16x32_bf16 v[136:139], v[48:51], a[48:51], v[136:139]
ds_read_b64_tr_b16 v[80:81], v30 offset:8192
s_add_u32 s34, s28, 295040
v_mfma_f32_16x16x32_bf16 v[140:143], v[48:51], a[120:123], v[140:143]
ds_read_b64_tr_b16 v[82:83], v30 offset:10240
v_mul_f32 v97, v97, v129
v_mfma_f32_16x16x32_bf16 v[136:139], v[52:55], a[52:55], v[136:139]
ds_read_b64_tr_b16 v[84:85], v30 offset:12288
v_mul_f32 v98, v98, v130
v_mfma_f32_16x16x32_bf16 v[140:143], v[52:55], a[124:127], v[140:143]
ds_read_b64_tr_b16 v[86:87], v30 offset:14336
v_mul_f32 v99, v99, v131
v_mfma_f32_16x16x32_bf16 v[136:139], v[56:59], a[56:59], v[136:139]
ds_read_b64_tr_b16 v[88:89], v30 offset:16384
buffer_load_dwordx4 v36, s[12:15], s34 offen offset:0 lds
v_mfma_f32_16x16x32_bf16 v[140:143], v[56:59], a[128:131], v[140:143]
ds_read_b64_tr_b16 v[90:91], v30 offset:18432
v_cvt_pk_bf16_f32 v160, v96, v97
v_mfma_f32_16x16x32_bf16 v[136:139], v[60:63], a[60:63], v[136:139]
ds_read_b64_tr_b16 v[92:93], v30 offset:20480
v_cvt_pk_bf16_f32 v161, v98, v99
v_mfma_f32_16x16x32_bf16 v[140:143], v[60:63], a[132:135], v[140:143]
ds_read_b64_tr_b16 v[94:95], v30 offset:22528
s_waitcnt lgkmcnt(8)
v_mfma_f32_16x16x32_bf16 v[136:139], v[64:67], a[64:67], v[136:139]
ds_read_b64_tr_b16 v[48:49], v30 offset:24576
buffer_load_dwordx4 v37, s[12:15], s34 offen offset:1024 lds
v_mfma_f32_16x16x32_bf16 v[140:143], v[64:67], a[136:139], v[140:143]
ds_read_b64_tr_b16 v[50:51], v30 offset:26624
v_mul_f32 v100, v100, v132
v_mfma_f32_16x16x32_bf16 v[136:139], v[68:71], a[68:71], v[136:139]
ds_read_b64_tr_b16 v[52:53], v30 offset:28672
v_mul_f32 v101, v101, v133
v_mfma_f32_16x16x32_bf16 v[140:143], v[68:71], a[140:143], v[140:143]
ds_read_b64_tr_b16 v[54:55], v30 offset:30720
buffer_load_dwordx4 v38, s[12:15], s34 offen offset:2048 lds
v_mfma_f32_16x16x32_bf16 v[144:147], v[72:75], a[36:39], v[144:147]
ds_read_b64_tr_b16 v[56:57], v30 offset:32768
v_mul_f32 v102, v102, v134
v_mfma_f32_16x16x32_bf16 v[148:151], v[72:75], a[108:111], v[148:151]
ds_read_b64_tr_b16 v[58:59], v30 offset:34816
v_mul_f32 v103, v103, v135
v_mfma_f32_16x16x32_bf16 v[144:147], v[76:79], a[40:43], v[144:147]
ds_read_b64_tr_b16 v[60:61], v31 offset:0
buffer_load_dwordx4 v39, s[12:15], s34 offen offset:3072 lds
v_mfma_f32_16x16x32_bf16 v[148:151], v[76:79], a[112:115], v[148:151]
ds_read_b64_tr_b16 v[62:63], v31 offset:2048
s_waitcnt lgkmcnt(8)
v_mfma_f32_16x16x32_bf16 v[144:147], v[80:83], a[44:47], v[144:147]
ds_read_b64_tr_b16 v[64:65], v31 offset:4096
v_cvt_pk_bf16_f32 v164, v100, v101
v_mfma_f32_16x16x32_bf16 v[148:151], v[80:83], a[116:119], v[148:151]
ds_read_b64_tr_b16 v[66:67], v31 offset:6144
v_cvt_pk_bf16_f32 v165, v102, v103
v_mfma_f32_16x16x32_bf16 v[144:147], v[84:87], a[48:51], v[144:147]
ds_read_b64_tr_b16 v[68:69], v31 offset:8192
s_add_u32 m0, s32, 45056
v_mfma_f32_16x16x32_bf16 v[148:151], v[84:87], a[120:123], v[148:151]
ds_read_b64_tr_b16 v[70:71], v31 offset:10240
v_mul_f32 v104, v104, v136
v_mfma_f32_16x16x32_bf16 v[144:147], v[88:91], a[52:55], v[144:147]
ds_read_b64_tr_b16 v[72:73], v31 offset:12288
v_mul_f32 v105, v105, v137
v_mfma_f32_16x16x32_bf16 v[148:151], v[88:91], a[124:127], v[148:151]
ds_read_b64_tr_b16 v[74:75], v31 offset:14336
s_add_u32 s34, s28, 589952
v_mfma_f32_16x16x32_bf16 v[144:147], v[92:95], a[56:59], v[144:147]
ds_read_b64_tr_b16 v[76:77], v31 offset:16384
v_mul_f32 v106, v106, v138
v_mfma_f32_16x16x32_bf16 v[148:151], v[92:95], a[128:131], v[148:151]
ds_read_b64_tr_b16 v[78:79], v31 offset:18432
s_waitcnt lgkmcnt(8)
v_mfma_f32_16x16x32_bf16 v[144:147], v[48:51], a[60:63], v[144:147]
ds_read_b64_tr_b16 v[80:81], v31 offset:20480
v_mul_f32 v107, v107, v139
v_mfma_f32_16x16x32_bf16 v[148:151], v[48:51], a[132:135], v[148:151]
ds_read_b64_tr_b16 v[82:83], v31 offset:22528
buffer_load_dwordx4 v36, s[12:15], s34 offen offset:0 lds
v_mfma_f32_16x16x32_bf16 v[144:147], v[52:55], a[64:67], v[144:147]
ds_read_b64_tr_b16 v[84:85], v31 offset:24576
v_cvt_pk_bf16_f32 v162, v104, v105
v_mfma_f32_16x16x32_bf16 v[148:151], v[52:55], a[136:139], v[148:151]
ds_read_b64_tr_b16 v[86:87], v31 offset:26624
v_cvt_pk_bf16_f32 v163, v106, v107
v_mfma_f32_16x16x32_bf16 v[144:147], v[56:59], a[68:71], v[144:147]
ds_read_b64_tr_b16 v[88:89], v31 offset:28672
v_mul_f32 v108, v108, v140
v_mfma_f32_16x16x32_bf16 v[148:151], v[56:59], a[140:143], v[148:151]
ds_read_b64_tr_b16 v[90:91], v31 offset:30720
s_waitcnt vmcnt(9)
v_mfma_f32_16x16x32_bf16 v[152:155], v[60:63], a[36:39], v[152:155]
ds_read_b64_tr_b16 v[92:93], v31 offset:32768
s_barrier
v_mfma_f32_16x16x32_bf16 v[156:159], v[60:63], a[108:111], v[156:159]
ds_read_b64_tr_b16 v[94:95], v31 offset:34816
s_waitcnt lgkmcnt(8)
v_mfma_f32_16x16x32_bf16 v[152:155], v[64:67], a[40:43], v[152:155]
ds_read_b64_tr_b16 v[48:49], v16 offset:0
v_mul_f32 v109, v109, v141
v_mfma_f32_16x16x32_bf16 v[156:159], v[64:67], a[112:115], v[156:159]
ds_read_b64_tr_b16 v[50:51], v16 offset:2048
v_mul_f32 v110, v110, v142
v_mfma_f32_16x16x32_bf16 v[152:155], v[68:71], a[44:47], v[152:155]
ds_read_b64_tr_b16 v[52:53], v16 offset:4096
v_mul_f32 v111, v111, v143
v_mfma_f32_16x16x32_bf16 v[156:159], v[68:71], a[116:119], v[156:159]
ds_read_b64_tr_b16 v[54:55], v16 offset:6144
v_cvt_pk_bf16_f32 v166, v108, v109
v_mfma_f32_16x16x32_bf16 v[152:155], v[72:75], a[48:51], v[152:155]
ds_read_b64_tr_b16 v[56:57], v16 offset:8192
v_cvt_pk_bf16_f32 v167, v110, v111
v_mfma_f32_16x16x32_bf16 v[156:159], v[72:75], a[120:123], v[156:159]
ds_read_b64_tr_b16 v[58:59], v16 offset:10240
v_mul_f32 v112, v112, v144
v_mfma_f32_16x16x32_bf16 v[152:155], v[76:79], a[52:55], v[152:155]
ds_read_b64_tr_b16 v[60:61], v16 offset:12288
v_mul_f32 v113, v113, v145
v_mfma_f32_16x16x32_bf16 v[156:159], v[76:79], a[124:127], v[156:159]
ds_read_b64_tr_b16 v[62:63], v16 offset:14336
s_waitcnt lgkmcnt(8)
v_mfma_f32_16x16x32_bf16 v[152:155], v[80:83], a[56:59], v[152:155]
ds_read_b64_tr_b16 v[64:65], v16 offset:16384
v_mul_f32 v114, v114, v146
v_mfma_f32_16x16x32_bf16 v[156:159], v[80:83], a[128:131], v[156:159]
ds_read_b64_tr_b16 v[66:67], v16 offset:18432
v_mul_f32 v115, v115, v147
v_mfma_f32_16x16x32_bf16 v[152:155], v[84:87], a[60:63], v[152:155]
ds_read_b64_tr_b16 v[68:69], v16 offset:20480
v_cvt_pk_bf16_f32 v168, v112, v113
v_mfma_f32_16x16x32_bf16 v[156:159], v[84:87], a[132:135], v[156:159]
ds_read_b64_tr_b16 v[70:71], v16 offset:22528
v_cvt_pk_bf16_f32 v169, v114, v115
v_mfma_f32_16x16x32_bf16 v[152:155], v[88:91], a[64:67], v[152:155]
ds_read_b64_tr_b16 v[72:73], v16 offset:24576
v_mul_f32 v116, v116, v148
v_mfma_f32_16x16x32_bf16 v[156:159], v[88:91], a[136:139], v[156:159]
ds_read_b64_tr_b16 v[74:75], v16 offset:26624
v_mul_f32 v117, v117, v149
v_mfma_f32_16x16x32_bf16 v[152:155], v[92:95], a[68:71], v[152:155]
ds_read_b64_tr_b16 v[76:77], v16 offset:28672
v_mul_f32 v118, v118, v150
v_mfma_f32_16x16x32_bf16 v[156:159], v[92:95], a[140:143], v[156:159]
ds_read_b64_tr_b16 v[78:79], v16 offset:30720
s_waitcnt lgkmcnt(8)
v_mfma_f32_16x16x32_bf16 v[96:99], v[48:51], a[0:3], 0
ds_read_b64_tr_b16 v[80:81], v16 offset:32768
v_mul_f32 v119, v119, v151
v_mfma_f32_16x16x32_bf16 v[100:103], v[48:51], a[72:75], 0
ds_read_b64_tr_b16 v[82:83], v16 offset:34816
v_cvt_pk_bf16_f32 v172, v116, v117
v_mfma_f32_16x16x32_bf16 v[96:99], v[52:55], a[4:7], v[96:99]
ds_read_b64_tr_b16 v[84:85], v17 offset:0
v_cvt_pk_bf16_f32 v173, v118, v119
v_mfma_f32_16x16x32_bf16 v[100:103], v[52:55], a[76:79], v[100:103]
ds_read_b64_tr_b16 v[86:87], v17 offset:2048
s_add_u32 m0, s32, 73728
v_mfma_f32_16x16x32_bf16 v[96:99], v[56:59], a[8:11], v[96:99]
ds_read_b64_tr_b16 v[88:89], v17 offset:4096
v_mul_f32 v120, v120, v152
v_mfma_f32_16x16x32_bf16 v[100:103], v[56:59], a[80:83], v[100:103]
ds_read_b64_tr_b16 v[90:91], v17 offset:6144
v_mul_f32 v121, v121, v153
v_mfma_f32_16x16x32_bf16 v[96:99], v[60:63], a[12:15], v[96:99]
ds_read_b64_tr_b16 v[92:93], v17 offset:8192
v_mul_f32 v122, v122, v154
v_mfma_f32_16x16x32_bf16 v[100:103], v[60:63], a[84:87], v[100:103]
ds_read_b64_tr_b16 v[94:95], v17 offset:10240
s_waitcnt lgkmcnt(8)
v_mfma_f32_16x16x32_bf16 v[96:99], v[64:67], a[16:19], v[96:99]
ds_read_b64_tr_b16 v[48:49], v17 offset:12288
v_mul_f32 v123, v123, v155
v_mfma_f32_16x16x32_bf16 v[100:103], v[64:67], a[88:91], v[100:103]
ds_read_b64_tr_b16 v[50:51], v17 offset:14336
v_cvt_pk_bf16_f32 v170, v120, v121
v_mfma_f32_16x16x32_bf16 v[96:99], v[68:71], a[20:23], v[96:99]
ds_read_b64_tr_b16 v[52:53], v17 offset:16384
v_cvt_pk_bf16_f32 v171, v122, v123
v_mfma_f32_16x16x32_bf16 v[100:103], v[68:71], a[92:95], v[100:103]
ds_read_b64_tr_b16 v[54:55], v17 offset:18432
v_mul_f32 v124, v124, v156
v_mfma_f32_16x16x32_bf16 v[96:99], v[72:75], a[24:27], v[96:99]
ds_read_b64_tr_b16 v[56:57], v17 offset:20480
v_mul_f32 v125, v125, v157
v_mfma_f32_16x16x32_bf16 v[100:103], v[72:75], a[96:99], v[100:103]
ds_read_b64_tr_b16 v[58:59], v17 offset:22528
v_mul_f32 v126, v126, v158
v_mfma_f32_16x16x32_bf16 v[96:99], v[76:79], a[28:31], v[96:99]
ds_read_b64_tr_b16 v[60:61], v17 offset:24576
v_mul_f32 v127, v127, v159
v_mfma_f32_16x16x32_bf16 v[100:103], v[76:79], a[100:103], v[100:103]
ds_read_b64_tr_b16 v[62:63], v17 offset:26624
s_waitcnt lgkmcnt(8)
v_mfma_f32_16x16x32_bf16 v[96:99], v[80:83], a[32:35], v[96:99]
ds_read_b64_tr_b16 v[64:65], v17 offset:28672
v_cvt_pk_bf16_f32 v174, v124, v125
v_mfma_f32_16x16x32_bf16 v[100:103], v[80:83], a[104:107], v[100:103]
ds_read_b64_tr_b16 v[66:67], v17 offset:30720
v_cvt_pk_bf16_f32 v175, v126, v127
v_mfma_f32_16x16x32_bf16 v[104:107], v[84:87], a[0:3], 0
ds_read_b64_tr_b16 v[68:69], v17 offset:32768
v_mfma_f32_16x16x32_bf16 v[108:111], v[84:87], a[72:75], 0
ds_read_b64_tr_b16 v[70:71], v17 offset:34816
s_add_u32 s34, s28, 2654336
v_mfma_f32_16x16x32_bf16 v[104:107], v[88:91], a[4:7], v[104:107]
ds_read_b64_tr_b16 v[72:73], v18 offset:0
v_mfma_f32_16x16x32_bf16 v[108:111], v[88:91], a[76:79], v[108:111]
ds_read_b64_tr_b16 v[74:75], v18 offset:2048
buffer_load_dwordx4 v36, s[8:11], s34 offen offset:0 lds
v_mfma_f32_16x16x32_bf16 v[104:107], v[92:95], a[8:11], v[104:107]
ds_read_b64_tr_b16 v[76:77], v18 offset:4096
v_mfma_f32_16x16x32_bf16 v[108:111], v[92:95], a[80:83], v[108:111]
ds_read_b64_tr_b16 v[78:79], v18 offset:6144
s_waitcnt lgkmcnt(8)
v_mfma_f32_16x16x32_bf16 v[104:107], v[48:51], a[12:15], v[104:107]
ds_read_b64_tr_b16 v[80:81], v18 offset:8192
buffer_load_dwordx4 v37, s[8:11], s34 offen offset:1024 lds
v_mfma_f32_16x16x32_bf16 v[108:111], v[48:51], a[84:87], v[108:111]
ds_read_b64_tr_b16 v[82:83], v18 offset:10240
v_mfma_f32_16x16x32_bf16 v[104:107], v[52:55], a[16:19], v[104:107]
ds_read_b64_tr_b16 v[84:85], v18 offset:12288
buffer_load_dwordx4 v38, s[8:11], s34 offen offset:2048 lds
v_mfma_f32_16x16x32_bf16 v[108:111], v[52:55], a[88:91], v[108:111]
ds_read_b64_tr_b16 v[86:87], v18 offset:14336
v_mfma_f32_16x16x32_bf16 v[104:107], v[56:59], a[20:23], v[104:107]
ds_read_b64_tr_b16 v[88:89], v18 offset:16384
buffer_load_dwordx4 v39, s[8:11], s34 offen offset:3072 lds
v_mfma_f32_16x16x32_bf16 v[108:111], v[56:59], a[92:95], v[108:111]
ds_read_b64_tr_b16 v[90:91], v18 offset:18432
v_mfma_f32_16x16x32_bf16 v[104:107], v[60:63], a[24:27], v[104:107]
ds_read_b64_tr_b16 v[92:93], v18 offset:20480
s_add_u32 m0, s32, 77824
v_mfma_f32_16x16x32_bf16 v[108:111], v[60:63], a[96:99], v[108:111]
ds_read_b64_tr_b16 v[94:95], v18 offset:22528
s_waitcnt lgkmcnt(8)
v_mfma_f32_16x16x32_bf16 v[104:107], v[64:67], a[28:31], v[104:107]
ds_read_b64_tr_b16 v[48:49], v18 offset:24576
v_mfma_f32_16x16x32_bf16 v[108:111], v[64:67], a[100:103], v[108:111]
ds_read_b64_tr_b16 v[50:51], v18 offset:26624
s_add_u32 s34, s28, 2949248
v_mfma_f32_16x16x32_bf16 v[104:107], v[68:71], a[32:35], v[104:107]
ds_read_b64_tr_b16 v[52:53], v18 offset:28672
v_mfma_f32_16x16x32_bf16 v[108:111], v[68:71], a[104:107], v[108:111]
ds_read_b64_tr_b16 v[54:55], v18 offset:30720
v_mfma_f32_16x16x32_bf16 v[112:115], v[72:75], a[0:3], 0
ds_read_b64_tr_b16 v[56:57], v18 offset:32768
buffer_load_dwordx4 v36, s[8:11], s34 offen offset:0 lds
v_mfma_f32_16x16x32_bf16 v[116:119], v[72:75], a[72:75], 0
ds_read_b64_tr_b16 v[58:59], v18 offset:34816
v_mfma_f32_16x16x32_bf16 v[112:115], v[76:79], a[4:7], v[112:115]
ds_read_b64_tr_b16 v[60:61], v19 offset:0
buffer_load_dwordx4 v37, s[8:11], s34 offen offset:1024 lds
v_mfma_f32_16x16x32_bf16 v[116:119], v[76:79], a[76:79], v[116:119]
ds_read_b64_tr_b16 v[62:63], v19 offset:2048
s_waitcnt lgkmcnt(8)
v_mfma_f32_16x16x32_bf16 v[112:115], v[80:83], a[8:11], v[112:115]
ds_read_b64_tr_b16 v[64:65], v19 offset:4096
v_mfma_f32_16x16x32_bf16 v[116:119], v[80:83], a[80:83], v[116:119]
ds_read_b64_tr_b16 v[66:67], v19 offset:6144
buffer_load_dwordx4 v38, s[8:11], s34 offen offset:2048 lds
v_mfma_f32_16x16x32_bf16 v[112:115], v[84:87], a[12:15], v[112:115]
ds_read_b64_tr_b16 v[68:69], v19 offset:8192
v_mfma_f32_16x16x32_bf16 v[116:119], v[84:87], a[84:87], v[116:119]
ds_read_b64_tr_b16 v[70:71], v19 offset:10240
buffer_load_dwordx4 v39, s[8:11], s34 offen offset:3072 lds
v_mfma_f32_16x16x32_bf16 v[112:115], v[88:91], a[16:19], v[112:115]
ds_read_b64_tr_b16 v[72:73], v19 offset:12288
v_mfma_f32_16x16x32_bf16 v[116:119], v[88:91], a[88:91], v[116:119]
ds_read_b64_tr_b16 v[74:75], v19 offset:14336
s_add_u32 m0, s32, 81920
v_mfma_f32_16x16x32_bf16 v[112:115], v[92:95], a[20:23], v[112:115]
ds_read_b64_tr_b16 v[76:77], v19 offset:16384
v_mfma_f32_16x16x32_bf16 v[116:119], v[92:95], a[92:95], v[116:119]
ds_read_b64_tr_b16 v[78:79], v19 offset:18432
s_waitcnt lgkmcnt(8)
v_mfma_f32_16x16x32_bf16 v[112:115], v[48:51], a[24:27], v[112:115]
ds_read_b64_tr_b16 v[80:81], v19 offset:20480
s_add_u32 s34, s28, 3244160
v_mfma_f32_16x16x32_bf16 v[116:119], v[48:51], a[96:99], v[116:119]
ds_read_b64_tr_b16 v[82:83], v19 offset:22528
v_mfma_f32_16x16x32_bf16 v[112:115], v[52:55], a[28:31], v[112:115]
ds_read_b64_tr_b16 v[84:85], v19 offset:24576
buffer_load_dwordx4 v36, s[8:11], s34 offen offset:0 lds
v_mfma_f32_16x16x32_bf16 v[116:119], v[52:55], a[100:103], v[116:119]
ds_read_b64_tr_b16 v[86:87], v19 offset:26624
v_mfma_f32_16x16x32_bf16 v[112:115], v[56:59], a[32:35], v[112:115]
ds_read_b64_tr_b16 v[88:89], v19 offset:28672
v_mfma_f32_16x16x32_bf16 v[116:119], v[56:59], a[104:107], v[116:119]
ds_read_b64_tr_b16 v[90:91], v19 offset:30720
s_waitcnt vmcnt(9)
v_mfma_f32_16x16x32_bf16 v[120:123], v[60:63], a[0:3], 0
ds_read_b64_tr_b16 v[92:93], v19 offset:32768
s_barrier
v_mfma_f32_16x16x32_bf16 v[124:127], v[60:63], a[72:75], 0
ds_read_b64_tr_b16 v[94:95], v19 offset:34816
s_waitcnt lgkmcnt(8)
v_mfma_f32_16x16x32_bf16 v[120:123], v[64:67], a[4:7], v[120:123]
ds_read_b64_tr_b16 v[48:49], v20 offset:0
v_mfma_f32_16x16x32_bf16 v[124:127], v[64:67], a[76:79], v[124:127]
ds_read_b64_tr_b16 v[50:51], v20 offset:2048
v_mfma_f32_16x16x32_bf16 v[120:123], v[68:71], a[8:11], v[120:123]
ds_read_b64_tr_b16 v[52:53], v20 offset:4096
v_mfma_f32_16x16x32_bf16 v[124:127], v[68:71], a[80:83], v[124:127]
ds_read_b64_tr_b16 v[54:55], v20 offset:6144
v_mfma_f32_16x16x32_bf16 v[120:123], v[72:75], a[12:15], v[120:123]
ds_read_b64_tr_b16 v[56:57], v20 offset:8192
v_mfma_f32_16x16x32_bf16 v[124:127], v[72:75], a[84:87], v[124:127]
ds_read_b64_tr_b16 v[58:59], v20 offset:10240
v_mfma_f32_16x16x32_bf16 v[120:123], v[76:79], a[16:19], v[120:123]
ds_read_b64_tr_b16 v[60:61], v20 offset:12288
v_mfma_f32_16x16x32_bf16 v[124:127], v[76:79], a[88:91], v[124:127]
ds_read_b64_tr_b16 v[62:63], v20 offset:14336
s_waitcnt lgkmcnt(8)
v_mfma_f32_16x16x32_bf16 v[120:123], v[80:83], a[20:23], v[120:123]
ds_read_b64_tr_b16 v[64:65], v20 offset:16384
v_mfma_f32_16x16x32_bf16 v[124:127], v[80:83], a[92:95], v[124:127]
ds_read_b64_tr_b16 v[66:67], v20 offset:18432
v_mfma_f32_16x16x32_bf16 v[120:123], v[84:87], a[24:27], v[120:123]
ds_read_b64_tr_b16 v[68:69], v20 offset:20480
v_mfma_f32_16x16x32_bf16 v[124:127], v[84:87], a[96:99], v[124:127]
ds_read_b64_tr_b16 v[70:71], v20 offset:22528
v_mfma_f32_16x16x32_bf16 v[120:123], v[88:91], a[28:31], v[120:123]
ds_read_b64_tr_b16 v[72:73], v20 offset:24576
v_mfma_f32_16x16x32_bf16 v[124:127], v[88:91], a[100:103], v[124:127]
ds_read_b64_tr_b16 v[74:75], v20 offset:26624
v_mfma_f32_16x16x32_bf16 v[120:123], v[92:95], a[32:35], v[120:123]
ds_read_b64_tr_b16 v[76:77], v20 offset:28672
v_mfma_f32_16x16x32_bf16 v[124:127], v[92:95], a[104:107], v[124:127]
ds_read_b64_tr_b16 v[78:79], v20 offset:30720
s_waitcnt lgkmcnt(8)
v_mfma_f32_16x16x32_bf16 v[128:131], v[48:51], a[0:3], 0
ds_read_b64_tr_b16 v[80:81], v20 offset:32768
s_add_u32 m0, s32, 110592
v_mfma_f32_16x16x32_bf16 v[132:135], v[48:51], a[72:75], 0
ds_read_b64_tr_b16 v[82:83], v20 offset:34816
v_mfma_f32_16x16x32_bf16 v[128:131], v[52:55], a[4:7], v[128:131]
ds_read_b64_tr_b16 v[84:85], v21 offset:0
v_mfma_f32_16x16x32_bf16 v[132:135], v[52:55], a[76:79], v[132:135]
ds_read_b64_tr_b16 v[86:87], v21 offset:2048
s_add_u32 s34, s28, 2654336
v_mfma_f32_16x16x32_bf16 v[128:131], v[56:59], a[8:11], v[128:131]
ds_read_b64_tr_b16 v[88:89], v21 offset:4096
v_mfma_f32_16x16x32_bf16 v[132:135], v[56:59], a[80:83], v[132:135]
ds_read_b64_tr_b16 v[90:91], v21 offset:6144
v_mfma_f32_16x16x32_bf16 v[128:131], v[60:63], a[12:15], v[128:131]
ds_read_b64_tr_b16 v[92:93], v21 offset:8192
buffer_load_dwordx4 v36, s[12:15], s34 offen offset:0 lds
v_mfma_f32_16x16x32_bf16 v[132:135], v[60:63], a[84:87], v[132:135]
ds_read_b64_tr_b16 v[94:95], v21 offset:10240
s_waitcnt lgkmcnt(8)
v_mfma_f32_16x16x32_bf16 v[128:131], v[64:67], a[16:19], v[128:131]
ds_read_b64_tr_b16 v[48:49], v21 offset:12288
v_mfma_f32_16x16x32_bf16 v[132:135], v[64:67], a[88:91], v[132:135]
ds_read_b64_tr_b16 v[50:51], v21 offset:14336
v_mfma_f32_16x16x32_bf16 v[128:131], v[68:71], a[20:23], v[128:131]
ds_read_b64_tr_b16 v[52:53], v21 offset:16384
buffer_load_dwordx4 v37, s[12:15], s34 offen offset:1024 lds
v_mfma_f32_16x16x32_bf16 v[132:135], v[68:71], a[92:95], v[132:135]
ds_read_b64_tr_b16 v[54:55], v21 offset:18432
v_mfma_f32_16x16x32_bf16 v[128:131], v[72:75], a[24:27], v[128:131]
ds_read_b64_tr_b16 v[56:57], v21 offset:20480
v_mfma_f32_16x16x32_bf16 v[132:135], v[72:75], a[96:99], v[132:135]
ds_read_b64_tr_b16 v[58:59], v21 offset:22528
buffer_load_dwordx4 v38, s[12:15], s34 offen offset:2048 lds
v_mfma_f32_16x16x32_bf16 v[128:131], v[76:79], a[28:31], v[128:131]
ds_read_b64_tr_b16 v[60:61], v21 offset:24576
v_mfma_f32_16x16x32_bf16 v[132:135], v[76:79], a[100:103], v[132:135]
ds_read_b64_tr_b16 v[62:63], v21 offset:26624
s_waitcnt lgkmcnt(8)
v_mfma_f32_16x16x32_bf16 v[128:131], v[80:83], a[32:35], v[128:131]
ds_read_b64_tr_b16 v[64:65], v21 offset:28672
v_mfma_f32_16x16x32_bf16 v[132:135], v[80:83], a[104:107], v[132:135]
ds_read_b64_tr_b16 v[66:67], v21 offset:30720
buffer_load_dwordx4 v39, s[12:15], s34 offen offset:3072 lds
v_mfma_f32_16x16x32_bf16 v[136:139], v[84:87], a[0:3], 0
ds_read_b64_tr_b16 v[68:69], v21 offset:32768
v_mfma_f32_16x16x32_bf16 v[140:143], v[84:87], a[72:75], 0
ds_read_b64_tr_b16 v[70:71], v21 offset:34816
v_mfma_f32_16x16x32_bf16 v[136:139], v[88:91], a[4:7], v[136:139]
ds_read_b64_tr_b16 v[72:73], v22 offset:0
s_add_u32 m0, s32, 114688
v_mfma_f32_16x16x32_bf16 v[140:143], v[88:91], a[76:79], v[140:143]
ds_read_b64_tr_b16 v[74:75], v22 offset:2048
v_mfma_f32_16x16x32_bf16 v[136:139], v[92:95], a[8:11], v[136:139]
ds_read_b64_tr_b16 v[76:77], v22 offset:4096
v_mfma_f32_16x16x32_bf16 v[140:143], v[92:95], a[80:83], v[140:143]
ds_read_b64_tr_b16 v[78:79], v22 offset:6144
s_waitcnt lgkmcnt(8)
v_mfma_f32_16x16x32_bf16 v[136:139], v[48:51], a[12:15], v[136:139]
ds_read_b64_tr_b16 v[80:81], v22 offset:8192
s_add_u32 s34, s28, 2949248
v_mfma_f32_16x16x32_bf16 v[140:143], v[48:51], a[84:87], v[140:143]
ds_read_b64_tr_b16 v[82:83], v22 offset:10240
v_mfma_f32_16x16x32_bf16 v[136:139], v[52:55], a[16:19], v[136:139]
ds_read_b64_tr_b16 v[84:85], v22 offset:12288
v_mfma_f32_16x16x32_bf16 v[140:143], v[52:55], a[88:91], v[140:143]
ds_read_b64_tr_b16 v[86:87], v22 offset:14336
v_mfma_f32_16x16x32_bf16 v[136:139], v[56:59], a[20:23], v[136:139]
ds_read_b64_tr_b16 v[88:89], v22 offset:16384
buffer_load_dwordx4 v36, s[12:15], s34 offen offset:0 lds
v_mfma_f32_16x16x32_bf16 v[140:143], v[56:59], a[92:95], v[140:143]
ds_read_b64_tr_b16 v[90:91], v22 offset:18432
v_mfma_f32_16x16x32_bf16 v[136:139], v[60:63], a[24:27], v[136:139]
ds_read_b64_tr_b16 v[92:93], v22 offset:20480
v_mfma_f32_16x16x32_bf16 v[140:143], v[60:63], a[96:99], v[140:143]
ds_read_b64_tr_b16 v[94:95], v22 offset:22528
s_waitcnt lgkmcnt(8)
v_mfma_f32_16x16x32_bf16 v[136:139], v[64:67], a[28:31], v[136:139]
ds_read_b64_tr_b16 v[48:49], v22 offset:24576
buffer_load_dwordx4 v37, s[12:15], s34 offen offset:1024 lds
v_mfma_f32_16x16x32_bf16 v[140:143], v[64:67], a[100:103], v[140:143]
ds_read_b64_tr_b16 v[50:51], v22 offset:26624
v_mfma_f32_16x16x32_bf16 v[136:139], v[68:71], a[32:35], v[136:139]
ds_read_b64_tr_b16 v[52:53], v22 offset:28672
v_mfma_f32_16x16x32_bf16 v[140:143], v[68:71], a[104:107], v[140:143]
ds_read_b64_tr_b16 v[54:55], v22 offset:30720
buffer_load_dwordx4 v38, s[12:15], s34 offen offset:2048 lds
v_mfma_f32_16x16x32_bf16 v[144:147], v[72:75], a[0:3], 0
ds_read_b64_tr_b16 v[56:57], v22 offset:32768
v_mfma_f32_16x16x32_bf16 v[148:151], v[72:75], a[72:75], 0
ds_read_b64_tr_b16 v[58:59], v22 offset:34816
v_mfma_f32_16x16x32_bf16 v[144:147], v[76:79], a[4:7], v[144:147]
ds_read_b64_tr_b16 v[60:61], v23 offset:0
buffer_load_dwordx4 v39, s[12:15], s34 offen offset:3072 lds
v_mfma_f32_16x16x32_bf16 v[148:151], v[76:79], a[76:79], v[148:151]
ds_read_b64_tr_b16 v[62:63], v23 offset:2048
s_waitcnt lgkmcnt(8)
v_mfma_f32_16x16x32_bf16 v[144:147], v[80:83], a[8:11], v[144:147]
ds_read_b64_tr_b16 v[64:65], v23 offset:4096
v_mfma_f32_16x16x32_bf16 v[148:151], v[80:83], a[80:83], v[148:151]
ds_read_b64_tr_b16 v[66:67], v23 offset:6144
v_mfma_f32_16x16x32_bf16 v[144:147], v[84:87], a[12:15], v[144:147]
ds_read_b64_tr_b16 v[68:69], v23 offset:8192
s_add_u32 m0, s32, 118784
v_mfma_f32_16x16x32_bf16 v[148:151], v[84:87], a[84:87], v[148:151]
ds_read_b64_tr_b16 v[70:71], v23 offset:10240
v_mfma_f32_16x16x32_bf16 v[144:147], v[88:91], a[16:19], v[144:147]
ds_read_b64_tr_b16 v[72:73], v23 offset:12288
v_mfma_f32_16x16x32_bf16 v[148:151], v[88:91], a[88:91], v[148:151]
ds_read_b64_tr_b16 v[74:75], v23 offset:14336
s_add_u32 s34, s28, 3244160
v_mfma_f32_16x16x32_bf16 v[144:147], v[92:95], a[20:23], v[144:147]
ds_read_b64_tr_b16 v[76:77], v23 offset:16384
v_mfma_f32_16x16x32_bf16 v[148:151], v[92:95], a[92:95], v[148:151]
ds_read_b64_tr_b16 v[78:79], v23 offset:18432
s_waitcnt lgkmcnt(8)
v_mfma_f32_16x16x32_bf16 v[144:147], v[48:51], a[24:27], v[144:147]
ds_read_b64_tr_b16 v[80:81], v23 offset:20480
v_mfma_f32_16x16x32_bf16 v[148:151], v[48:51], a[96:99], v[148:151]
ds_read_b64_tr_b16 v[82:83], v23 offset:22528
buffer_load_dwordx4 v36, s[12:15], s34 offen offset:0 lds
v_mfma_f32_16x16x32_bf16 v[144:147], v[52:55], a[28:31], v[144:147]
ds_read_b64_tr_b16 v[84:85], v23 offset:24576
v_mfma_f32_16x16x32_bf16 v[148:151], v[52:55], a[100:103], v[148:151]
ds_read_b64_tr_b16 v[86:87], v23 offset:26624
v_mfma_f32_16x16x32_bf16 v[144:147], v[56:59], a[32:35], v[144:147]
ds_read_b64_tr_b16 v[88:89], v23 offset:28672
v_mfma_f32_16x16x32_bf16 v[148:151], v[56:59], a[104:107], v[148:151]
ds_read_b64_tr_b16 v[90:91], v23 offset:30720
s_waitcnt vmcnt(9)
v_mfma_f32_16x16x32_bf16 v[152:155], v[60:63], a[0:3], 0
ds_read_b64_tr_b16 v[92:93], v23 offset:32768
L_mlp_pad2:
s_cbranch_execz L_mlp_pad6
s_barrier
v_mfma_f32_16x16x32_bf16 v[156:159], v[60:63], a[72:75], 0
ds_read_b64_tr_b16 v[94:95], v23 offset:34816
s_waitcnt lgkmcnt(8)
v_mfma_f32_16x16x32_bf16 v[152:155], v[64:67], a[4:7], v[152:155]
ds_read_b64_tr_b16 v[48:49], v24 offset:0
v_mfma_f32_16x16x32_bf16 v[156:159], v[64:67], a[76:79], v[156:159]
ds_read_b64_tr_b16 v[50:51], v24 offset:2048
v_mfma_f32_16x16x32_bf16 v[152:155], v[68:71], a[8:11], v[152:155]
ds_read_b64_tr_b16 v[52:53], v24 offset:4096
v_mfma_f32_16x16x32_bf16 v[156:159], v[68:71], a[80:83], v[156:159]
ds_read_b64_tr_b16 v[54:55], v24 offset:6144
v_mfma_f32_16x16x32_bf16 v[152:155], v[72:75], a[12:15], v[152:155]
ds_read_b64_tr_b16 v[56:57], v24 offset:8192
v_mfma_f32_16x16x32_bf16 v[156:159], v[72:75], a[84:87], v[156:159]
ds_read_b64_tr_b16 v[58:59], v24 offset:10240
v_mfma_f32_16x16x32_bf16 v[152:155], v[76:79], a[16:19], v[152:155]
ds_read_b64_tr_b16 v[60:61], v24 offset:12288
v_mfma_f32_16x16x32_bf16 v[156:159], v[76:79], a[88:91], v[156:159]
ds_read_b64_tr_b16 v[62:63], v24 offset:14336
s_waitcnt lgkmcnt(8)
v_mfma_f32_16x16x32_bf16 v[152:155], v[80:83], a[20:23], v[152:155]
ds_read_b64_tr_b16 v[64:65], v24 offset:16384
v_mfma_f32_16x16x32_bf16 v[156:159], v[80:83], a[92:95], v[156:159]
ds_read_b64_tr_b16 v[66:67], v24 offset:18432
v_mfma_f32_16x16x32_bf16 v[152:155], v[84:87], a[24:27], v[152:155]
ds_read_b64_tr_b16 v[68:69], v24 offset:20480
v_mfma_f32_16x16x32_bf16 v[156:159], v[84:87], a[96:99], v[156:159]
ds_read_b64_tr_b16 v[70:71], v24 offset:22528
v_mfma_f32_16x16x32_bf16 v[152:155], v[88:91], a[28:31], v[152:155]
ds_read_b64_tr_b16 v[72:73], v24 offset:24576
v_mfma_f32_16x16x32_bf16 v[156:159], v[88:91], a[100:103], v[156:159]
ds_read_b64_tr_b16 v[74:75], v24 offset:26624
v_mfma_f32_16x16x32_bf16 v[152:155], v[92:95], a[32:35], v[152:155]
ds_read_b64_tr_b16 v[76:77], v24 offset:28672
v_mfma_f32_16x16x32_bf16 v[156:159], v[92:95], a[104:107], v[156:159]
ds_read_b64_tr_b16 v[78:79], v24 offset:30720
s_waitcnt lgkmcnt(8)
v_mfma_f32_16x16x32_bf16 v[96:99], v[48:51], a[36:39], v[96:99]
ds_read_b64_tr_b16 v[80:81], v24 offset:32768
s_add_u32 m0, s32, 0
v_mfma_f32_16x16x32_bf16 v[100:103], v[48:51], a[108:111], v[100:103]
ds_read_b64_tr_b16 v[82:83], v24 offset:34816
v_mfma_f32_16x16x32_bf16 v[96:99], v[52:55], a[40:43], v[96:99]
ds_read_b64_tr_b16 v[84:85], v25 offset:0
v_mfma_f32_16x16x32_bf16 v[100:103], v[52:55], a[112:115], v[100:103]
ds_read_b64_tr_b16 v[86:87], v25 offset:2048
s_add_u32 s34, s28, 256
v_mfma_f32_16x16x32_bf16 v[96:99], v[56:59], a[44:47], v[96:99]
ds_read_b64_tr_b16 v[88:89], v25 offset:4096
v_mfma_f32_16x16x32_bf16 v[100:103], v[56:59], a[116:119], v[100:103]
ds_read_b64_tr_b16 v[90:91], v25 offset:6144
v_mfma_f32_16x16x32_bf16 v[96:99], v[60:63], a[48:51], v[96:99]
ds_read_b64_tr_b16 v[92:93], v25 offset:8192
buffer_load_dwordx4 v36, s[8:11], s34 offen offset:0 lds
v_mfma_f32_16x16x32_bf16 v[100:103], v[60:63], a[120:123], v[100:103]
ds_read_b64_tr_b16 v[94:95], v25 offset:10240
s_waitcnt lgkmcnt(8)
v_mfma_f32_16x16x32_bf16 v[96:99], v[64:67], a[52:55], v[96:99]
ds_read_b64_tr_b16 v[48:49], v25 offset:12288
v_mfma_f32_16x16x32_bf16 v[100:103], v[64:67], a[124:127], v[100:103]
ds_read_b64_tr_b16 v[50:51], v25 offset:14336
v_mfma_f32_16x16x32_bf16 v[96:99], v[68:71], a[56:59], v[96:99]
ds_read_b64_tr_b16 v[52:53], v25 offset:16384
buffer_load_dwordx4 v37, s[8:11], s34 offen offset:1024 lds
v_mfma_f32_16x16x32_bf16 v[100:103], v[68:71], a[128:131], v[100:103]
ds_read_b64_tr_b16 v[54:55], v25 offset:18432
v_mfma_f32_16x16x32_bf16 v[96:99], v[72:75], a[60:63], v[96:99]
ds_read_b64_tr_b16 v[56:57], v25 offset:20480
v_mfma_f32_16x16x32_bf16 v[100:103], v[72:75], a[132:135], v[100:103]
ds_read_b64_tr_b16 v[58:59], v25 offset:22528
buffer_load_dwordx4 v38, s[8:11], s34 offen offset:2048 lds
v_mfma_f32_16x16x32_bf16 v[96:99], v[76:79], a[64:67], v[96:99]
ds_read_b64_tr_b16 v[60:61], v25 offset:24576
v_mfma_f32_16x16x32_bf16 v[100:103], v[76:79], a[136:139], v[100:103]
ds_read_b64_tr_b16 v[62:63], v25 offset:26624
s_waitcnt lgkmcnt(8)
v_mfma_f32_16x16x32_bf16 v[96:99], v[80:83], a[68:71], v[96:99]
ds_read_b64_tr_b16 v[64:65], v25 offset:28672
v_mfma_f32_16x16x32_bf16 v[100:103], v[80:83], a[140:143], v[100:103]
ds_read_b64_tr_b16 v[66:67], v25 offset:30720
buffer_load_dwordx4 v39, s[8:11], s34 offen offset:3072 lds
v_mfma_f32_16x16x32_bf16 v[104:107], v[84:87], a[36:39], v[104:107]
ds_read_b64_tr_b16 v[68:69], v25 offset:32768
v_mfma_f32_16x16x32_bf16 v[108:111], v[84:87], a[108:111], v[108:111]
ds_read_b64_tr_b16 v[70:71], v25 offset:34816
v_mfma_f32_16x16x32_bf16 v[104:107], v[88:91], a[40:43], v[104:107]
ds_read_b64_tr_b16 v[72:73], v26 offset:0
s_add_u32 m0, s32, 4096
v_mfma_f32_16x16x32_bf16 v[108:111], v[88:91], a[112:115], v[108:111]
ds_read_b64_tr_b16 v[74:75], v26 offset:2048
v_mfma_f32_16x16x32_bf16 v[104:107], v[92:95], a[44:47], v[104:107]
ds_read_b64_tr_b16 v[76:77], v26 offset:4096
v_mfma_f32_16x16x32_bf16 v[108:111], v[92:95], a[116:119], v[108:111]
ds_read_b64_tr_b16 v[78:79], v26 offset:6144
s_waitcnt lgkmcnt(8)
v_mfma_f32_16x16x32_bf16 v[104:107], v[48:51], a[48:51], v[104:107]
ds_read_b64_tr_b16 v[80:81], v26 offset:8192
s_add_u32 s34, s28, 295168
v_mfma_f32_16x16x32_bf16 v[108:111], v[48:51], a[120:123], v[108:111]
ds_read_b64_tr_b16 v[82:83], v26 offset:10240
v_mfma_f32_16x16x32_bf16 v[104:107], v[52:55], a[52:55], v[104:107]
ds_read_b64_tr_b16 v[84:85], v26 offset:12288
v_mfma_f32_16x16x32_bf16 v[108:111], v[52:55], a[124:127], v[108:111]
ds_read_b64_tr_b16 v[86:87], v26 offset:14336
v_mfma_f32_16x16x32_bf16 v[104:107], v[56:59], a[56:59], v[104:107]
ds_read_b64_tr_b16 v[88:89], v26 offset:16384
buffer_load_dwordx4 v36, s[8:11], s34 offen offset:0 lds
v_mfma_f32_16x16x32_bf16 v[108:111], v[56:59], a[128:131], v[108:111]
ds_read_b64_tr_b16 v[90:91], v26 offset:18432
v_mfma_f32_16x16x32_bf16 v[104:107], v[60:63], a[60:63], v[104:107]
ds_read_b64_tr_b16 v[92:93], v26 offset:20480
v_mfma_f32_16x16x32_bf16 v[108:111], v[60:63], a[132:135], v[108:111]
ds_read_b64_tr_b16 v[94:95], v26 offset:22528
s_waitcnt lgkmcnt(8)
v_mfma_f32_16x16x32_bf16 v[104:107], v[64:67], a[64:67], v[104:107]
ds_read_b64_tr_b16 v[48:49], v26 offset:24576
buffer_load_dwordx4 v37, s[8:11], s34 offen offset:1024 lds
v_mfma_f32_16x16x32_bf16 v[108:111], v[64:67], a[136:139], v[108:111]
ds_read_b64_tr_b16 v[50:51], v26 offset:26624
v_mfma_f32_16x16x32_bf16 v[104:107], v[68:71], a[68:71], v[104:107]
ds_read_b64_tr_b16 v[52:53], v26 offset:28672
v_mfma_f32_16x16x32_bf16 v[108:111], v[68:71], a[140:143], v[108:111]
ds_read_b64_tr_b16 v[54:55], v26 offset:30720
buffer_load_dwordx4 v38, s[8:11], s34 offen offset:2048 lds
v_mfma_f32_16x16x32_bf16 v[112:115], v[72:75], a[36:39], v[112:115]
ds_read_b64_tr_b16 v[56:57], v26 offset:32768
v_mfma_f32_16x16x32_bf16 v[116:119], v[72:75], a[108:111], v[116:119]
ds_read_b64_tr_b16 v[58:59], v26 offset:34816
v_mfma_f32_16x16x32_bf16 v[112:115], v[76:79], a[40:43], v[112:115]
ds_read_b64_tr_b16 v[60:61], v27 offset:0
buffer_load_dwordx4 v39, s[8:11], s34 offen offset:3072 lds
v_mfma_f32_16x16x32_bf16 v[116:119], v[76:79], a[112:115], v[116:119]
ds_read_b64_tr_b16 v[62:63], v27 offset:2048
s_waitcnt lgkmcnt(8)
v_mfma_f32_16x16x32_bf16 v[112:115], v[80:83], a[44:47], v[112:115]
ds_read_b64_tr_b16 v[64:65], v27 offset:4096
v_mfma_f32_16x16x32_bf16 v[116:119], v[80:83], a[116:119], v[116:119]
ds_read_b64_tr_b16 v[66:67], v27 offset:6144
v_mfma_f32_16x16x32_bf16 v[112:115], v[84:87], a[48:51], v[112:115]
ds_read_b64_tr_b16 v[68:69], v27 offset:8192
s_add_u32 m0, s32, 8192
v_mfma_f32_16x16x32_bf16 v[116:119], v[84:87], a[120:123], v[116:119]
ds_read_b64_tr_b16 v[70:71], v27 offset:10240
v_mfma_f32_16x16x32_bf16 v[112:115], v[88:91], a[52:55], v[112:115]
ds_read_b64_tr_b16 v[72:73], v27 offset:12288
v_mfma_f32_16x16x32_bf16 v[116:119], v[88:91], a[124:127], v[116:119]
ds_read_b64_tr_b16 v[74:75], v27 offset:14336
s_add_u32 s34, s28, 590080
v_mfma_f32_16x16x32_bf16 v[112:115], v[92:95], a[56:59], v[112:115]
ds_read_b64_tr_b16 v[76:77], v27 offset:16384
v_mfma_f32_16x16x32_bf16 v[116:119], v[92:95], a[128:131], v[116:119]
ds_read_b64_tr_b16 v[78:79], v27 offset:18432
s_waitcnt lgkmcnt(8)
v_mfma_f32_16x16x32_bf16 v[112:115], v[48:51], a[60:63], v[112:115]
ds_read_b64_tr_b16 v[80:81], v27 offset:20480
v_mfma_f32_16x16x32_bf16 v[116:119], v[48:51], a[132:135], v[116:119]
ds_read_b64_tr_b16 v[82:83], v27 offset:22528
buffer_load_dwordx4 v36, s[8:11], s34 offen offset:0 lds
v_mfma_f32_16x16x32_bf16 v[112:115], v[52:55], a[64:67], v[112:115]
ds_read_b64_tr_b16 v[84:85], v27 offset:24576
v_mfma_f32_16x16x32_bf16 v[116:119], v[52:55], a[136:139], v[116:119]
ds_read_b64_tr_b16 v[86:87], v27 offset:26624
v_mfma_f32_16x16x32_bf16 v[112:115], v[56:59], a[68:71], v[112:115]
ds_read_b64_tr_b16 v[88:89], v27 offset:28672
v_mfma_f32_16x16x32_bf16 v[116:119], v[56:59], a[140:143], v[116:119]
ds_read_b64_tr_b16 v[90:91], v27 offset:30720
s_waitcnt vmcnt(9)
v_mfma_f32_16x16x32_bf16 v[120:123], v[60:63], a[36:39], v[120:123]
ds_read_b64_tr_b16 v[92:93], v27 offset:32768
s_barrier
v_mfma_f32_16x16x32_bf16 v[124:127], v[60:63], a[108:111], v[124:127]
ds_read_b64_tr_b16 v[94:95], v27 offset:34816
s_waitcnt lgkmcnt(8)
v_mfma_f32_16x16x32_bf16 v[120:123], v[64:67], a[40:43], v[120:123]
ds_read_b64_tr_b16 v[48:49], v28 offset:0
v_mfma_f32_16x16x32_bf16 v[124:127], v[64:67], a[112:115], v[124:127]
ds_read_b64_tr_b16 v[50:51], v28 offset:2048
v_mfma_f32_16x16x32_bf16 v[120:123], v[68:71], a[44:47], v[120:123]
ds_read_b64_tr_b16 v[52:53], v28 offset:4096
v_mfma_f32_16x16x32_bf16 v[124:127], v[68:71], a[116:119], v[124:127]
ds_read_b64_tr_b16 v[54:55], v28 offset:6144
v_mfma_f32_16x16x32_bf16 v[120:123], v[72:75], a[48:51], v[120:123]
ds_read_b64_tr_b16 v[56:57], v28 offset:8192
v_mfma_f32_16x16x32_bf16 v[124:127], v[72:75], a[120:123], v[124:127]
ds_read_b64_tr_b16 v[58:59], v28 offset:10240
v_mfma_f32_16x16x32_bf16 v[120:123], v[76:79], a[52:55], v[120:123]
ds_read_b64_tr_b16 v[60:61], v28 offset:12288
v_mfma_f32_16x16x32_bf16 v[124:127], v[76:79], a[124:127], v[124:127]
ds_read_b64_tr_b16 v[62:63], v28 offset:14336
s_waitcnt lgkmcnt(8)
v_mfma_f32_16x16x32_bf16 v[120:123], v[80:83], a[56:59], v[120:123]
ds_read_b64_tr_b16 v[64:65], v28 offset:16384
v_mfma_f32_16x16x32_bf16 v[124:127], v[80:83], a[128:131], v[124:127]
ds_read_b64_tr_b16 v[66:67], v28 offset:18432
v_mfma_f32_16x16x32_bf16 v[120:123], v[84:87], a[60:63], v[120:123]
ds_read_b64_tr_b16 v[68:69], v28 offset:20480
v_mfma_f32_16x16x32_bf16 v[124:127], v[84:87], a[132:135], v[124:127]
ds_read_b64_tr_b16 v[70:71], v28 offset:22528
v_mfma_f32_16x16x32_bf16 v[120:123], v[88:91], a[64:67], v[120:123]
ds_read_b64_tr_b16 v[72:73], v28 offset:24576
v_mfma_f32_16x16x32_bf16 v[124:127], v[88:91], a[136:139], v[124:127]
ds_read_b64_tr_b16 v[74:75], v28 offset:26624
v_mfma_f32_16x16x32_bf16 v[120:123], v[92:95], a[68:71], v[120:123]
ds_read_b64_tr_b16 v[76:77], v28 offset:28672
v_mfma_f32_16x16x32_bf16 v[124:127], v[92:95], a[140:143], v[124:127]
ds_read_b64_tr_b16 v[78:79], v28 offset:30720
s_waitcnt lgkmcnt(8)
v_mfma_f32_16x16x32_bf16 v[128:131], v[48:51], a[36:39], v[128:131]
ds_read_b64_tr_b16 v[80:81], v28 offset:32768
s_add_u32 m0, s32, 36864
v_mfma_f32_16x16x32_bf16 v[132:135], v[48:51], a[108:111], v[132:135]
ds_read_b64_tr_b16 v[82:83], v28 offset:34816
v_mfma_f32_16x16x32_bf16 v[128:131], v[52:55], a[40:43], v[128:131]
ds_read_b64_tr_b16 v[84:85], v29 offset:0
v_mfma_f32_16x16x32_bf16 v[132:135], v[52:55], a[112:115], v[132:135]
ds_read_b64_tr_b16 v[86:87], v29 offset:2048
s_add_u32 s34, s28, 256
v_mfma_f32_16x16x32_bf16 v[128:131], v[56:59], a[44:47], v[128:131]
ds_read_b64_tr_b16 v[88:89], v29 offset:4096
v_mfma_f32_16x16x32_bf16 v[132:135], v[56:59], a[116:119], v[132:135]
ds_read_b64_tr_b16 v[90:91], v29 offset:6144
v_mfma_f32_16x16x32_bf16 v[128:131], v[60:63], a[48:51], v[128:131]
ds_read_b64_tr_b16 v[92:93], v29 offset:8192
buffer_load_dwordx4 v36, s[12:15], s34 offen offset:0 lds
v_mfma_f32_16x16x32_bf16 v[132:135], v[60:63], a[120:123], v[132:135]
ds_read_b64_tr_b16 v[94:95], v29 offset:10240
s_waitcnt lgkmcnt(8)
v_mfma_f32_16x16x32_bf16 v[128:131], v[64:67], a[52:55], v[128:131]
ds_read_b64_tr_b16 v[48:49], v29 offset:12288
v_mfma_f32_16x16x32_bf16 v[132:135], v[64:67], a[124:127], v[132:135]
ds_read_b64_tr_b16 v[50:51], v29 offset:14336
v_mfma_f32_16x16x32_bf16 v[128:131], v[68:71], a[56:59], v[128:131]
ds_read_b64_tr_b16 v[52:53], v29 offset:16384
buffer_load_dwordx4 v37, s[12:15], s34 offen offset:1024 lds
v_mfma_f32_16x16x32_bf16 v[132:135], v[68:71], a[128:131], v[132:135]
ds_read_b64_tr_b16 v[54:55], v29 offset:18432
v_mfma_f32_16x16x32_bf16 v[128:131], v[72:75], a[60:63], v[128:131]
ds_read_b64_tr_b16 v[56:57], v29 offset:20480
v_mfma_f32_16x16x32_bf16 v[132:135], v[72:75], a[132:135], v[132:135]
ds_read_b64_tr_b16 v[58:59], v29 offset:22528
buffer_load_dwordx4 v38, s[12:15], s34 offen offset:2048 lds
v_mfma_f32_16x16x32_bf16 v[128:131], v[76:79], a[64:67], v[128:131]
ds_read_b64_tr_b16 v[60:61], v29 offset:24576
v_mfma_f32_16x16x32_bf16 v[132:135], v[76:79], a[136:139], v[132:135]
ds_read_b64_tr_b16 v[62:63], v29 offset:26624
s_waitcnt lgkmcnt(8)
v_mfma_f32_16x16x32_bf16 v[128:131], v[80:83], a[68:71], v[128:131]
ds_read_b64_tr_b16 v[64:65], v29 offset:28672
v_mfma_f32_16x16x32_bf16 v[132:135], v[80:83], a[140:143], v[132:135]
ds_read_b64_tr_b16 v[66:67], v29 offset:30720
buffer_load_dwordx4 v39, s[12:15], s34 offen offset:3072 lds
v_mfma_f32_16x16x32_bf16 v[136:139], v[84:87], a[36:39], v[136:139]
ds_read_b64_tr_b16 v[68:69], v29 offset:32768
v_mfma_f32_16x16x32_bf16 v[140:143], v[84:87], a[108:111], v[140:143]
ds_read_b64_tr_b16 v[70:71], v29 offset:34816
v_mfma_f32_16x16x32_bf16 v[136:139], v[88:91], a[40:43], v[136:139]
ds_read_b64_tr_b16 v[72:73], v30 offset:0
s_add_u32 m0, s32, 40960
v_mfma_f32_16x16x32_bf16 v[140:143], v[88:91], a[112:115], v[140:143]
ds_read_b64_tr_b16 v[74:75], v30 offset:2048
v_mfma_f32_16x16x32_bf16 v[136:139], v[92:95], a[44:47], v[136:139]
ds_read_b64_tr_b16 v[76:77], v30 offset:4096
v_mul_f32 v96, v96, v128
v_mfma_f32_16x16x32_bf16 v[140:143], v[92:95], a[116:119], v[140:143]
ds_read_b64_tr_b16 v[78:79], v30 offset:6144
s_waitcnt lgkmcnt(8)
v_mfma_f32_16x16x32_bf16 v[136:139], v[48:51], a[48:51], v[136:139]
ds_read_b64_tr_b16 v[80:81], v30 offset:8192
s_add_u32 s34, s28, 295168
v_mfma_f32_16x16x32_bf16 v[140:143], v[48:51], a[120:123], v[140:143]
ds_read_b64_tr_b16 v[82:83], v30 offset:10240
v_mul_f32 v97, v97, v129
v_mfma_f32_16x16x32_bf16 v[136:139], v[52:55], a[52:55], v[136:139]
ds_read_b64_tr_b16 v[84:85], v30 offset:12288
v_mul_f32 v98, v98, v130
v_mfma_f32_16x16x32_bf16 v[140:143], v[52:55], a[124:127], v[140:143]
ds_read_b64_tr_b16 v[86:87], v30 offset:14336
v_mul_f32 v99, v99, v131
v_mfma_f32_16x16x32_bf16 v[136:139], v[56:59], a[56:59], v[136:139]
ds_read_b64_tr_b16 v[88:89], v30 offset:16384
buffer_load_dwordx4 v36, s[12:15], s34 offen offset:0 lds
v_mfma_f32_16x16x32_bf16 v[140:143], v[56:59], a[128:131], v[140:143]
ds_read_b64_tr_b16 v[90:91], v30 offset:18432
v_cvt_pk_bf16_f32 v176, v96, v97
v_mfma_f32_16x16x32_bf16 v[136:139], v[60:63], a[60:63], v[136:139]
ds_read_b64_tr_b16 v[92:93], v30 offset:20480
v_cvt_pk_bf16_f32 v177, v98, v99
v_mfma_f32_16x16x32_bf16 v[140:143], v[60:63], a[132:135], v[140:143]
ds_read_b64_tr_b16 v[94:95], v30 offset:22528
s_waitcnt lgkmcnt(8)
v_mfma_f32_16x16x32_bf16 v[136:139], v[64:67], a[64:67], v[136:139]
ds_read_b64_tr_b16 v[48:49], v30 offset:24576
buffer_load_dwordx4 v37, s[12:15], s34 offen offset:1024 lds
v_mfma_f32_16x16x32_bf16 v[140:143], v[64:67], a[136:139], v[140:143]
ds_read_b64_tr_b16 v[50:51], v30 offset:26624
v_mul_f32 v100, v100, v132
v_mfma_f32_16x16x32_bf16 v[136:139], v[68:71], a[68:71], v[136:139]
ds_read_b64_tr_b16 v[52:53], v30 offset:28672
v_mul_f32 v101, v101, v133
v_mfma_f32_16x16x32_bf16 v[140:143], v[68:71], a[140:143], v[140:143]
ds_read_b64_tr_b16 v[54:55], v30 offset:30720
buffer_load_dwordx4 v38, s[12:15], s34 offen offset:2048 lds
v_mfma_f32_16x16x32_bf16 v[144:147], v[72:75], a[36:39], v[144:147]
ds_read_b64_tr_b16 v[56:57], v30 offset:32768
v_mul_f32 v102, v102, v134
v_mfma_f32_16x16x32_bf16 v[148:151], v[72:75], a[108:111], v[148:151]
ds_read_b64_tr_b16 v[58:59], v30 offset:34816
v_mul_f32 v103, v103, v135
v_mfma_f32_16x16x32_bf16 v[144:147], v[76:79], a[40:43], v[144:147]
ds_read_b64_tr_b16 v[60:61], v31 offset:0
buffer_load_dwordx4 v39, s[12:15], s34 offen offset:3072 lds
v_mfma_f32_16x16x32_bf16 v[148:151], v[76:79], a[112:115], v[148:151]
ds_read_b64_tr_b16 v[62:63], v31 offset:2048
s_waitcnt lgkmcnt(8)
v_mfma_f32_16x16x32_bf16 v[144:147], v[80:83], a[44:47], v[144:147]
ds_read_b64_tr_b16 v[64:65], v31 offset:4096
v_cvt_pk_bf16_f32 v180, v100, v101
v_mfma_f32_16x16x32_bf16 v[148:151], v[80:83], a[116:119], v[148:151]
ds_read_b64_tr_b16 v[66:67], v31 offset:6144
v_cvt_pk_bf16_f32 v181, v102, v103
v_mfma_f32_16x16x32_bf16 v[144:147], v[84:87], a[48:51], v[144:147]
ds_read_b64_tr_b16 v[68:69], v31 offset:8192
s_add_u32 m0, s32, 45056
v_mfma_f32_16x16x32_bf16 v[148:151], v[84:87], a[120:123], v[148:151]
ds_read_b64_tr_b16 v[70:71], v31 offset:10240
v_mul_f32 v104, v104, v136
v_mfma_f32_16x16x32_bf16 v[144:147], v[88:91], a[52:55], v[144:147]
ds_read_b64_tr_b16 v[72:73], v31 offset:12288
v_mul_f32 v105, v105, v137
v_mfma_f32_16x16x32_bf16 v[148:151], v[88:91], a[124:127], v[148:151]
ds_read_b64_tr_b16 v[74:75], v31 offset:14336
s_add_u32 s34, s28, 590080
v_mfma_f32_16x16x32_bf16 v[144:147], v[92:95], a[56:59], v[144:147]
ds_read_b64_tr_b16 v[76:77], v31 offset:16384
v_mul_f32 v106, v106, v138
v_mfma_f32_16x16x32_bf16 v[148:151], v[92:95], a[128:131], v[148:151]
ds_read_b64_tr_b16 v[78:79], v31 offset:18432
s_waitcnt lgkmcnt(8)
v_mfma_f32_16x16x32_bf16 v[144:147], v[48:51], a[60:63], v[144:147]
ds_read_b64_tr_b16 v[80:81], v31 offset:20480
v_mul_f32 v107, v107, v139
v_mfma_f32_16x16x32_bf16 v[148:151], v[48:51], a[132:135], v[148:151]
ds_read_b64_tr_b16 v[82:83], v31 offset:22528
buffer_load_dwordx4 v36, s[12:15], s34 offen offset:0 lds
v_mfma_f32_16x16x32_bf16 v[144:147], v[52:55], a[64:67], v[144:147]
ds_read_b64_tr_b16 v[84:85], v31 offset:24576
v_cvt_pk_bf16_f32 v178, v104, v105
v_mfma_f32_16x16x32_bf16 v[148:151], v[52:55], a[136:139], v[148:151]
ds_read_b64_tr_b16 v[86:87], v31 offset:26624
v_cvt_pk_bf16_f32 v179, v106, v107
v_mfma_f32_16x16x32_bf16 v[144:147], v[56:59], a[68:71], v[144:147]
ds_read_b64_tr_b16 v[88:89], v31 offset:28672
v_mul_f32 v108, v108, v140
v_mfma_f32_16x16x32_bf16 v[148:151], v[56:59], a[140:143], v[148:151]
ds_read_b64_tr_b16 v[90:91], v31 offset:30720
s_waitcnt vmcnt(9)
v_mfma_f32_16x16x32_bf16 v[152:155], v[60:63], a[36:39], v[152:155]
ds_read_b64_tr_b16 v[92:93], v31 offset:32768
s_barrier
v_mfma_f32_16x16x32_bf16 v[156:159], v[60:63], a[108:111], v[156:159]
ds_read_b64_tr_b16 v[94:95], v31 offset:34816
s_waitcnt lgkmcnt(8)
v_mfma_f32_16x16x32_bf16 v[152:155], v[64:67], a[40:43], v[152:155]
ds_read_b64_tr_b16 v[48:49], v16 offset:0
v_mul_f32 v109, v109, v141
v_mfma_f32_16x16x32_bf16 v[156:159], v[64:67], a[112:115], v[156:159]
ds_read_b64_tr_b16 v[50:51], v16 offset:2048
v_mul_f32 v110, v110, v142
v_mfma_f32_16x16x32_bf16 v[152:155], v[68:71], a[44:47], v[152:155]
ds_read_b64_tr_b16 v[52:53], v16 offset:4096
v_mul_f32 v111, v111, v143
v_mfma_f32_16x16x32_bf16 v[156:159], v[68:71], a[116:119], v[156:159]
ds_read_b64_tr_b16 v[54:55], v16 offset:6144
v_cvt_pk_bf16_f32 v182, v108, v109
v_mfma_f32_16x16x32_bf16 v[152:155], v[72:75], a[48:51], v[152:155]
ds_read_b64_tr_b16 v[56:57], v16 offset:8192
v_cvt_pk_bf16_f32 v183, v110, v111
v_mfma_f32_16x16x32_bf16 v[156:159], v[72:75], a[120:123], v[156:159]
ds_read_b64_tr_b16 v[58:59], v16 offset:10240
v_mul_f32 v112, v112, v144
v_mfma_f32_16x16x32_bf16 v[152:155], v[76:79], a[52:55], v[152:155]
ds_read_b64_tr_b16 v[60:61], v16 offset:12288
v_mul_f32 v113, v113, v145
v_mfma_f32_16x16x32_bf16 v[156:159], v[76:79], a[124:127], v[156:159]
ds_read_b64_tr_b16 v[62:63], v16 offset:14336
s_waitcnt lgkmcnt(8)
v_mfma_f32_16x16x32_bf16 v[152:155], v[80:83], a[56:59], v[152:155]
ds_read_b64_tr_b16 v[64:65], v16 offset:16384
v_mul_f32 v114, v114, v146
v_mfma_f32_16x16x32_bf16 v[156:159], v[80:83], a[128:131], v[156:159]
ds_read_b64_tr_b16 v[66:67], v16 offset:18432
v_mul_f32 v115, v115, v147
v_mfma_f32_16x16x32_bf16 v[152:155], v[84:87], a[60:63], v[152:155]
ds_read_b64_tr_b16 v[68:69], v16 offset:20480
v_cvt_pk_bf16_f32 v184, v112, v113
v_mfma_f32_16x16x32_bf16 v[156:159], v[84:87], a[132:135], v[156:159]
ds_read_b64_tr_b16 v[70:71], v16 offset:22528
v_cvt_pk_bf16_f32 v185, v114, v115
v_mfma_f32_16x16x32_bf16 v[152:155], v[88:91], a[64:67], v[152:155]
ds_read_b64_tr_b16 v[72:73], v16 offset:24576
v_mul_f32 v116, v116, v148
v_mfma_f32_16x16x32_bf16 v[156:159], v[88:91], a[136:139], v[156:159]
ds_read_b64_tr_b16 v[74:75], v16 offset:26624
v_mul_f32 v117, v117, v149
v_mfma_f32_16x16x32_bf16 v[152:155], v[92:95], a[68:71], v[152:155]
ds_read_b64_tr_b16 v[76:77], v16 offset:28672
v_mul_f32 v118, v118, v150
v_mfma_f32_16x16x32_bf16 v[156:159], v[92:95], a[140:143], v[156:159]
ds_read_b64_tr_b16 v[78:79], v16 offset:30720
s_waitcnt lgkmcnt(8)
v_mfma_f32_16x16x32_bf16 v[96:99], v[48:51], a[0:3], 0
ds_read_b64_tr_b16 v[80:81], v16 offset:32768
v_mul_f32 v119, v119, v151
v_mfma_f32_16x16x32_bf16 v[100:103], v[48:51], a[72:75], 0
ds_read_b64_tr_b16 v[82:83], v16 offset:34816
v_cvt_pk_bf16_f32 v188, v116, v117
v_mfma_f32_16x16x32_bf16 v[96:99], v[52:55], a[4:7], v[96:99]
ds_read_b64_tr_b16 v[84:85], v17 offset:0
v_cvt_pk_bf16_f32 v189, v118, v119
v_mfma_f32_16x16x32_bf16 v[100:103], v[52:55], a[76:79], v[100:103]
ds_read_b64_tr_b16 v[86:87], v17 offset:2048
s_add_u32 m0, s32, 73728
v_mfma_f32_16x16x32_bf16 v[96:99], v[56:59], a[8:11], v[96:99]
ds_read_b64_tr_b16 v[88:89], v17 offset:4096
v_mul_f32 v120, v120, v152
v_mfma_f32_16x16x32_bf16 v[100:103], v[56:59], a[80:83], v[100:103]
ds_read_b64_tr_b16 v[90:91], v17 offset:6144
v_mul_f32 v121, v121, v153
v_mfma_f32_16x16x32_bf16 v[96:99], v[60:63], a[12:15], v[96:99]
ds_read_b64_tr_b16 v[92:93], v17 offset:8192
v_mul_f32 v122, v122, v154
v_mfma_f32_16x16x32_bf16 v[100:103], v[60:63], a[84:87], v[100:103]
ds_read_b64_tr_b16 v[94:95], v17 offset:10240
s_waitcnt lgkmcnt(8)
v_mfma_f32_16x16x32_bf16 v[96:99], v[64:67], a[16:19], v[96:99]
ds_read_b64_tr_b16 v[48:49], v17 offset:12288
v_mul_f32 v123, v123, v155
v_mfma_f32_16x16x32_bf16 v[100:103], v[64:67], a[88:91], v[100:103]
ds_read_b64_tr_b16 v[50:51], v17 offset:14336
v_cvt_pk_bf16_f32 v186, v120, v121
v_mfma_f32_16x16x32_bf16 v[96:99], v[68:71], a[20:23], v[96:99]
ds_read_b64_tr_b16 v[52:53], v17 offset:16384
v_cvt_pk_bf16_f32 v187, v122, v123
v_mfma_f32_16x16x32_bf16 v[100:103], v[68:71], a[92:95], v[100:103]
ds_read_b64_tr_b16 v[54:55], v17 offset:18432
v_mul_f32 v124, v124, v156
v_mfma_f32_16x16x32_bf16 v[96:99], v[72:75], a[24:27], v[96:99]
ds_read_b64_tr_b16 v[56:57], v17 offset:20480
v_mul_f32 v125, v125, v157
v_mfma_f32_16x16x32_bf16 v[100:103], v[72:75], a[96:99], v[100:103]
ds_read_b64_tr_b16 v[58:59], v17 offset:22528
v_mul_f32 v126, v126, v158
v_mfma_f32_16x16x32_bf16 v[96:99], v[76:79], a[28:31], v[96:99]
ds_read_b64_tr_b16 v[60:61], v17 offset:24576
v_mul_f32 v127, v127, v159
v_mfma_f32_16x16x32_bf16 v[100:103], v[76:79], a[100:103], v[100:103]
ds_read_b64_tr_b16 v[62:63], v17 offset:26624
s_waitcnt lgkmcnt(8)
v_mfma_f32_16x16x32_bf16 v[96:99], v[80:83], a[32:35], v[96:99]
ds_read_b64_tr_b16 v[64:65], v17 offset:28672
v_cvt_pk_bf16_f32 v190, v124, v125
v_mfma_f32_16x16x32_bf16 v[100:103], v[80:83], a[104:107], v[100:103]
ds_read_b64_tr_b16 v[66:67], v17 offset:30720
v_cvt_pk_bf16_f32 v191, v126, v127
v_mfma_f32_16x16x32_bf16 v[104:107], v[84:87], a[0:3], 0
ds_read_b64_tr_b16 v[68:69], v17 offset:32768
v_mfma_f32_16x16x32_bf16 v[108:111], v[84:87], a[72:75], 0
ds_read_b64_tr_b16 v[70:71], v17 offset:34816
s_add_u32 s34, s28, 2654464
v_mfma_f32_16x16x32_bf16 v[104:107], v[88:91], a[4:7], v[104:107]
ds_read_b64_tr_b16 v[72:73], v18 offset:0
v_mfma_f32_16x16x32_bf16 v[108:111], v[88:91], a[76:79], v[108:111]
ds_read_b64_tr_b16 v[74:75], v18 offset:2048
buffer_load_dwordx4 v36, s[8:11], s34 offen offset:0 lds
v_mfma_f32_16x16x32_bf16 v[104:107], v[92:95], a[8:11], v[104:107]
ds_read_b64_tr_b16 v[76:77], v18 offset:4096
v_mfma_f32_16x16x32_bf16 v[108:111], v[92:95], a[80:83], v[108:111]
ds_read_b64_tr_b16 v[78:79], v18 offset:6144
s_waitcnt lgkmcnt(8)
v_mfma_f32_16x16x32_bf16 v[104:107], v[48:51], a[12:15], v[104:107]
ds_read_b64_tr_b16 v[80:81], v18 offset:8192
buffer_load_dwordx4 v37, s[8:11], s34 offen offset:1024 lds
v_mfma_f32_16x16x32_bf16 v[108:111], v[48:51], a[84:87], v[108:111]
ds_read_b64_tr_b16 v[82:83], v18 offset:10240
v_mfma_f32_16x16x32_bf16 v[104:107], v[52:55], a[16:19], v[104:107]
ds_read_b64_tr_b16 v[84:85], v18 offset:12288
buffer_load_dwordx4 v38, s[8:11], s34 offen offset:2048 lds
v_mfma_f32_16x16x32_bf16 v[108:111], v[52:55], a[88:91], v[108:111]
ds_read_b64_tr_b16 v[86:87], v18 offset:14336
v_mfma_f32_16x16x32_bf16 v[104:107], v[56:59], a[20:23], v[104:107]
ds_read_b64_tr_b16 v[88:89], v18 offset:16384
buffer_load_dwordx4 v39, s[8:11], s34 offen offset:3072 lds
v_mfma_f32_16x16x32_bf16 v[108:111], v[56:59], a[92:95], v[108:111]
ds_read_b64_tr_b16 v[90:91], v18 offset:18432
v_mfma_f32_16x16x32_bf16 v[104:107], v[60:63], a[24:27], v[104:107]
ds_read_b64_tr_b16 v[92:93], v18 offset:20480
s_add_u32 m0, s32, 77824
v_mfma_f32_16x16x32_bf16 v[108:111], v[60:63], a[96:99], v[108:111]
ds_read_b64_tr_b16 v[94:95], v18 offset:22528
s_waitcnt lgkmcnt(8)
v_mfma_f32_16x16x32_bf16 v[104:107], v[64:67], a[28:31], v[104:107]
ds_read_b64_tr_b16 v[48:49], v18 offset:24576
v_mfma_f32_16x16x32_bf16 v[108:111], v[64:67], a[100:103], v[108:111]
ds_read_b64_tr_b16 v[50:51], v18 offset:26624
s_add_u32 s34, s28, 2949376
v_mfma_f32_16x16x32_bf16 v[104:107], v[68:71], a[32:35], v[104:107]
ds_read_b64_tr_b16 v[52:53], v18 offset:28672
v_mfma_f32_16x16x32_bf16 v[108:111], v[68:71], a[104:107], v[108:111]
ds_read_b64_tr_b16 v[54:55], v18 offset:30720
v_mfma_f32_16x16x32_bf16 v[112:115], v[72:75], a[0:3], 0
ds_read_b64_tr_b16 v[56:57], v18 offset:32768
buffer_load_dwordx4 v36, s[8:11], s34 offen offset:0 lds
v_mfma_f32_16x16x32_bf16 v[116:119], v[72:75], a[72:75], 0
ds_read_b64_tr_b16 v[58:59], v18 offset:34816
v_mfma_f32_16x16x32_bf16 v[112:115], v[76:79], a[4:7], v[112:115]
ds_read_b64_tr_b16 v[60:61], v19 offset:0
buffer_load_dwordx4 v37, s[8:11], s34 offen offset:1024 lds
v_mfma_f32_16x16x32_bf16 v[116:119], v[76:79], a[76:79], v[116:119]
ds_read_b64_tr_b16 v[62:63], v19 offset:2048
s_waitcnt lgkmcnt(8)
v_mfma_f32_16x16x32_bf16 v[112:115], v[80:83], a[8:11], v[112:115]
ds_read_b64_tr_b16 v[64:65], v19 offset:4096
v_mfma_f32_16x16x32_bf16 v[116:119], v[80:83], a[80:83], v[116:119]
ds_read_b64_tr_b16 v[66:67], v19 offset:6144
buffer_load_dwordx4 v38, s[8:11], s34 offen offset:2048 lds
v_mfma_f32_16x16x32_bf16 v[112:115], v[84:87], a[12:15], v[112:115]
ds_read_b64_tr_b16 v[68:69], v19 offset:8192
v_mfma_f32_16x16x32_bf16 v[116:119], v[84:87], a[84:87], v[116:119]
ds_read_b64_tr_b16 v[70:71], v19 offset:10240
buffer_load_dwordx4 v39, s[8:11], s34 offen offset:3072 lds
v_mfma_f32_16x16x32_bf16 v[112:115], v[88:91], a[16:19], v[112:115]
ds_read_b64_tr_b16 v[72:73], v19 offset:12288
v_mfma_f32_16x16x32_bf16 v[116:119], v[88:91], a[88:91], v[116:119]
ds_read_b64_tr_b16 v[74:75], v19 offset:14336
s_add_u32 m0, s32, 81920
v_mfma_f32_16x16x32_bf16 v[112:115], v[92:95], a[20:23], v[112:115]
ds_read_b64_tr_b16 v[76:77], v19 offset:16384
v_mfma_f32_16x16x32_bf16 v[116:119], v[92:95], a[92:95], v[116:119]
ds_read_b64_tr_b16 v[78:79], v19 offset:18432
s_waitcnt lgkmcnt(8)
v_mfma_f32_16x16x32_bf16 v[112:115], v[48:51], a[24:27], v[112:115]
ds_read_b64_tr_b16 v[80:81], v19 offset:20480
s_add_u32 s34, s28, 3244288
L_mlp_pad3:
s_cbranch_execz L_mlp_pad7
v_mfma_f32_16x16x32_bf16 v[116:119], v[48:51], a[96:99], v[116:119]
ds_read_b64_tr_b16 v[82:83], v19 offset:22528
v_mfma_f32_16x16x32_bf16 v[112:115], v[52:55], a[28:31], v[112:115]
ds_read_b64_tr_b16 v[84:85], v19 offset:24576
buffer_load_dwordx4 v36, s[8:11], s34 offen offset:0 lds
v_mfma_f32_16x16x32_bf16 v[116:119], v[52:55], a[100:103], v[116:119]
ds_read_b64_tr_b16 v[86:87], v19 offset:26624
v_mfma_f32_16x16x32_bf16 v[112:115], v[56:59], a[32:35], v[112:115]
ds_read_b64_tr_b16 v[88:89], v19 offset:28672
v_mfma_f32_16x16x32_bf16 v[116:119], v[56:59], a[104:107], v[116:119]
ds_read_b64_tr_b16 v[90:91], v19 offset:30720
s_waitcnt vmcnt(9)
v_mfma_f32_16x16x32_bf16 v[120:123], v[60:63], a[0:3], 0
ds_read_b64_tr_b16 v[92:93], v19 offset:32768
s_barrier
v_mfma_f32_16x16x32_bf16 v[124:127], v[60:63], a[72:75], 0
ds_read_b64_tr_b16 v[94:95], v19 offset:34816
s_waitcnt lgkmcnt(8)
v_mfma_f32_16x16x32_bf16 v[120:123], v[64:67], a[4:7], v[120:123]
ds_read_b64_tr_b16 v[48:49], v20 offset:0
v_mfma_f32_16x16x32_bf16 v[124:127], v[64:67], a[76:79], v[124:127]
ds_read_b64_tr_b16 v[50:51], v20 offset:2048
v_mfma_f32_16x16x32_bf16 v[120:123], v[68:71], a[8:11], v[120:123]
ds_read_b64_tr_b16 v[52:53], v20 offset:4096
v_mfma_f32_16x16x32_bf16 v[124:127], v[68:71], a[80:83], v[124:127]
ds_read_b64_tr_b16 v[54:55], v20 offset:6144
v_mfma_f32_16x16x32_bf16 v[120:123], v[72:75], a[12:15], v[120:123]
ds_read_b64_tr_b16 v[56:57], v20 offset:8192
v_mfma_f32_16x16x32_bf16 v[124:127], v[72:75], a[84:87], v[124:127]
ds_read_b64_tr_b16 v[58:59], v20 offset:10240
v_mfma_f32_16x16x32_bf16 v[120:123], v[76:79], a[16:19], v[120:123]
ds_read_b64_tr_b16 v[60:61], v20 offset:12288
v_mfma_f32_16x16x32_bf16 v[124:127], v[76:79], a[88:91], v[124:127]
ds_read_b64_tr_b16 v[62:63], v20 offset:14336
s_waitcnt lgkmcnt(8)
v_mfma_f32_16x16x32_bf16 v[120:123], v[80:83], a[20:23], v[120:123]
ds_read_b64_tr_b16 v[64:65], v20 offset:16384
v_mfma_f32_16x16x32_bf16 v[124:127], v[80:83], a[92:95], v[124:127]
ds_read_b64_tr_b16 v[66:67], v20 offset:18432
v_mfma_f32_16x16x32_bf16 v[120:123], v[84:87], a[24:27], v[120:123]
ds_read_b64_tr_b16 v[68:69], v20 offset:20480
v_mfma_f32_16x16x32_bf16 v[124:127], v[84:87], a[96:99], v[124:127]
ds_read_b64_tr_b16 v[70:71], v20 offset:22528
v_mfma_f32_16x16x32_bf16 v[120:123], v[88:91], a[28:31], v[120:123]
ds_read_b64_tr_b16 v[72:73], v20 offset:24576
v_mfma_f32_16x16x32_bf16 v[124:127], v[88:91], a[100:103], v[124:127]
ds_read_b64_tr_b16 v[74:75], v20 offset:26624
v_mfma_f32_16x16x32_bf16 v[120:123], v[92:95], a[32:35], v[120:123]
ds_read_b64_tr_b16 v[76:77], v20 offset:28672
v_mfma_f32_16x16x32_bf16 v[124:127], v[92:95], a[104:107], v[124:127]
ds_read_b64_tr_b16 v[78:79], v20 offset:30720
s_waitcnt lgkmcnt(8)
v_mfma_f32_16x16x32_bf16 v[128:131], v[48:51], a[0:3], 0
ds_read_b64_tr_b16 v[80:81], v20 offset:32768
s_add_u32 m0, s32, 110592
v_mfma_f32_16x16x32_bf16 v[132:135], v[48:51], a[72:75], 0
ds_read_b64_tr_b16 v[82:83], v20 offset:34816
v_mfma_f32_16x16x32_bf16 v[128:131], v[52:55], a[4:7], v[128:131]
ds_read_b64_tr_b16 v[84:85], v21 offset:0
v_mfma_f32_16x16x32_bf16 v[132:135], v[52:55], a[76:79], v[132:135]
ds_read_b64_tr_b16 v[86:87], v21 offset:2048
s_add_u32 s34, s28, 2654464
v_mfma_f32_16x16x32_bf16 v[128:131], v[56:59], a[8:11], v[128:131]
ds_read_b64_tr_b16 v[88:89], v21 offset:4096
v_mfma_f32_16x16x32_bf16 v[132:135], v[56:59], a[80:83], v[132:135]
ds_read_b64_tr_b16 v[90:91], v21 offset:6144
v_mfma_f32_16x16x32_bf16 v[128:131], v[60:63], a[12:15], v[128:131]
ds_read_b64_tr_b16 v[92:93], v21 offset:8192
buffer_load_dwordx4 v36, s[12:15], s34 offen offset:0 lds
v_mfma_f32_16x16x32_bf16 v[132:135], v[60:63], a[84:87], v[132:135]
ds_read_b64_tr_b16 v[94:95], v21 offset:10240
s_waitcnt lgkmcnt(8)
v_mfma_f32_16x16x32_bf16 v[128:131], v[64:67], a[16:19], v[128:131]
ds_read_b64_tr_b16 v[48:49], v21 offset:12288
v_mfma_f32_16x16x32_bf16 v[132:135], v[64:67], a[88:91], v[132:135]
ds_read_b64_tr_b16 v[50:51], v21 offset:14336
v_mfma_f32_16x16x32_bf16 v[128:131], v[68:71], a[20:23], v[128:131]
ds_read_b64_tr_b16 v[52:53], v21 offset:16384
buffer_load_dwordx4 v37, s[12:15], s34 offen offset:1024 lds
v_mfma_f32_16x16x32_bf16 v[132:135], v[68:71], a[92:95], v[132:135]
ds_read_b64_tr_b16 v[54:55], v21 offset:18432
v_mfma_f32_16x16x32_bf16 v[128:131], v[72:75], a[24:27], v[128:131]
ds_read_b64_tr_b16 v[56:57], v21 offset:20480
v_mfma_f32_16x16x32_bf16 v[132:135], v[72:75], a[96:99], v[132:135]
ds_read_b64_tr_b16 v[58:59], v21 offset:22528
buffer_load_dwordx4 v38, s[12:15], s34 offen offset:2048 lds
v_mfma_f32_16x16x32_bf16 v[128:131], v[76:79], a[28:31], v[128:131]
ds_read_b64_tr_b16 v[60:61], v21 offset:24576
v_mfma_f32_16x16x32_bf16 v[132:135], v[76:79], a[100:103], v[132:135]
ds_read_b64_tr_b16 v[62:63], v21 offset:26624
s_waitcnt lgkmcnt(8)
v_mfma_f32_16x16x32_bf16 v[128:131], v[80:83], a[32:35], v[128:131]
ds_read_b64_tr_b16 v[64:65], v21 offset:28672
v_mfma_f32_16x16x32_bf16 v[132:135], v[80:83], a[104:107], v[132:135]
ds_read_b64_tr_b16 v[66:67], v21 offset:30720
buffer_load_dwordx4 v39, s[12:15], s34 offen offset:3072 lds
v_mfma_f32_16x16x32_bf16 v[136:139], v[84:87], a[0:3], 0
ds_read_b64_tr_b16 v[68:69], v21 offset:32768
v_mfma_f32_16x16x32_bf16 v[140:143], v[84:87], a[72:75], 0
ds_read_b64_tr_b16 v[70:71], v21 offset:34816
v_mfma_f32_16x16x32_bf16 v[136:139], v[88:91], a[4:7], v[136:139]
ds_read_b64_tr_b16 v[72:73], v22 offset:0
s_add_u32 m0, s32, 114688
v_mfma_f32_16x16x32_bf16 v[140:143], v[88:91], a[76:79], v[140:143]
ds_read_b64_tr_b16 v[74:75], v22 offset:2048
v_mfma_f32_16x16x32_bf16 v[136:139], v[92:95], a[8:11], v[136:139]
ds_read_b64_tr_b16 v[76:77], v22 offset:4096
v_mfma_f32_16x16x32_bf16 v[140:143], v[92:95], a[80:83], v[140:143]
ds_read_b64_tr_b16 v[78:79], v22 offset:6144
s_waitcnt lgkmcnt(8)
v_mfma_f32_16x16x32_bf16 v[136:139], v[48:51], a[12:15], v[136:139]
ds_read_b64_tr_b16 v[80:81], v22 offset:8192
s_add_u32 s34, s28, 2949376
v_mfma_f32_16x16x32_bf16 v[140:143], v[48:51], a[84:87], v[140:143]
ds_read_b64_tr_b16 v[82:83], v22 offset:10240
v_mfma_f32_16x16x32_bf16 v[136:139], v[52:55], a[16:19], v[136:139]
ds_read_b64_tr_b16 v[84:85], v22 offset:12288
v_mfma_f32_16x16x32_bf16 v[140:143], v[52:55], a[88:91], v[140:143]
ds_read_b64_tr_b16 v[86:87], v22 offset:14336
v_mfma_f32_16x16x32_bf16 v[136:139], v[56:59], a[20:23], v[136:139]
ds_read_b64_tr_b16 v[88:89], v22 offset:16384
buffer_load_dwordx4 v36, s[12:15], s34 offen offset:0 lds
v_mfma_f32_16x16x32_bf16 v[140:143], v[56:59], a[92:95], v[140:143]
ds_read_b64_tr_b16 v[90:91], v22 offset:18432
v_mfma_f32_16x16x32_bf16 v[136:139], v[60:63], a[24:27], v[136:139]
ds_read_b64_tr_b16 v[92:93], v22 offset:20480
v_mfma_f32_16x16x32_bf16 v[140:143], v[60:63], a[96:99], v[140:143]
ds_read_b64_tr_b16 v[94:95], v22 offset:22528
s_waitcnt lgkmcnt(8)
v_mfma_f32_16x16x32_bf16 v[136:139], v[64:67], a[28:31], v[136:139]
ds_read_b64_tr_b16 v[48:49], v22 offset:24576
buffer_load_dwordx4 v37, s[12:15], s34 offen offset:1024 lds
v_mfma_f32_16x16x32_bf16 v[140:143], v[64:67], a[100:103], v[140:143]
ds_read_b64_tr_b16 v[50:51], v22 offset:26624
v_mfma_f32_16x16x32_bf16 v[136:139], v[68:71], a[32:35], v[136:139]
ds_read_b64_tr_b16 v[52:53], v22 offset:28672
v_mfma_f32_16x16x32_bf16 v[140:143], v[68:71], a[104:107], v[140:143]
ds_read_b64_tr_b16 v[54:55], v22 offset:30720
buffer_load_dwordx4 v38, s[12:15], s34 offen offset:2048 lds
v_mfma_f32_16x16x32_bf16 v[144:147], v[72:75], a[0:3], 0
ds_read_b64_tr_b16 v[56:57], v22 offset:32768
v_mfma_f32_16x16x32_bf16 v[148:151], v[72:75], a[72:75], 0
ds_read_b64_tr_b16 v[58:59], v22 offset:34816
v_mfma_f32_16x16x32_bf16 v[144:147], v[76:79], a[4:7], v[144:147]
ds_read_b64_tr_b16 v[60:61], v23 offset:0
buffer_load_dwordx4 v39, s[12:15], s34 offen offset:3072 lds
v_mfma_f32_16x16x32_bf16 v[148:151], v[76:79], a[76:79], v[148:151]
ds_read_b64_tr_b16 v[62:63], v23 offset:2048
s_waitcnt lgkmcnt(8)
v_mfma_f32_16x16x32_bf16 v[144:147], v[80:83], a[8:11], v[144:147]
ds_read_b64_tr_b16 v[64:65], v23 offset:4096
v_mfma_f32_16x16x32_bf16 v[148:151], v[80:83], a[80:83], v[148:151]
ds_read_b64_tr_b16 v[66:67], v23 offset:6144
v_mfma_f32_16x16x32_bf16 v[144:147], v[84:87], a[12:15], v[144:147]
ds_read_b64_tr_b16 v[68:69], v23 offset:8192
s_add_u32 m0, s32, 118784
v_mfma_f32_16x16x32_bf16 v[148:151], v[84:87], a[84:87], v[148:151]
ds_read_b64_tr_b16 v[70:71], v23 offset:10240
v_mfma_f32_16x16x32_bf16 v[144:147], v[88:91], a[16:19], v[144:147]
ds_read_b64_tr_b16 v[72:73], v23 offset:12288
v_mfma_f32_16x16x32_bf16 v[148:151], v[88:91], a[88:91], v[148:151]
ds_read_b64_tr_b16 v[74:75], v23 offset:14336
s_add_u32 s34, s28, 3244288
v_mfma_f32_16x16x32_bf16 v[144:147], v[92:95], a[20:23], v[144:147]
ds_read_b64_tr_b16 v[76:77], v23 offset:16384
v_mfma_f32_16x16x32_bf16 v[148:151], v[92:95], a[92:95], v[148:151]
ds_read_b64_tr_b16 v[78:79], v23 offset:18432
s_waitcnt lgkmcnt(8)
v_mfma_f32_16x16x32_bf16 v[144:147], v[48:51], a[24:27], v[144:147]
ds_read_b64_tr_b16 v[80:81], v23 offset:20480
v_mfma_f32_16x16x32_bf16 v[148:151], v[48:51], a[96:99], v[148:151]
ds_read_b64_tr_b16 v[82:83], v23 offset:22528
buffer_load_dwordx4 v36, s[12:15], s34 offen offset:0 lds
v_mfma_f32_16x16x32_bf16 v[144:147], v[52:55], a[28:31], v[144:147]
ds_read_b64_tr_b16 v[84:85], v23 offset:24576
v_mfma_f32_16x16x32_bf16 v[148:151], v[52:55], a[100:103], v[148:151]
ds_read_b64_tr_b16 v[86:87], v23 offset:26624
v_mfma_f32_16x16x32_bf16 v[144:147], v[56:59], a[32:35], v[144:147]
ds_read_b64_tr_b16 v[88:89], v23 offset:28672
v_mfma_f32_16x16x32_bf16 v[148:151], v[56:59], a[104:107], v[148:151]
ds_read_b64_tr_b16 v[90:91], v23 offset:30720
s_waitcnt vmcnt(9)
v_mfma_f32_16x16x32_bf16 v[152:155], v[60:63], a[0:3], 0
ds_read_b64_tr_b16 v[92:93], v23 offset:32768
s_barrier
v_mfma_f32_16x16x32_bf16 v[156:159], v[60:63], a[72:75], 0
ds_read_b64_tr_b16 v[94:95], v23 offset:34816
s_waitcnt lgkmcnt(8)
v_mfma_f32_16x16x32_bf16 v[152:155], v[64:67], a[4:7], v[152:155]
ds_read_b64_tr_b16 v[48:49], v24 offset:0
v_mfma_f32_16x16x32_bf16 v[156:159], v[64:67], a[76:79], v[156:159]
ds_read_b64_tr_b16 v[50:51], v24 offset:2048
v_mfma_f32_16x16x32_bf16 v[152:155], v[68:71], a[8:11], v[152:155]
ds_read_b64_tr_b16 v[52:53], v24 offset:4096
v_mfma_f32_16x16x32_bf16 v[156:159], v[68:71], a[80:83], v[156:159]
ds_read_b64_tr_b16 v[54:55], v24 offset:6144
v_mfma_f32_16x16x32_bf16 v[152:155], v[72:75], a[12:15], v[152:155]
ds_read_b64_tr_b16 v[56:57], v24 offset:8192
v_mfma_f32_16x16x32_bf16 v[156:159], v[72:75], a[84:87], v[156:159]
ds_read_b64_tr_b16 v[58:59], v24 offset:10240
v_mfma_f32_16x16x32_bf16 v[152:155], v[76:79], a[16:19], v[152:155]
ds_read_b64_tr_b16 v[60:61], v24 offset:12288
v_mfma_f32_16x16x32_bf16 v[156:159], v[76:79], a[88:91], v[156:159]
ds_read_b64_tr_b16 v[62:63], v24 offset:14336
s_waitcnt lgkmcnt(8)
v_mfma_f32_16x16x32_bf16 v[152:155], v[80:83], a[20:23], v[152:155]
ds_read_b64_tr_b16 v[64:65], v24 offset:16384
v_mfma_f32_16x16x32_bf16 v[156:159], v[80:83], a[92:95], v[156:159]
ds_read_b64_tr_b16 v[66:67], v24 offset:18432
v_mfma_f32_16x16x32_bf16 v[152:155], v[84:87], a[24:27], v[152:155]
ds_read_b64_tr_b16 v[68:69], v24 offset:20480
v_mfma_f32_16x16x32_bf16 v[156:159], v[84:87], a[96:99], v[156:159]
ds_read_b64_tr_b16 v[70:71], v24 offset:22528
v_mfma_f32_16x16x32_bf16 v[152:155], v[88:91], a[28:31], v[152:155]
ds_read_b64_tr_b16 v[72:73], v24 offset:24576
v_mfma_f32_16x16x32_bf16 v[156:159], v[88:91], a[100:103], v[156:159]
ds_read_b64_tr_b16 v[74:75], v24 offset:26624
v_mfma_f32_16x16x32_bf16 v[152:155], v[92:95], a[32:35], v[152:155]
ds_read_b64_tr_b16 v[76:77], v24 offset:28672
v_mfma_f32_16x16x32_bf16 v[156:159], v[92:95], a[104:107], v[156:159]
ds_read_b64_tr_b16 v[78:79], v24 offset:30720
s_waitcnt lgkmcnt(8)
v_mfma_f32_16x16x32_bf16 v[96:99], v[48:51], a[36:39], v[96:99]
ds_read_b64_tr_b16 v[80:81], v24 offset:32768
s_add_u32 m0, s32, 0
v_mfma_f32_16x16x32_bf16 v[100:103], v[48:51], a[108:111], v[100:103]
ds_read_b64_tr_b16 v[82:83], v24 offset:34816
v_mfma_f32_16x16x32_bf16 v[96:99], v[52:55], a[40:43], v[96:99]
ds_read_b64_tr_b16 v[84:85], v25 offset:0
v_mfma_f32_16x16x32_bf16 v[100:103], v[52:55], a[112:115], v[100:103]
ds_read_b64_tr_b16 v[86:87], v25 offset:2048
s_add_u32 s34, s28, 384
v_mfma_f32_16x16x32_bf16 v[96:99], v[56:59], a[44:47], v[96:99]
ds_read_b64_tr_b16 v[88:89], v25 offset:4096
v_mfma_f32_16x16x32_bf16 v[100:103], v[56:59], a[116:119], v[100:103]
ds_read_b64_tr_b16 v[90:91], v25 offset:6144
v_mfma_f32_16x16x32_bf16 v[96:99], v[60:63], a[48:51], v[96:99]
ds_read_b64_tr_b16 v[92:93], v25 offset:8192
buffer_load_dwordx4 v36, s[8:11], s34 offen offset:0 lds
v_mfma_f32_16x16x32_bf16 v[100:103], v[60:63], a[120:123], v[100:103]
ds_read_b64_tr_b16 v[94:95], v25 offset:10240
s_waitcnt lgkmcnt(8)
v_mfma_f32_16x16x32_bf16 v[96:99], v[64:67], a[52:55], v[96:99]
ds_read_b64_tr_b16 v[48:49], v25 offset:12288
v_mfma_f32_16x16x32_bf16 v[100:103], v[64:67], a[124:127], v[100:103]
ds_read_b64_tr_b16 v[50:51], v25 offset:14336
v_mfma_f32_16x16x32_bf16 v[96:99], v[68:71], a[56:59], v[96:99]
ds_read_b64_tr_b16 v[52:53], v25 offset:16384
buffer_load_dwordx4 v37, s[8:11], s34 offen offset:1024 lds
v_mfma_f32_16x16x32_bf16 v[100:103], v[68:71], a[128:131], v[100:103]
ds_read_b64_tr_b16 v[54:55], v25 offset:18432
v_mfma_f32_16x16x32_bf16 v[96:99], v[72:75], a[60:63], v[96:99]
ds_read_b64_tr_b16 v[56:57], v25 offset:20480
v_mfma_f32_16x16x32_bf16 v[100:103], v[72:75], a[132:135], v[100:103]
ds_read_b64_tr_b16 v[58:59], v25 offset:22528
buffer_load_dwordx4 v38, s[8:11], s34 offen offset:2048 lds
v_mfma_f32_16x16x32_bf16 v[96:99], v[76:79], a[64:67], v[96:99]
ds_read_b64_tr_b16 v[60:61], v25 offset:24576
v_mfma_f32_16x16x32_bf16 v[100:103], v[76:79], a[136:139], v[100:103]
ds_read_b64_tr_b16 v[62:63], v25 offset:26624
s_waitcnt lgkmcnt(8)
v_mfma_f32_16x16x32_bf16 v[96:99], v[80:83], a[68:71], v[96:99]
ds_read_b64_tr_b16 v[64:65], v25 offset:28672
v_mfma_f32_16x16x32_bf16 v[100:103], v[80:83], a[140:143], v[100:103]
ds_read_b64_tr_b16 v[66:67], v25 offset:30720
buffer_load_dwordx4 v39, s[8:11], s34 offen offset:3072 lds
v_mfma_f32_16x16x32_bf16 v[104:107], v[84:87], a[36:39], v[104:107]
ds_read_b64_tr_b16 v[68:69], v25 offset:32768
v_mfma_f32_16x16x32_bf16 v[108:111], v[84:87], a[108:111], v[108:111]
ds_read_b64_tr_b16 v[70:71], v25 offset:34816
v_mfma_f32_16x16x32_bf16 v[104:107], v[88:91], a[40:43], v[104:107]
ds_read_b64_tr_b16 v[72:73], v26 offset:0
s_add_u32 m0, s32, 4096
v_mfma_f32_16x16x32_bf16 v[108:111], v[88:91], a[112:115], v[108:111]
ds_read_b64_tr_b16 v[74:75], v26 offset:2048
v_mfma_f32_16x16x32_bf16 v[104:107], v[92:95], a[44:47], v[104:107]
ds_read_b64_tr_b16 v[76:77], v26 offset:4096
v_mfma_f32_16x16x32_bf16 v[108:111], v[92:95], a[116:119], v[108:111]
ds_read_b64_tr_b16 v[78:79], v26 offset:6144
s_waitcnt lgkmcnt(8)
v_mfma_f32_16x16x32_bf16 v[104:107], v[48:51], a[48:51], v[104:107]
ds_read_b64_tr_b16 v[80:81], v26 offset:8192
s_add_u32 s34, s28, 295296
v_mfma_f32_16x16x32_bf16 v[108:111], v[48:51], a[120:123], v[108:111]
ds_read_b64_tr_b16 v[82:83], v26 offset:10240
v_mfma_f32_16x16x32_bf16 v[104:107], v[52:55], a[52:55], v[104:107]
ds_read_b64_tr_b16 v[84:85], v26 offset:12288
v_mfma_f32_16x16x32_bf16 v[108:111], v[52:55], a[124:127], v[108:111]
ds_read_b64_tr_b16 v[86:87], v26 offset:14336
v_mfma_f32_16x16x32_bf16 v[104:107], v[56:59], a[56:59], v[104:107]
ds_read_b64_tr_b16 v[88:89], v26 offset:16384
buffer_load_dwordx4 v36, s[8:11], s34 offen offset:0 lds
v_mfma_f32_16x16x32_bf16 v[108:111], v[56:59], a[128:131], v[108:111]
ds_read_b64_tr_b16 v[90:91], v26 offset:18432
v_mfma_f32_16x16x32_bf16 v[104:107], v[60:63], a[60:63], v[104:107]
ds_read_b64_tr_b16 v[92:93], v26 offset:20480
v_mfma_f32_16x16x32_bf16 v[108:111], v[60:63], a[132:135], v[108:111]
ds_read_b64_tr_b16 v[94:95], v26 offset:22528
s_waitcnt lgkmcnt(8)
v_mfma_f32_16x16x32_bf16 v[104:107], v[64:67], a[64:67], v[104:107]
ds_read_b64_tr_b16 v[48:49], v26 offset:24576
buffer_load_dwordx4 v37, s[8:11], s34 offen offset:1024 lds
v_mfma_f32_16x16x32_bf16 v[108:111], v[64:67], a[136:139], v[108:111]
ds_read_b64_tr_b16 v[50:51], v26 offset:26624
v_mfma_f32_16x16x32_bf16 v[104:107], v[68:71], a[68:71], v[104:107]
ds_read_b64_tr_b16 v[52:53], v26 offset:28672
v_mfma_f32_16x16x32_bf16 v[108:111], v[68:71], a[140:143], v[108:111]
ds_read_b64_tr_b16 v[54:55], v26 offset:30720
buffer_load_dwordx4 v38, s[8:11], s34 offen offset:2048 lds
v_mfma_f32_16x16x32_bf16 v[112:115], v[72:75], a[36:39], v[112:115]
ds_read_b64_tr_b16 v[56:57], v26 offset:32768
v_mfma_f32_16x16x32_bf16 v[116:119], v[72:75], a[108:111], v[116:119]
ds_read_b64_tr_b16 v[58:59], v26 offset:34816
v_mfma_f32_16x16x32_bf16 v[112:115], v[76:79], a[40:43], v[112:115]
ds_read_b64_tr_b16 v[60:61], v27 offset:0
buffer_load_dwordx4 v39, s[8:11], s34 offen offset:3072 lds
v_mfma_f32_16x16x32_bf16 v[116:119], v[76:79], a[112:115], v[116:119]
ds_read_b64_tr_b16 v[62:63], v27 offset:2048
s_waitcnt lgkmcnt(8)
v_mfma_f32_16x16x32_bf16 v[112:115], v[80:83], a[44:47], v[112:115]
ds_read_b64_tr_b16 v[64:65], v27 offset:4096
v_mfma_f32_16x16x32_bf16 v[116:119], v[80:83], a[116:119], v[116:119]
ds_read_b64_tr_b16 v[66:67], v27 offset:6144
v_mfma_f32_16x16x32_bf16 v[112:115], v[84:87], a[48:51], v[112:115]
ds_read_b64_tr_b16 v[68:69], v27 offset:8192
s_add_u32 m0, s32, 8192
v_mfma_f32_16x16x32_bf16 v[116:119], v[84:87], a[120:123], v[116:119]
ds_read_b64_tr_b16 v[70:71], v27 offset:10240
v_mfma_f32_16x16x32_bf16 v[112:115], v[88:91], a[52:55], v[112:115]
ds_read_b64_tr_b16 v[72:73], v27 offset:12288
v_mfma_f32_16x16x32_bf16 v[116:119], v[88:91], a[124:127], v[116:119]
ds_read_b64_tr_b16 v[74:75], v27 offset:14336
s_add_u32 s34, s28, 590208
v_mfma_f32_16x16x32_bf16 v[112:115], v[92:95], a[56:59], v[112:115]
ds_read_b64_tr_b16 v[76:77], v27 offset:16384
v_mfma_f32_16x16x32_bf16 v[116:119], v[92:95], a[128:131], v[116:119]
ds_read_b64_tr_b16 v[78:79], v27 offset:18432
s_waitcnt lgkmcnt(8)
v_mfma_f32_16x16x32_bf16 v[112:115], v[48:51], a[60:63], v[112:115]
ds_read_b64_tr_b16 v[80:81], v27 offset:20480
v_mfma_f32_16x16x32_bf16 v[116:119], v[48:51], a[132:135], v[116:119]
ds_read_b64_tr_b16 v[82:83], v27 offset:22528
buffer_load_dwordx4 v36, s[8:11], s34 offen offset:0 lds
v_mfma_f32_16x16x32_bf16 v[112:115], v[52:55], a[64:67], v[112:115]
ds_read_b64_tr_b16 v[84:85], v27 offset:24576
v_mfma_f32_16x16x32_bf16 v[116:119], v[52:55], a[136:139], v[116:119]
ds_read_b64_tr_b16 v[86:87], v27 offset:26624
v_mfma_f32_16x16x32_bf16 v[112:115], v[56:59], a[68:71], v[112:115]
ds_read_b64_tr_b16 v[88:89], v27 offset:28672
v_mfma_f32_16x16x32_bf16 v[116:119], v[56:59], a[140:143], v[116:119]
ds_read_b64_tr_b16 v[90:91], v27 offset:30720
s_waitcnt vmcnt(9)
v_mfma_f32_16x16x32_bf16 v[120:123], v[60:63], a[36:39], v[120:123]
ds_read_b64_tr_b16 v[92:93], v27 offset:32768
s_barrier
v_mfma_f32_16x16x32_bf16 v[124:127], v[60:63], a[108:111], v[124:127]
ds_read_b64_tr_b16 v[94:95], v27 offset:34816
s_waitcnt lgkmcnt(8)
v_mfma_f32_16x16x32_bf16 v[120:123], v[64:67], a[40:43], v[120:123]
ds_read_b64_tr_b16 v[48:49], v28 offset:0
v_mfma_f32_16x16x32_bf16 v[124:127], v[64:67], a[112:115], v[124:127]
ds_read_b64_tr_b16 v[50:51], v28 offset:2048
v_mfma_f32_16x16x32_bf16 v[120:123], v[68:71], a[44:47], v[120:123]
ds_read_b64_tr_b16 v[52:53], v28 offset:4096
v_mfma_f32_16x16x32_bf16 v[124:127], v[68:71], a[116:119], v[124:127]
ds_read_b64_tr_b16 v[54:55], v28 offset:6144
v_mfma_f32_16x16x32_bf16 v[120:123], v[72:75], a[48:51], v[120:123]
ds_read_b64_tr_b16 v[56:57], v28 offset:8192
v_mfma_f32_16x16x32_bf16 v[124:127], v[72:75], a[120:123], v[124:127]
ds_read_b64_tr_b16 v[58:59], v28 offset:10240
v_mfma_f32_16x16x32_bf16 v[120:123], v[76:79], a[52:55], v[120:123]
ds_read_b64_tr_b16 v[60:61], v28 offset:12288
v_mfma_f32_16x16x32_bf16 v[124:127], v[76:79], a[124:127], v[124:127]
ds_read_b64_tr_b16 v[62:63], v28 offset:14336
s_waitcnt lgkmcnt(8)
v_mfma_f32_16x16x32_bf16 v[120:123], v[80:83], a[56:59], v[120:123]
ds_read_b64_tr_b16 v[64:65], v28 offset:16384
v_mfma_f32_16x16x32_bf16 v[124:127], v[80:83], a[128:131], v[124:127]
ds_read_b64_tr_b16 v[66:67], v28 offset:18432
v_mfma_f32_16x16x32_bf16 v[120:123], v[84:87], a[60:63], v[120:123]
ds_read_b64_tr_b16 v[68:69], v28 offset:20480
v_mfma_f32_16x16x32_bf16 v[124:127], v[84:87], a[132:135], v[124:127]
ds_read_b64_tr_b16 v[70:71], v28 offset:22528
v_mfma_f32_16x16x32_bf16 v[120:123], v[88:91], a[64:67], v[120:123]
ds_read_b64_tr_b16 v[72:73], v28 offset:24576
v_mfma_f32_16x16x32_bf16 v[124:127], v[88:91], a[136:139], v[124:127]
ds_read_b64_tr_b16 v[74:75], v28 offset:26624
v_mfma_f32_16x16x32_bf16 v[120:123], v[92:95], a[68:71], v[120:123]
ds_read_b64_tr_b16 v[76:77], v28 offset:28672
v_mfma_f32_16x16x32_bf16 v[124:127], v[92:95], a[140:143], v[124:127]
ds_read_b64_tr_b16 v[78:79], v28 offset:30720
s_waitcnt lgkmcnt(8)
v_mfma_f32_16x16x32_bf16 v[128:131], v[48:51], a[36:39], v[128:131]
ds_read_b64_tr_b16 v[80:81], v28 offset:32768
s_add_u32 m0, s32, 36864
v_mfma_f32_16x16x32_bf16 v[132:135], v[48:51], a[108:111], v[132:135]
ds_read_b64_tr_b16 v[82:83], v28 offset:34816
v_mfma_f32_16x16x32_bf16 v[128:131], v[52:55], a[40:43], v[128:131]
ds_read_b64_tr_b16 v[84:85], v29 offset:0
v_mfma_f32_16x16x32_bf16 v[132:135], v[52:55], a[112:115], v[132:135]
ds_read_b64_tr_b16 v[86:87], v29 offset:2048
s_add_u32 s34, s28, 384
v_mfma_f32_16x16x32_bf16 v[128:131], v[56:59], a[44:47], v[128:131]
ds_read_b64_tr_b16 v[88:89], v29 offset:4096
v_mfma_f32_16x16x32_bf16 v[132:135], v[56:59], a[116:119], v[132:135]
ds_read_b64_tr_b16 v[90:91], v29 offset:6144
v_mfma_f32_16x16x32_bf16 v[128:131], v[60:63], a[48:51], v[128:131]
ds_read_b64_tr_b16 v[92:93], v29 offset:8192
buffer_load_dwordx4 v36, s[12:15], s34 offen offset:0 lds
v_mfma_f32_16x16x32_bf16 v[132:135], v[60:63], a[120:123], v[132:135]
ds_read_b64_tr_b16 v[94:95], v29 offset:10240
s_waitcnt lgkmcnt(8)
v_mfma_f32_16x16x32_bf16 v[128:131], v[64:67], a[52:55], v[128:131]
ds_read_b64_tr_b16 v[48:49], v29 offset:12288
v_mfma_f32_16x16x32_bf16 v[132:135], v[64:67], a[124:127], v[132:135]
ds_read_b64_tr_b16 v[50:51], v29 offset:14336
v_mfma_f32_16x16x32_bf16 v[128:131], v[68:71], a[56:59], v[128:131]
ds_read_b64_tr_b16 v[52:53], v29 offset:16384
buffer_load_dwordx4 v37, s[12:15], s34 offen offset:1024 lds
v_mfma_f32_16x16x32_bf16 v[132:135], v[68:71], a[128:131], v[132:135]
ds_read_b64_tr_b16 v[54:55], v29 offset:18432
v_mfma_f32_16x16x32_bf16 v[128:131], v[72:75], a[60:63], v[128:131]
ds_read_b64_tr_b16 v[56:57], v29 offset:20480
v_mfma_f32_16x16x32_bf16 v[132:135], v[72:75], a[132:135], v[132:135]
ds_read_b64_tr_b16 v[58:59], v29 offset:22528
buffer_load_dwordx4 v38, s[12:15], s34 offen offset:2048 lds
v_mfma_f32_16x16x32_bf16 v[128:131], v[76:79], a[64:67], v[128:131]
ds_read_b64_tr_b16 v[60:61], v29 offset:24576
v_mfma_f32_16x16x32_bf16 v[132:135], v[76:79], a[136:139], v[132:135]
ds_read_b64_tr_b16 v[62:63], v29 offset:26624
s_waitcnt lgkmcnt(8)
v_mfma_f32_16x16x32_bf16 v[128:131], v[80:83], a[68:71], v[128:131]
ds_read_b64_tr_b16 v[64:65], v29 offset:28672
v_mfma_f32_16x16x32_bf16 v[132:135], v[80:83], a[140:143], v[132:135]
ds_read_b64_tr_b16 v[66:67], v29 offset:30720
buffer_load_dwordx4 v39, s[12:15], s34 offen offset:3072 lds
v_mfma_f32_16x16x32_bf16 v[136:139], v[84:87], a[36:39], v[136:139]
ds_read_b64_tr_b16 v[68:69], v29 offset:32768
v_mfma_f32_16x16x32_bf16 v[140:143], v[84:87], a[108:111], v[140:143]
ds_read_b64_tr_b16 v[70:71], v29 offset:34816
v_mfma_f32_16x16x32_bf16 v[136:139], v[88:91], a[40:43], v[136:139]
ds_read_b64_tr_b16 v[72:73], v30 offset:0
s_add_u32 m0, s32, 40960
v_mfma_f32_16x16x32_bf16 v[140:143], v[88:91], a[112:115], v[140:143]
ds_read_b64_tr_b16 v[74:75], v30 offset:2048
v_mfma_f32_16x16x32_bf16 v[136:139], v[92:95], a[44:47], v[136:139]
ds_read_b64_tr_b16 v[76:77], v30 offset:4096
v_mul_f32 v96, v96, v128
v_mfma_f32_16x16x32_bf16 v[140:143], v[92:95], a[116:119], v[140:143]
ds_read_b64_tr_b16 v[78:79], v30 offset:6144
s_waitcnt lgkmcnt(8)
v_mfma_f32_16x16x32_bf16 v[136:139], v[48:51], a[48:51], v[136:139]
ds_read_b64_tr_b16 v[80:81], v30 offset:8192
s_add_u32 s34, s28, 295296
v_mfma_f32_16x16x32_bf16 v[140:143], v[48:51], a[120:123], v[140:143]
ds_read_b64_tr_b16 v[82:83], v30 offset:10240
v_mul_f32 v97, v97, v129
v_mfma_f32_16x16x32_bf16 v[136:139], v[52:55], a[52:55], v[136:139]
ds_read_b64_tr_b16 v[84:85], v30 offset:12288
v_mul_f32 v98, v98, v130
v_mfma_f32_16x16x32_bf16 v[140:143], v[52:55], a[124:127], v[140:143]
ds_read_b64_tr_b16 v[86:87], v30 offset:14336
v_mul_f32 v99, v99, v131
v_mfma_f32_16x16x32_bf16 v[136:139], v[56:59], a[56:59], v[136:139]
ds_read_b64_tr_b16 v[88:89], v30 offset:16384
buffer_load_dwordx4 v36, s[12:15], s34 offen offset:0 lds
v_mfma_f32_16x16x32_bf16 v[140:143], v[56:59], a[128:131], v[140:143]
ds_read_b64_tr_b16 v[90:91], v30 offset:18432
v_cvt_pk_bf16_f32 v192, v96, v97
v_mfma_f32_16x16x32_bf16 v[136:139], v[60:63], a[60:63], v[136:139]
ds_read_b64_tr_b16 v[92:93], v30 offset:20480
v_cvt_pk_bf16_f32 v193, v98, v99
v_mfma_f32_16x16x32_bf16 v[140:143], v[60:63], a[132:135], v[140:143]
ds_read_b64_tr_b16 v[94:95], v30 offset:22528
s_waitcnt lgkmcnt(8)
v_mfma_f32_16x16x32_bf16 v[136:139], v[64:67], a[64:67], v[136:139]
ds_read_b64_tr_b16 v[48:49], v30 offset:24576
buffer_load_dwordx4 v37, s[12:15], s34 offen offset:1024 lds
v_mfma_f32_16x16x32_bf16 v[140:143], v[64:67], a[136:139], v[140:143]
ds_read_b64_tr_b16 v[50:51], v30 offset:26624
v_mul_f32 v100, v100, v132
v_mfma_f32_16x16x32_bf16 v[136:139], v[68:71], a[68:71], v[136:139]
ds_read_b64_tr_b16 v[52:53], v30 offset:28672
v_mul_f32 v101, v101, v133
v_mfma_f32_16x16x32_bf16 v[140:143], v[68:71], a[140:143], v[140:143]
ds_read_b64_tr_b16 v[54:55], v30 offset:30720
buffer_load_dwordx4 v38, s[12:15], s34 offen offset:2048 lds
v_mfma_f32_16x16x32_bf16 v[144:147], v[72:75], a[36:39], v[144:147]
ds_read_b64_tr_b16 v[56:57], v30 offset:32768
v_mul_f32 v102, v102, v134
v_mfma_f32_16x16x32_bf16 v[148:151], v[72:75], a[108:111], v[148:151]
ds_read_b64_tr_b16 v[58:59], v30 offset:34816
v_mul_f32 v103, v103, v135
v_mfma_f32_16x16x32_bf16 v[144:147], v[76:79], a[40:43], v[144:147]
ds_read_b64_tr_b16 v[60:61], v31 offset:0
buffer_load_dwordx4 v39, s[12:15], s34 offen offset:3072 lds
v_mfma_f32_16x16x32_bf16 v[148:151], v[76:79], a[112:115], v[148:151]
ds_read_b64_tr_b16 v[62:63], v31 offset:2048
s_waitcnt lgkmcnt(8)
v_mfma_f32_16x16x32_bf16 v[144:147], v[80:83], a[44:47], v[144:147]
ds_read_b64_tr_b16 v[64:65], v31 offset:4096
v_cvt_pk_bf16_f32 v196, v100, v101
v_mfma_f32_16x16x32_bf16 v[148:151], v[80:83], a[116:119], v[148:151]
ds_read_b64_tr_b16 v[66:67], v31 offset:6144
v_cvt_pk_bf16_f32 v197, v102, v103
v_mfma_f32_16x16x32_bf16 v[144:147], v[84:87], a[48:51], v[144:147]
ds_read_b64_tr_b16 v[68:69], v31 offset:8192
s_add_u32 m0, s32, 45056
v_mfma_f32_16x16x32_bf16 v[148:151], v[84:87], a[120:123], v[148:151]
ds_read_b64_tr_b16 v[70:71], v31 offset:10240
v_mul_f32 v104, v104, v136
v_mfma_f32_16x16x32_bf16 v[144:147], v[88:91], a[52:55], v[144:147]
ds_read_b64_tr_b16 v[72:73], v31 offset:12288
v_mul_f32 v105, v105, v137
v_mfma_f32_16x16x32_bf16 v[148:151], v[88:91], a[124:127], v[148:151]
ds_read_b64_tr_b16 v[74:75], v31 offset:14336
s_add_u32 s34, s28, 590208
v_mfma_f32_16x16x32_bf16 v[144:147], v[92:95], a[56:59], v[144:147]
ds_read_b64_tr_b16 v[76:77], v31 offset:16384
v_mul_f32 v106, v106, v138
v_mfma_f32_16x16x32_bf16 v[148:151], v[92:95], a[128:131], v[148:151]
ds_read_b64_tr_b16 v[78:79], v31 offset:18432
s_waitcnt lgkmcnt(8)
v_mfma_f32_16x16x32_bf16 v[144:147], v[48:51], a[60:63], v[144:147]
ds_read_b64_tr_b16 v[80:81], v31 offset:20480
v_mul_f32 v107, v107, v139
v_mfma_f32_16x16x32_bf16 v[148:151], v[48:51], a[132:135], v[148:151]
ds_read_b64_tr_b16 v[82:83], v31 offset:22528
buffer_load_dwordx4 v36, s[12:15], s34 offen offset:0 lds
v_mfma_f32_16x16x32_bf16 v[144:147], v[52:55], a[64:67], v[144:147]
ds_read_b64_tr_b16 v[84:85], v31 offset:24576
v_cvt_pk_bf16_f32 v194, v104, v105
v_mfma_f32_16x16x32_bf16 v[148:151], v[52:55], a[136:139], v[148:151]
ds_read_b64_tr_b16 v[86:87], v31 offset:26624
v_cvt_pk_bf16_f32 v195, v106, v107
L_mlp_pad4:
s_cbranch_execz L_mlp_pad8
v_mfma_f32_16x16x32_bf16 v[144:147], v[56:59], a[68:71], v[144:147]
ds_read_b64_tr_b16 v[88:89], v31 offset:28672
v_mul_f32 v108, v108, v140
v_mfma_f32_16x16x32_bf16 v[148:151], v[56:59], a[140:143], v[148:151]
ds_read_b64_tr_b16 v[90:91], v31 offset:30720
s_waitcnt vmcnt(9)
v_mfma_f32_16x16x32_bf16 v[152:155], v[60:63], a[36:39], v[152:155]
ds_read_b64_tr_b16 v[92:93], v31 offset:32768
s_barrier
v_mfma_f32_16x16x32_bf16 v[156:159], v[60:63], a[108:111], v[156:159]
ds_read_b64_tr_b16 v[94:95], v31 offset:34816
s_waitcnt lgkmcnt(8)
v_mfma_f32_16x16x32_bf16 v[152:155], v[64:67], a[40:43], v[152:155]
ds_read_b64_tr_b16 v[48:49], v16 offset:0
v_mul_f32 v109, v109, v141
v_mfma_f32_16x16x32_bf16 v[156:159], v[64:67], a[112:115], v[156:159]
ds_read_b64_tr_b16 v[50:51], v16 offset:2048
v_mul_f32 v110, v110, v142
v_mfma_f32_16x16x32_bf16 v[152:155], v[68:71], a[44:47], v[152:155]
ds_read_b64_tr_b16 v[52:53], v16 offset:4096
v_mul_f32 v111, v111, v143
v_mfma_f32_16x16x32_bf16 v[156:159], v[68:71], a[116:119], v[156:159]
ds_read_b64_tr_b16 v[54:55], v16 offset:6144
v_cvt_pk_bf16_f32 v198, v108, v109
v_mfma_f32_16x16x32_bf16 v[152:155], v[72:75], a[48:51], v[152:155]
ds_read_b64_tr_b16 v[56:57], v16 offset:8192
v_cvt_pk_bf16_f32 v199, v110, v111
v_mfma_f32_16x16x32_bf16 v[156:159], v[72:75], a[120:123], v[156:159]
ds_read_b64_tr_b16 v[58:59], v16 offset:10240
v_mul_f32 v112, v112, v144
v_mfma_f32_16x16x32_bf16 v[152:155], v[76:79], a[52:55], v[152:155]
ds_read_b64_tr_b16 v[60:61], v16 offset:12288
v_mul_f32 v113, v113, v145
v_mfma_f32_16x16x32_bf16 v[156:159], v[76:79], a[124:127], v[156:159]
ds_read_b64_tr_b16 v[62:63], v16 offset:14336
s_waitcnt lgkmcnt(8)
v_mfma_f32_16x16x32_bf16 v[152:155], v[80:83], a[56:59], v[152:155]
ds_read_b64_tr_b16 v[64:65], v16 offset:16384
v_mul_f32 v114, v114, v146
v_mfma_f32_16x16x32_bf16 v[156:159], v[80:83], a[128:131], v[156:159]
ds_read_b64_tr_b16 v[66:67], v16 offset:18432
v_mul_f32 v115, v115, v147
v_mfma_f32_16x16x32_bf16 v[152:155], v[84:87], a[60:63], v[152:155]
ds_read_b64_tr_b16 v[68:69], v16 offset:20480
v_cvt_pk_bf16_f32 v200, v112, v113
v_mfma_f32_16x16x32_bf16 v[156:159], v[84:87], a[132:135], v[156:159]
ds_read_b64_tr_b16 v[70:71], v16 offset:22528
v_cvt_pk_bf16_f32 v201, v114, v115
v_mfma_f32_16x16x32_bf16 v[152:155], v[88:91], a[64:67], v[152:155]
ds_read_b64_tr_b16 v[72:73], v16 offset:24576
v_mul_f32 v116, v116, v148
v_mfma_f32_16x16x32_bf16 v[156:159], v[88:91], a[136:139], v[156:159]
ds_read_b64_tr_b16 v[74:75], v16 offset:26624
v_mul_f32 v117, v117, v149
v_mfma_f32_16x16x32_bf16 v[152:155], v[92:95], a[68:71], v[152:155]
ds_read_b64_tr_b16 v[76:77], v16 offset:28672
v_mul_f32 v118, v118, v150
v_mfma_f32_16x16x32_bf16 v[156:159], v[92:95], a[140:143], v[156:159]
ds_read_b64_tr_b16 v[78:79], v16 offset:30720
s_waitcnt lgkmcnt(8)
v_mfma_f32_16x16x32_bf16 v[96:99], v[48:51], a[0:3], 0
ds_read_b64_tr_b16 v[80:81], v16 offset:32768
v_mul_f32 v119, v119, v151
v_mfma_f32_16x16x32_bf16 v[100:103], v[48:51], a[72:75], 0
ds_read_b64_tr_b16 v[82:83], v16 offset:34816
v_cvt_pk_bf16_f32 v204, v116, v117
v_mfma_f32_16x16x32_bf16 v[96:99], v[52:55], a[4:7], v[96:99]
ds_read_b64_tr_b16 v[84:85], v17 offset:0
v_cvt_pk_bf16_f32 v205, v118, v119
v_mfma_f32_16x16x32_bf16 v[100:103], v[52:55], a[76:79], v[100:103]
ds_read_b64_tr_b16 v[86:87], v17 offset:2048
s_add_u32 m0, s32, 73728
v_mfma_f32_16x16x32_bf16 v[96:99], v[56:59], a[8:11], v[96:99]
ds_read_b64_tr_b16 v[88:89], v17 offset:4096
v_mul_f32 v120, v120, v152
v_mfma_f32_16x16x32_bf16 v[100:103], v[56:59], a[80:83], v[100:103]
ds_read_b64_tr_b16 v[90:91], v17 offset:6144
v_mul_f32 v121, v121, v153
v_mfma_f32_16x16x32_bf16 v[96:99], v[60:63], a[12:15], v[96:99]
ds_read_b64_tr_b16 v[92:93], v17 offset:8192
v_mul_f32 v122, v122, v154
v_mfma_f32_16x16x32_bf16 v[100:103], v[60:63], a[84:87], v[100:103]
ds_read_b64_tr_b16 v[94:95], v17 offset:10240
s_waitcnt lgkmcnt(8)
v_mfma_f32_16x16x32_bf16 v[96:99], v[64:67], a[16:19], v[96:99]
ds_read_b64_tr_b16 v[48:49], v17 offset:12288
v_mul_f32 v123, v123, v155
v_mfma_f32_16x16x32_bf16 v[100:103], v[64:67], a[88:91], v[100:103]
ds_read_b64_tr_b16 v[50:51], v17 offset:14336
v_cvt_pk_bf16_f32 v202, v120, v121
v_mfma_f32_16x16x32_bf16 v[96:99], v[68:71], a[20:23], v[96:99]
ds_read_b64_tr_b16 v[52:53], v17 offset:16384
v_cvt_pk_bf16_f32 v203, v122, v123
v_mfma_f32_16x16x32_bf16 v[100:103], v[68:71], a[92:95], v[100:103]
ds_read_b64_tr_b16 v[54:55], v17 offset:18432
v_mul_f32 v124, v124, v156
v_mfma_f32_16x16x32_bf16 v[96:99], v[72:75], a[24:27], v[96:99]
ds_read_b64_tr_b16 v[56:57], v17 offset:20480
v_mul_f32 v125, v125, v157
v_mfma_f32_16x16x32_bf16 v[100:103], v[72:75], a[96:99], v[100:103]
ds_read_b64_tr_b16 v[58:59], v17 offset:22528
v_mul_f32 v126, v126, v158
v_mfma_f32_16x16x32_bf16 v[96:99], v[76:79], a[28:31], v[96:99]
ds_read_b64_tr_b16 v[60:61], v17 offset:24576
v_mul_f32 v127, v127, v159
v_mfma_f32_16x16x32_bf16 v[100:103], v[76:79], a[100:103], v[100:103]
ds_read_b64_tr_b16 v[62:63], v17 offset:26624
s_waitcnt lgkmcnt(8)
v_mfma_f32_16x16x32_bf16 v[96:99], v[80:83], a[32:35], v[96:99]
ds_read_b64_tr_b16 v[64:65], v17 offset:28672
v_cvt_pk_bf16_f32 v206, v124, v125
v_mfma_f32_16x16x32_bf16 v[100:103], v[80:83], a[104:107], v[100:103]
ds_read_b64_tr_b16 v[66:67], v17 offset:30720
v_cvt_pk_bf16_f32 v207, v126, v127
v_mfma_f32_16x16x32_bf16 v[104:107], v[84:87], a[0:3], 0
ds_read_b64_tr_b16 v[68:69], v17 offset:32768
v_mfma_f32_16x16x32_bf16 v[108:111], v[84:87], a[72:75], 0
ds_read_b64_tr_b16 v[70:71], v17 offset:34816
s_add_u32 s34, s28, 2654592
v_mfma_f32_16x16x32_bf16 v[104:107], v[88:91], a[4:7], v[104:107]
ds_read_b64_tr_b16 v[72:73], v18 offset:0
v_mfma_f32_16x16x32_bf16 v[108:111], v[88:91], a[76:79], v[108:111]
ds_read_b64_tr_b16 v[74:75], v18 offset:2048
buffer_load_dwordx4 v36, s[8:11], s34 offen offset:0 lds
v_mfma_f32_16x16x32_bf16 v[104:107], v[92:95], a[8:11], v[104:107]
ds_read_b64_tr_b16 v[76:77], v18 offset:4096
v_mfma_f32_16x16x32_bf16 v[108:111], v[92:95], a[80:83], v[108:111]
ds_read_b64_tr_b16 v[78:79], v18 offset:6144
s_waitcnt lgkmcnt(8)
v_mfma_f32_16x16x32_bf16 v[104:107], v[48:51], a[12:15], v[104:107]
ds_read_b64_tr_b16 v[80:81], v18 offset:8192
buffer_load_dwordx4 v37, s[8:11], s34 offen offset:1024 lds
v_mfma_f32_16x16x32_bf16 v[108:111], v[48:51], a[84:87], v[108:111]
ds_read_b64_tr_b16 v[82:83], v18 offset:10240
v_mfma_f32_16x16x32_bf16 v[104:107], v[52:55], a[16:19], v[104:107]
ds_read_b64_tr_b16 v[84:85], v18 offset:12288
buffer_load_dwordx4 v38, s[8:11], s34 offen offset:2048 lds
v_mfma_f32_16x16x32_bf16 v[108:111], v[52:55], a[88:91], v[108:111]
ds_read_b64_tr_b16 v[86:87], v18 offset:14336
v_mfma_f32_16x16x32_bf16 v[104:107], v[56:59], a[20:23], v[104:107]
ds_read_b64_tr_b16 v[88:89], v18 offset:16384
buffer_load_dwordx4 v39, s[8:11], s34 offen offset:3072 lds
v_mfma_f32_16x16x32_bf16 v[108:111], v[56:59], a[92:95], v[108:111]
ds_read_b64_tr_b16 v[90:91], v18 offset:18432
v_mfma_f32_16x16x32_bf16 v[104:107], v[60:63], a[24:27], v[104:107]
ds_read_b64_tr_b16 v[92:93], v18 offset:20480
s_add_u32 m0, s32, 77824
v_mfma_f32_16x16x32_bf16 v[108:111], v[60:63], a[96:99], v[108:111]
ds_read_b64_tr_b16 v[94:95], v18 offset:22528
s_waitcnt lgkmcnt(8)
v_mfma_f32_16x16x32_bf16 v[104:107], v[64:67], a[28:31], v[104:107]
ds_read_b64_tr_b16 v[48:49], v18 offset:24576
v_mfma_f32_16x16x32_bf16 v[108:111], v[64:67], a[100:103], v[108:111]
ds_read_b64_tr_b16 v[50:51], v18 offset:26624
s_add_u32 s34, s28, 2949504
v_mfma_f32_16x16x32_bf16 v[104:107], v[68:71], a[32:35], v[104:107]
ds_read_b64_tr_b16 v[52:53], v18 offset:28672
v_mfma_f32_16x16x32_bf16 v[108:111], v[68:71], a[104:107], v[108:111]
ds_read_b64_tr_b16 v[54:55], v18 offset:30720
v_mfma_f32_16x16x32_bf16 v[112:115], v[72:75], a[0:3], 0
ds_read_b64_tr_b16 v[56:57], v18 offset:32768
buffer_load_dwordx4 v36, s[8:11], s34 offen offset:0 lds
v_mfma_f32_16x16x32_bf16 v[116:119], v[72:75], a[72:75], 0
ds_read_b64_tr_b16 v[58:59], v18 offset:34816
v_mfma_f32_16x16x32_bf16 v[112:115], v[76:79], a[4:7], v[112:115]
ds_read_b64_tr_b16 v[60:61], v19 offset:0
buffer_load_dwordx4 v37, s[8:11], s34 offen offset:1024 lds
v_mfma_f32_16x16x32_bf16 v[116:119], v[76:79], a[76:79], v[116:119]
ds_read_b64_tr_b16 v[62:63], v19 offset:2048
s_waitcnt lgkmcnt(8)
v_mfma_f32_16x16x32_bf16 v[112:115], v[80:83], a[8:11], v[112:115]
ds_read_b64_tr_b16 v[64:65], v19 offset:4096
v_mfma_f32_16x16x32_bf16 v[116:119], v[80:83], a[80:83], v[116:119]
ds_read_b64_tr_b16 v[66:67], v19 offset:6144
buffer_load_dwordx4 v38, s[8:11], s34 offen offset:2048 lds
v_mfma_f32_16x16x32_bf16 v[112:115], v[84:87], a[12:15], v[112:115]
ds_read_b64_tr_b16 v[68:69], v19 offset:8192
v_mfma_f32_16x16x32_bf16 v[116:119], v[84:87], a[84:87], v[116:119]
ds_read_b64_tr_b16 v[70:71], v19 offset:10240
buffer_load_dwordx4 v39, s[8:11], s34 offen offset:3072 lds
v_mfma_f32_16x16x32_bf16 v[112:115], v[88:91], a[16:19], v[112:115]
ds_read_b64_tr_b16 v[72:73], v19 offset:12288
v_mfma_f32_16x16x32_bf16 v[116:119], v[88:91], a[88:91], v[116:119]
ds_read_b64_tr_b16 v[74:75], v19 offset:14336
s_add_u32 m0, s32, 81920
v_mfma_f32_16x16x32_bf16 v[112:115], v[92:95], a[20:23], v[112:115]
ds_read_b64_tr_b16 v[76:77], v19 offset:16384
v_mfma_f32_16x16x32_bf16 v[116:119], v[92:95], a[92:95], v[116:119]
ds_read_b64_tr_b16 v[78:79], v19 offset:18432
s_waitcnt lgkmcnt(8)
v_mfma_f32_16x16x32_bf16 v[112:115], v[48:51], a[24:27], v[112:115]
ds_read_b64_tr_b16 v[80:81], v19 offset:20480
s_add_u32 s34, s28, 3244416
v_mfma_f32_16x16x32_bf16 v[116:119], v[48:51], a[96:99], v[116:119]
ds_read_b64_tr_b16 v[82:83], v19 offset:22528
v_mfma_f32_16x16x32_bf16 v[112:115], v[52:55], a[28:31], v[112:115]
ds_read_b64_tr_b16 v[84:85], v19 offset:24576
buffer_load_dwordx4 v36, s[8:11], s34 offen offset:0 lds
v_mfma_f32_16x16x32_bf16 v[116:119], v[52:55], a[100:103], v[116:119]
ds_read_b64_tr_b16 v[86:87], v19 offset:26624
v_mfma_f32_16x16x32_bf16 v[112:115], v[56:59], a[32:35], v[112:115]
ds_read_b64_tr_b16 v[88:89], v19 offset:28672
v_mfma_f32_16x16x32_bf16 v[116:119], v[56:59], a[104:107], v[116:119]
ds_read_b64_tr_b16 v[90:91], v19 offset:30720
s_waitcnt vmcnt(9)
v_mfma_f32_16x16x32_bf16 v[120:123], v[60:63], a[0:3], 0
ds_read_b64_tr_b16 v[92:93], v19 offset:32768
s_barrier
v_mfma_f32_16x16x32_bf16 v[124:127], v[60:63], a[72:75], 0
ds_read_b64_tr_b16 v[94:95], v19 offset:34816
s_waitcnt lgkmcnt(8)
v_mfma_f32_16x16x32_bf16 v[120:123], v[64:67], a[4:7], v[120:123]
ds_read_b64_tr_b16 v[48:49], v20 offset:0
v_mfma_f32_16x16x32_bf16 v[124:127], v[64:67], a[76:79], v[124:127]
ds_read_b64_tr_b16 v[50:51], v20 offset:2048
v_mfma_f32_16x16x32_bf16 v[120:123], v[68:71], a[8:11], v[120:123]
ds_read_b64_tr_b16 v[52:53], v20 offset:4096
v_mfma_f32_16x16x32_bf16 v[124:127], v[68:71], a[80:83], v[124:127]
ds_read_b64_tr_b16 v[54:55], v20 offset:6144
v_mfma_f32_16x16x32_bf16 v[120:123], v[72:75], a[12:15], v[120:123]
ds_read_b64_tr_b16 v[56:57], v20 offset:8192
v_mfma_f32_16x16x32_bf16 v[124:127], v[72:75], a[84:87], v[124:127]
ds_read_b64_tr_b16 v[58:59], v20 offset:10240
v_mfma_f32_16x16x32_bf16 v[120:123], v[76:79], a[16:19], v[120:123]
ds_read_b64_tr_b16 v[60:61], v20 offset:12288
v_mfma_f32_16x16x32_bf16 v[124:127], v[76:79], a[88:91], v[124:127]
ds_read_b64_tr_b16 v[62:63], v20 offset:14336
s_waitcnt lgkmcnt(8)
v_mfma_f32_16x16x32_bf16 v[120:123], v[80:83], a[20:23], v[120:123]
ds_read_b64_tr_b16 v[64:65], v20 offset:16384
v_mfma_f32_16x16x32_bf16 v[124:127], v[80:83], a[92:95], v[124:127]
ds_read_b64_tr_b16 v[66:67], v20 offset:18432
v_mfma_f32_16x16x32_bf16 v[120:123], v[84:87], a[24:27], v[120:123]
ds_read_b64_tr_b16 v[68:69], v20 offset:20480
v_mfma_f32_16x16x32_bf16 v[124:127], v[84:87], a[96:99], v[124:127]
ds_read_b64_tr_b16 v[70:71], v20 offset:22528
v_mfma_f32_16x16x32_bf16 v[120:123], v[88:91], a[28:31], v[120:123]
ds_read_b64_tr_b16 v[72:73], v20 offset:24576
v_mfma_f32_16x16x32_bf16 v[124:127], v[88:91], a[100:103], v[124:127]
ds_read_b64_tr_b16 v[74:75], v20 offset:26624
v_mfma_f32_16x16x32_bf16 v[120:123], v[92:95], a[32:35], v[120:123]
ds_read_b64_tr_b16 v[76:77], v20 offset:28672
v_mfma_f32_16x16x32_bf16 v[124:127], v[92:95], a[104:107], v[124:127]
ds_read_b64_tr_b16 v[78:79], v20 offset:30720
s_waitcnt lgkmcnt(8)
v_mfma_f32_16x16x32_bf16 v[128:131], v[48:51], a[0:3], 0
ds_read_b64_tr_b16 v[80:81], v20 offset:32768
s_add_u32 m0, s32, 110592
v_mfma_f32_16x16x32_bf16 v[132:135], v[48:51], a[72:75], 0
ds_read_b64_tr_b16 v[82:83], v20 offset:34816
v_mfma_f32_16x16x32_bf16 v[128:131], v[52:55], a[4:7], v[128:131]
ds_read_b64_tr_b16 v[84:85], v21 offset:0
v_mfma_f32_16x16x32_bf16 v[132:135], v[52:55], a[76:79], v[132:135]
ds_read_b64_tr_b16 v[86:87], v21 offset:2048
s_add_u32 s34, s28, 2654592
v_mfma_f32_16x16x32_bf16 v[128:131], v[56:59], a[8:11], v[128:131]
ds_read_b64_tr_b16 v[88:89], v21 offset:4096
v_mfma_f32_16x16x32_bf16 v[132:135], v[56:59], a[80:83], v[132:135]
ds_read_b64_tr_b16 v[90:91], v21 offset:6144
v_mfma_f32_16x16x32_bf16 v[128:131], v[60:63], a[12:15], v[128:131]
ds_read_b64_tr_b16 v[92:93], v21 offset:8192
buffer_load_dwordx4 v36, s[12:15], s34 offen offset:0 lds
v_mfma_f32_16x16x32_bf16 v[132:135], v[60:63], a[84:87], v[132:135]
ds_read_b64_tr_b16 v[94:95], v21 offset:10240
s_waitcnt lgkmcnt(8)
v_mfma_f32_16x16x32_bf16 v[128:131], v[64:67], a[16:19], v[128:131]
ds_read_b64_tr_b16 v[48:49], v21 offset:12288
v_mfma_f32_16x16x32_bf16 v[132:135], v[64:67], a[88:91], v[132:135]
ds_read_b64_tr_b16 v[50:51], v21 offset:14336
v_mfma_f32_16x16x32_bf16 v[128:131], v[68:71], a[20:23], v[128:131]
ds_read_b64_tr_b16 v[52:53], v21 offset:16384
buffer_load_dwordx4 v37, s[12:15], s34 offen offset:1024 lds
v_mfma_f32_16x16x32_bf16 v[132:135], v[68:71], a[92:95], v[132:135]
ds_read_b64_tr_b16 v[54:55], v21 offset:18432
v_mfma_f32_16x16x32_bf16 v[128:131], v[72:75], a[24:27], v[128:131]
ds_read_b64_tr_b16 v[56:57], v21 offset:20480
v_mfma_f32_16x16x32_bf16 v[132:135], v[72:75], a[96:99], v[132:135]
ds_read_b64_tr_b16 v[58:59], v21 offset:22528
buffer_load_dwordx4 v38, s[12:15], s34 offen offset:2048 lds
v_mfma_f32_16x16x32_bf16 v[128:131], v[76:79], a[28:31], v[128:131]
ds_read_b64_tr_b16 v[60:61], v21 offset:24576
v_mfma_f32_16x16x32_bf16 v[132:135], v[76:79], a[100:103], v[132:135]
ds_read_b64_tr_b16 v[62:63], v21 offset:26624
s_waitcnt lgkmcnt(8)
v_mfma_f32_16x16x32_bf16 v[128:131], v[80:83], a[32:35], v[128:131]
ds_read_b64_tr_b16 v[64:65], v21 offset:28672
v_mfma_f32_16x16x32_bf16 v[132:135], v[80:83], a[104:107], v[132:135]
ds_read_b64_tr_b16 v[66:67], v21 offset:30720
buffer_load_dwordx4 v39, s[12:15], s34 offen offset:3072 lds
v_mfma_f32_16x16x32_bf16 v[136:139], v[84:87], a[0:3], 0
ds_read_b64_tr_b16 v[68:69], v21 offset:32768
v_mfma_f32_16x16x32_bf16 v[140:143], v[84:87], a[72:75], 0
ds_read_b64_tr_b16 v[70:71], v21 offset:34816
v_mfma_f32_16x16x32_bf16 v[136:139], v[88:91], a[4:7], v[136:139]
ds_read_b64_tr_b16 v[72:73], v22 offset:0
s_add_u32 m0, s32, 114688
v_mfma_f32_16x16x32_bf16 v[140:143], v[88:91], a[76:79], v[140:143]
ds_read_b64_tr_b16 v[74:75], v22 offset:2048
v_mfma_f32_16x16x32_bf16 v[136:139], v[92:95], a[8:11], v[136:139]
ds_read_b64_tr_b16 v[76:77], v22 offset:4096
v_mfma_f32_16x16x32_bf16 v[140:143], v[92:95], a[80:83], v[140:143]
ds_read_b64_tr_b16 v[78:79], v22 offset:6144
s_waitcnt lgkmcnt(8)
v_mfma_f32_16x16x32_bf16 v[136:139], v[48:51], a[12:15], v[136:139]
ds_read_b64_tr_b16 v[80:81], v22 offset:8192
s_add_u32 s34, s28, 2949504
v_mfma_f32_16x16x32_bf16 v[140:143], v[48:51], a[84:87], v[140:143]
ds_read_b64_tr_b16 v[82:83], v22 offset:10240
v_mfma_f32_16x16x32_bf16 v[136:139], v[52:55], a[16:19], v[136:139]
ds_read_b64_tr_b16 v[84:85], v22 offset:12288
v_mfma_f32_16x16x32_bf16 v[140:143], v[52:55], a[88:91], v[140:143]
ds_read_b64_tr_b16 v[86:87], v22 offset:14336
v_mfma_f32_16x16x32_bf16 v[136:139], v[56:59], a[20:23], v[136:139]
ds_read_b64_tr_b16 v[88:89], v22 offset:16384
buffer_load_dwordx4 v36, s[12:15], s34 offen offset:0 lds
v_mfma_f32_16x16x32_bf16 v[140:143], v[56:59], a[92:95], v[140:143]
ds_read_b64_tr_b16 v[90:91], v22 offset:18432
v_mfma_f32_16x16x32_bf16 v[136:139], v[60:63], a[24:27], v[136:139]
ds_read_b64_tr_b16 v[92:93], v22 offset:20480
v_mfma_f32_16x16x32_bf16 v[140:143], v[60:63], a[96:99], v[140:143]
ds_read_b64_tr_b16 v[94:95], v22 offset:22528
s_waitcnt lgkmcnt(8)
v_mfma_f32_16x16x32_bf16 v[136:139], v[64:67], a[28:31], v[136:139]
ds_read_b64_tr_b16 v[48:49], v22 offset:24576
buffer_load_dwordx4 v37, s[12:15], s34 offen offset:1024 lds
v_mfma_f32_16x16x32_bf16 v[140:143], v[64:67], a[100:103], v[140:143]
ds_read_b64_tr_b16 v[50:51], v22 offset:26624
v_mfma_f32_16x16x32_bf16 v[136:139], v[68:71], a[32:35], v[136:139]
ds_read_b64_tr_b16 v[52:53], v22 offset:28672
v_mfma_f32_16x16x32_bf16 v[140:143], v[68:71], a[104:107], v[140:143]
ds_read_b64_tr_b16 v[54:55], v22 offset:30720
buffer_load_dwordx4 v38, s[12:15], s34 offen offset:2048 lds
v_mfma_f32_16x16x32_bf16 v[144:147], v[72:75], a[0:3], 0
ds_read_b64_tr_b16 v[56:57], v22 offset:32768
v_mfma_f32_16x16x32_bf16 v[148:151], v[72:75], a[72:75], 0
ds_read_b64_tr_b16 v[58:59], v22 offset:34816
v_mfma_f32_16x16x32_bf16 v[144:147], v[76:79], a[4:7], v[144:147]
ds_read_b64_tr_b16 v[60:61], v23 offset:0
buffer_load_dwordx4 v39, s[12:15], s34 offen offset:3072 lds
v_mfma_f32_16x16x32_bf16 v[148:151], v[76:79], a[76:79], v[148:151]
ds_read_b64_tr_b16 v[62:63], v23 offset:2048
s_waitcnt lgkmcnt(8)
v_mfma_f32_16x16x32_bf16 v[144:147], v[80:83], a[8:11], v[144:147]
ds_read_b64_tr_b16 v[64:65], v23 offset:4096
v_mfma_f32_16x16x32_bf16 v[148:151], v[80:83], a[80:83], v[148:151]
ds_read_b64_tr_b16 v[66:67], v23 offset:6144
v_mfma_f32_16x16x32_bf16 v[144:147], v[84:87], a[12:15], v[144:147]
ds_read_b64_tr_b16 v[68:69], v23 offset:8192
s_add_u32 m0, s32, 118784
v_mfma_f32_16x16x32_bf16 v[148:151], v[84:87], a[84:87], v[148:151]
ds_read_b64_tr_b16 v[70:71], v23 offset:10240
v_mfma_f32_16x16x32_bf16 v[144:147], v[88:91], a[16:19], v[144:147]
ds_read_b64_tr_b16 v[72:73], v23 offset:12288
v_mfma_f32_16x16x32_bf16 v[148:151], v[88:91], a[88:91], v[148:151]
ds_read_b64_tr_b16 v[74:75], v23 offset:14336
s_add_u32 s34, s28, 3244416
v_mfma_f32_16x16x32_bf16 v[144:147], v[92:95], a[20:23], v[144:147]
ds_read_b64_tr_b16 v[76:77], v23 offset:16384
v_mfma_f32_16x16x32_bf16 v[148:151], v[92:95], a[92:95], v[148:151]
ds_read_b64_tr_b16 v[78:79], v23 offset:18432
s_waitcnt lgkmcnt(8)
v_mfma_f32_16x16x32_bf16 v[144:147], v[48:51], a[24:27], v[144:147]
ds_read_b64_tr_b16 v[80:81], v23 offset:20480
v_mfma_f32_16x16x32_bf16 v[148:151], v[48:51], a[96:99], v[148:151]
ds_read_b64_tr_b16 v[82:83], v23 offset:22528
buffer_load_dwordx4 v36, s[12:15], s34 offen offset:0 lds
v_mfma_f32_16x16x32_bf16 v[144:147], v[52:55], a[28:31], v[144:147]
ds_read_b64_tr_b16 v[84:85], v23 offset:24576
v_mfma_f32_16x16x32_bf16 v[148:151], v[52:55], a[100:103], v[148:151]
ds_read_b64_tr_b16 v[86:87], v23 offset:26624
v_mfma_f32_16x16x32_bf16 v[144:147], v[56:59], a[32:35], v[144:147]
ds_read_b64_tr_b16 v[88:89], v23 offset:28672
v_mfma_f32_16x16x32_bf16 v[148:151], v[56:59], a[104:107], v[148:151]
ds_read_b64_tr_b16 v[90:91], v23 offset:30720
s_waitcnt vmcnt(9)
v_mfma_f32_16x16x32_bf16 v[152:155], v[60:63], a[0:3], 0
ds_read_b64_tr_b16 v[92:93], v23 offset:32768
s_barrier
v_mfma_f32_16x16x32_bf16 v[156:159], v[60:63], a[72:75], 0
ds_read_b64_tr_b16 v[94:95], v23 offset:34816
s_waitcnt lgkmcnt(8)
v_mfma_f32_16x16x32_bf16 v[152:155], v[64:67], a[4:7], v[152:155]
ds_read_b64_tr_b16 v[48:49], v24 offset:0
v_mfma_f32_16x16x32_bf16 v[156:159], v[64:67], a[76:79], v[156:159]
ds_read_b64_tr_b16 v[50:51], v24 offset:2048
v_mfma_f32_16x16x32_bf16 v[152:155], v[68:71], a[8:11], v[152:155]
ds_read_b64_tr_b16 v[52:53], v24 offset:4096
v_mfma_f32_16x16x32_bf16 v[156:159], v[68:71], a[80:83], v[156:159]
ds_read_b64_tr_b16 v[54:55], v24 offset:6144
v_mfma_f32_16x16x32_bf16 v[152:155], v[72:75], a[12:15], v[152:155]
ds_read_b64_tr_b16 v[56:57], v24 offset:8192
v_mfma_f32_16x16x32_bf16 v[156:159], v[72:75], a[84:87], v[156:159]
ds_read_b64_tr_b16 v[58:59], v24 offset:10240
v_mfma_f32_16x16x32_bf16 v[152:155], v[76:79], a[16:19], v[152:155]
ds_read_b64_tr_b16 v[60:61], v24 offset:12288
v_mfma_f32_16x16x32_bf16 v[156:159], v[76:79], a[88:91], v[156:159]
ds_read_b64_tr_b16 v[62:63], v24 offset:14336
s_waitcnt lgkmcnt(8)
v_mfma_f32_16x16x32_bf16 v[152:155], v[80:83], a[20:23], v[152:155]
ds_read_b64_tr_b16 v[64:65], v24 offset:16384
v_mfma_f32_16x16x32_bf16 v[156:159], v[80:83], a[92:95], v[156:159]
ds_read_b64_tr_b16 v[66:67], v24 offset:18432
v_mfma_f32_16x16x32_bf16 v[152:155], v[84:87], a[24:27], v[152:155]
ds_read_b64_tr_b16 v[68:69], v24 offset:20480
v_mfma_f32_16x16x32_bf16 v[156:159], v[84:87], a[96:99], v[156:159]
ds_read_b64_tr_b16 v[70:71], v24 offset:22528
v_mfma_f32_16x16x32_bf16 v[152:155], v[88:91], a[28:31], v[152:155]
ds_read_b64_tr_b16 v[72:73], v24 offset:24576
v_mfma_f32_16x16x32_bf16 v[156:159], v[88:91], a[100:103], v[156:159]
ds_read_b64_tr_b16 v[74:75], v24 offset:26624
v_mfma_f32_16x16x32_bf16 v[152:155], v[92:95], a[32:35], v[152:155]
ds_read_b64_tr_b16 v[76:77], v24 offset:28672
v_mfma_f32_16x16x32_bf16 v[156:159], v[92:95], a[104:107], v[156:159]
ds_read_b64_tr_b16 v[78:79], v24 offset:30720
s_waitcnt lgkmcnt(8)
v_mfma_f32_16x16x32_bf16 v[96:99], v[48:51], a[36:39], v[96:99]
ds_read_b64_tr_b16 v[80:81], v24 offset:32768
s_add_u32 m0, s32, 0
v_mfma_f32_16x16x32_bf16 v[100:103], v[48:51], a[108:111], v[100:103]
ds_read_b64_tr_b16 v[82:83], v24 offset:34816
v_mfma_f32_16x16x32_bf16 v[96:99], v[52:55], a[40:43], v[96:99]
ds_read_b64_tr_b16 v[84:85], v25 offset:0
v_mfma_f32_16x16x32_bf16 v[100:103], v[52:55], a[112:115], v[100:103]
ds_read_b64_tr_b16 v[86:87], v25 offset:2048
s_add_u32 s34, s29, 0
v_mfma_f32_16x16x32_bf16 v[96:99], v[56:59], a[44:47], v[96:99]
ds_read_b64_tr_b16 v[88:89], v25 offset:4096
v_mfma_f32_16x16x32_bf16 v[100:103], v[56:59], a[116:119], v[100:103]
ds_read_b64_tr_b16 v[90:91], v25 offset:6144
v_mfma_f32_16x16x32_bf16 v[96:99], v[60:63], a[48:51], v[96:99]
ds_read_b64_tr_b16 v[92:93], v25 offset:8192
buffer_load_dwordx4 v40, s[8:11], s34 offen offset:0 lds
v_mfma_f32_16x16x32_bf16 v[100:103], v[60:63], a[120:123], v[100:103]
ds_read_b64_tr_b16 v[94:95], v25 offset:10240
s_waitcnt lgkmcnt(8)
v_mfma_f32_16x16x32_bf16 v[96:99], v[64:67], a[52:55], v[96:99]
ds_read_b64_tr_b16 v[48:49], v25 offset:12288
v_mfma_f32_16x16x32_bf16 v[100:103], v[64:67], a[124:127], v[100:103]
ds_read_b64_tr_b16 v[50:51], v25 offset:14336
v_mfma_f32_16x16x32_bf16 v[96:99], v[68:71], a[56:59], v[96:99]
ds_read_b64_tr_b16 v[52:53], v25 offset:16384
buffer_load_dwordx4 v41, s[8:11], s34 offen offset:1024 lds
v_mfma_f32_16x16x32_bf16 v[100:103], v[68:71], a[128:131], v[100:103]
ds_read_b64_tr_b16 v[54:55], v25 offset:18432
v_mfma_f32_16x16x32_bf16 v[96:99], v[72:75], a[60:63], v[96:99]
ds_read_b64_tr_b16 v[56:57], v25 offset:20480
v_mfma_f32_16x16x32_bf16 v[100:103], v[72:75], a[132:135], v[100:103]
ds_read_b64_tr_b16 v[58:59], v25 offset:22528
buffer_load_dwordx4 v42, s[8:11], s34 offen offset:2048 lds
v_mfma_f32_16x16x32_bf16 v[96:99], v[76:79], a[64:67], v[96:99]
ds_read_b64_tr_b16 v[60:61], v25 offset:24576
v_mfma_f32_16x16x32_bf16 v[100:103], v[76:79], a[136:139], v[100:103]
ds_read_b64_tr_b16 v[62:63], v25 offset:26624
s_waitcnt lgkmcnt(8)
v_mfma_f32_16x16x32_bf16 v[96:99], v[80:83], a[68:71], v[96:99]
ds_read_b64_tr_b16 v[64:65], v25 offset:28672
v_mfma_f32_16x16x32_bf16 v[100:103], v[80:83], a[140:143], v[100:103]
ds_read_b64_tr_b16 v[66:67], v25 offset:30720
buffer_load_dwordx4 v43, s[8:11], s34 offen offset:3072 lds
v_mfma_f32_16x16x32_bf16 v[104:107], v[84:87], a[36:39], v[104:107]
ds_read_b64_tr_b16 v[68:69], v25 offset:32768
v_mfma_f32_16x16x32_bf16 v[108:111], v[84:87], a[108:111], v[108:111]
ds_read_b64_tr_b16 v[70:71], v25 offset:34816
v_mfma_f32_16x16x32_bf16 v[104:107], v[88:91], a[40:43], v[104:107]
ds_read_b64_tr_b16 v[72:73], v26 offset:0
s_add_u32 m0, s32, 4096
v_mfma_f32_16x16x32_bf16 v[108:111], v[88:91], a[112:115], v[108:111]
ds_read_b64_tr_b16 v[74:75], v26 offset:2048
v_mfma_f32_16x16x32_bf16 v[104:107], v[92:95], a[44:47], v[104:107]
ds_read_b64_tr_b16 v[76:77], v26 offset:4096
v_mfma_f32_16x16x32_bf16 v[108:111], v[92:95], a[116:119], v[108:111]
ds_read_b64_tr_b16 v[78:79], v26 offset:6144
s_waitcnt lgkmcnt(8)
v_mfma_f32_16x16x32_bf16 v[104:107], v[48:51], a[48:51], v[104:107]
ds_read_b64_tr_b16 v[80:81], v26 offset:8192
s_add_u32 s34, s29, 589824
v_mfma_f32_16x16x32_bf16 v[108:111], v[48:51], a[120:123], v[108:111]
ds_read_b64_tr_b16 v[82:83], v26 offset:10240
v_mfma_f32_16x16x32_bf16 v[104:107], v[52:55], a[52:55], v[104:107]
ds_read_b64_tr_b16 v[84:85], v26 offset:12288
v_mfma_f32_16x16x32_bf16 v[108:111], v[52:55], a[124:127], v[108:111]
ds_read_b64_tr_b16 v[86:87], v26 offset:14336
v_mfma_f32_16x16x32_bf16 v[104:107], v[56:59], a[56:59], v[104:107]
ds_read_b64_tr_b16 v[88:89], v26 offset:16384
buffer_load_dwordx4 v40, s[8:11], s34 offen offset:0 lds
v_mfma_f32_16x16x32_bf16 v[108:111], v[56:59], a[128:131], v[108:111]
ds_read_b64_tr_b16 v[90:91], v26 offset:18432
v_mfma_f32_16x16x32_bf16 v[104:107], v[60:63], a[60:63], v[104:107]
ds_read_b64_tr_b16 v[92:93], v26 offset:20480
v_mfma_f32_16x16x32_bf16 v[108:111], v[60:63], a[132:135], v[108:111]
ds_read_b64_tr_b16 v[94:95], v26 offset:22528
s_waitcnt lgkmcnt(8)
v_mfma_f32_16x16x32_bf16 v[104:107], v[64:67], a[64:67], v[104:107]
ds_read_b64_tr_b16 v[48:49], v26 offset:24576
buffer_load_dwordx4 v41, s[8:11], s34 offen offset:1024 lds
v_mfma_f32_16x16x32_bf16 v[108:111], v[64:67], a[136:139], v[108:111]
ds_read_b64_tr_b16 v[50:51], v26 offset:26624
v_mfma_f32_16x16x32_bf16 v[104:107], v[68:71], a[68:71], v[104:107]
ds_read_b64_tr_b16 v[52:53], v26 offset:28672
v_mfma_f32_16x16x32_bf16 v[108:111], v[68:71], a[140:143], v[108:111]
ds_read_b64_tr_b16 v[54:55], v26 offset:30720
buffer_load_dwordx4 v42, s[8:11], s34 offen offset:2048 lds
v_mfma_f32_16x16x32_bf16 v[112:115], v[72:75], a[36:39], v[112:115]
ds_read_b64_tr_b16 v[56:57], v26 offset:32768
v_mfma_f32_16x16x32_bf16 v[116:119], v[72:75], a[108:111], v[116:119]
ds_read_b64_tr_b16 v[58:59], v26 offset:34816
v_mfma_f32_16x16x32_bf16 v[112:115], v[76:79], a[40:43], v[112:115]
ds_read_b64_tr_b16 v[60:61], v27 offset:0
buffer_load_dwordx4 v43, s[8:11], s34 offen offset:3072 lds
v_mfma_f32_16x16x32_bf16 v[116:119], v[76:79], a[112:115], v[116:119]
ds_read_b64_tr_b16 v[62:63], v27 offset:2048
s_waitcnt lgkmcnt(8)
v_mfma_f32_16x16x32_bf16 v[112:115], v[80:83], a[44:47], v[112:115]
ds_read_b64_tr_b16 v[64:65], v27 offset:4096
v_mfma_f32_16x16x32_bf16 v[116:119], v[80:83], a[116:119], v[116:119]
ds_read_b64_tr_b16 v[66:67], v27 offset:6144
v_mfma_f32_16x16x32_bf16 v[112:115], v[84:87], a[48:51], v[112:115]
ds_read_b64_tr_b16 v[68:69], v27 offset:8192
s_add_u32 m0, s32, 8192
v_mfma_f32_16x16x32_bf16 v[116:119], v[84:87], a[120:123], v[116:119]
ds_read_b64_tr_b16 v[70:71], v27 offset:10240
v_mfma_f32_16x16x32_bf16 v[112:115], v[88:91], a[52:55], v[112:115]
ds_read_b64_tr_b16 v[72:73], v27 offset:12288
v_mfma_f32_16x16x32_bf16 v[116:119], v[88:91], a[124:127], v[116:119]
ds_read_b64_tr_b16 v[74:75], v27 offset:14336
s_add_u32 s34, s29, 1179648
v_mfma_f32_16x16x32_bf16 v[112:115], v[92:95], a[56:59], v[112:115]
ds_read_b64_tr_b16 v[76:77], v27 offset:16384
v_mfma_f32_16x16x32_bf16 v[116:119], v[92:95], a[128:131], v[116:119]
ds_read_b64_tr_b16 v[78:79], v27 offset:18432
s_waitcnt lgkmcnt(8)
v_mfma_f32_16x16x32_bf16 v[112:115], v[48:51], a[60:63], v[112:115]
ds_read_b64_tr_b16 v[80:81], v27 offset:20480
v_mfma_f32_16x16x32_bf16 v[116:119], v[48:51], a[132:135], v[116:119]
ds_read_b64_tr_b16 v[82:83], v27 offset:22528
buffer_load_dwordx4 v40, s[8:11], s34 offen offset:0 lds
v_mfma_f32_16x16x32_bf16 v[112:115], v[52:55], a[64:67], v[112:115]
ds_read_b64_tr_b16 v[84:85], v27 offset:24576
v_mfma_f32_16x16x32_bf16 v[116:119], v[52:55], a[136:139], v[116:119]
L_mlp_pad5:
s_cbranch_execz L_mlp_pad9
ds_read_b64_tr_b16 v[86:87], v27 offset:26624
v_mfma_f32_16x16x32_bf16 v[112:115], v[56:59], a[68:71], v[112:115]
ds_read_b64_tr_b16 v[88:89], v27 offset:28672
v_mfma_f32_16x16x32_bf16 v[116:119], v[56:59], a[140:143], v[116:119]
ds_read_b64_tr_b16 v[90:91], v27 offset:30720
s_waitcnt vmcnt(9)
v_mfma_f32_16x16x32_bf16 v[120:123], v[60:63], a[36:39], v[120:123]
ds_read_b64_tr_b16 v[92:93], v27 offset:32768
s_barrier
v_mfma_f32_16x16x32_bf16 v[124:127], v[60:63], a[108:111], v[124:127]
ds_read_b64_tr_b16 v[94:95], v27 offset:34816
s_waitcnt lgkmcnt(8)
v_mfma_f32_16x16x32_bf16 v[120:123], v[64:67], a[40:43], v[120:123]
ds_read_b64_tr_b16 v[48:49], v28 offset:0
v_mfma_f32_16x16x32_bf16 v[124:127], v[64:67], a[112:115], v[124:127]
ds_read_b64_tr_b16 v[50:51], v28 offset:2048
v_mfma_f32_16x16x32_bf16 v[120:123], v[68:71], a[44:47], v[120:123]
ds_read_b64_tr_b16 v[52:53], v28 offset:4096
v_mfma_f32_16x16x32_bf16 v[124:127], v[68:71], a[116:119], v[124:127]
ds_read_b64_tr_b16 v[54:55], v28 offset:6144
v_mfma_f32_16x16x32_bf16 v[120:123], v[72:75], a[48:51], v[120:123]
ds_read_b64_tr_b16 v[56:57], v28 offset:8192
v_mfma_f32_16x16x32_bf16 v[124:127], v[72:75], a[120:123], v[124:127]
ds_read_b64_tr_b16 v[58:59], v28 offset:10240
v_mfma_f32_16x16x32_bf16 v[120:123], v[76:79], a[52:55], v[120:123]
ds_read_b64_tr_b16 v[60:61], v28 offset:12288
v_mfma_f32_16x16x32_bf16 v[124:127], v[76:79], a[124:127], v[124:127]
ds_read_b64_tr_b16 v[62:63], v28 offset:14336
s_waitcnt lgkmcnt(8)
v_mfma_f32_16x16x32_bf16 v[120:123], v[80:83], a[56:59], v[120:123]
ds_read_b64_tr_b16 v[64:65], v28 offset:16384
v_mfma_f32_16x16x32_bf16 v[124:127], v[80:83], a[128:131], v[124:127]
ds_read_b64_tr_b16 v[66:67], v28 offset:18432
v_mfma_f32_16x16x32_bf16 v[120:123], v[84:87], a[60:63], v[120:123]
ds_read_b64_tr_b16 v[68:69], v28 offset:20480
v_mfma_f32_16x16x32_bf16 v[124:127], v[84:87], a[132:135], v[124:127]
ds_read_b64_tr_b16 v[70:71], v28 offset:22528
v_mfma_f32_16x16x32_bf16 v[120:123], v[88:91], a[64:67], v[120:123]
ds_read_b64_tr_b16 v[72:73], v28 offset:24576
v_mfma_f32_16x16x32_bf16 v[124:127], v[88:91], a[136:139], v[124:127]
ds_read_b64_tr_b16 v[74:75], v28 offset:26624
v_mfma_f32_16x16x32_bf16 v[120:123], v[92:95], a[68:71], v[120:123]
ds_read_b64_tr_b16 v[76:77], v28 offset:28672
v_mfma_f32_16x16x32_bf16 v[124:127], v[92:95], a[140:143], v[124:127]
ds_read_b64_tr_b16 v[78:79], v28 offset:30720
s_waitcnt lgkmcnt(8)
v_mfma_f32_16x16x32_bf16 v[128:131], v[48:51], a[36:39], v[128:131]
ds_read_b64_tr_b16 v[80:81], v28 offset:32768
s_add_u32 m0, s32, 36864
v_mfma_f32_16x16x32_bf16 v[132:135], v[48:51], a[108:111], v[132:135]
ds_read_b64_tr_b16 v[82:83], v28 offset:34816
v_mfma_f32_16x16x32_bf16 v[128:131], v[52:55], a[40:43], v[128:131]
ds_read_b64_tr_b16 v[84:85], v29 offset:0
v_mfma_f32_16x16x32_bf16 v[132:135], v[52:55], a[112:115], v[132:135]
ds_read_b64_tr_b16 v[86:87], v29 offset:2048
s_add_u32 s34, s29, 0
v_mfma_f32_16x16x32_bf16 v[128:131], v[56:59], a[44:47], v[128:131]
ds_read_b64_tr_b16 v[88:89], v29 offset:4096
v_mfma_f32_16x16x32_bf16 v[132:135], v[56:59], a[116:119], v[132:135]
ds_read_b64_tr_b16 v[90:91], v29 offset:6144
v_mfma_f32_16x16x32_bf16 v[128:131], v[60:63], a[48:51], v[128:131]
ds_read_b64_tr_b16 v[92:93], v29 offset:8192
buffer_load_dwordx4 v40, s[12:15], s34 offen offset:0 lds
v_mfma_f32_16x16x32_bf16 v[132:135], v[60:63], a[120:123], v[132:135]
ds_read_b64_tr_b16 v[94:95], v29 offset:10240
s_waitcnt lgkmcnt(8)
v_mfma_f32_16x16x32_bf16 v[128:131], v[64:67], a[52:55], v[128:131]
ds_read_b64_tr_b16 v[48:49], v29 offset:12288
v_mfma_f32_16x16x32_bf16 v[132:135], v[64:67], a[124:127], v[132:135]
ds_read_b64_tr_b16 v[50:51], v29 offset:14336
v_mfma_f32_16x16x32_bf16 v[128:131], v[68:71], a[56:59], v[128:131]
ds_read_b64_tr_b16 v[52:53], v29 offset:16384
buffer_load_dwordx4 v41, s[12:15], s34 offen offset:1024 lds
v_mfma_f32_16x16x32_bf16 v[132:135], v[68:71], a[128:131], v[132:135]
ds_read_b64_tr_b16 v[54:55], v29 offset:18432
v_mfma_f32_16x16x32_bf16 v[128:131], v[72:75], a[60:63], v[128:131]
ds_read_b64_tr_b16 v[56:57], v29 offset:20480
v_mfma_f32_16x16x32_bf16 v[132:135], v[72:75], a[132:135], v[132:135]
ds_read_b64_tr_b16 v[58:59], v29 offset:22528
buffer_load_dwordx4 v42, s[12:15], s34 offen offset:2048 lds
v_mfma_f32_16x16x32_bf16 v[128:131], v[76:79], a[64:67], v[128:131]
ds_read_b64_tr_b16 v[60:61], v29 offset:24576
v_mfma_f32_16x16x32_bf16 v[132:135], v[76:79], a[136:139], v[132:135]
ds_read_b64_tr_b16 v[62:63], v29 offset:26624
s_waitcnt lgkmcnt(8)
v_mfma_f32_16x16x32_bf16 v[128:131], v[80:83], a[68:71], v[128:131]
ds_read_b64_tr_b16 v[64:65], v29 offset:28672
v_mfma_f32_16x16x32_bf16 v[132:135], v[80:83], a[140:143], v[132:135]
ds_read_b64_tr_b16 v[66:67], v29 offset:30720
buffer_load_dwordx4 v43, s[12:15], s34 offen offset:3072 lds
v_mfma_f32_16x16x32_bf16 v[136:139], v[84:87], a[36:39], v[136:139]
ds_read_b64_tr_b16 v[68:69], v29 offset:32768
v_mfma_f32_16x16x32_bf16 v[140:143], v[84:87], a[108:111], v[140:143]
ds_read_b64_tr_b16 v[70:71], v29 offset:34816
v_mfma_f32_16x16x32_bf16 v[136:139], v[88:91], a[40:43], v[136:139]
ds_read_b64_tr_b16 v[72:73], v30 offset:0
s_add_u32 m0, s32, 40960
v_mfma_f32_16x16x32_bf16 v[140:143], v[88:91], a[112:115], v[140:143]
ds_read_b64_tr_b16 v[74:75], v30 offset:2048
v_mfma_f32_16x16x32_bf16 v[136:139], v[92:95], a[44:47], v[136:139]
ds_read_b64_tr_b16 v[76:77], v30 offset:4096
v_mul_f32 v96, v96, v128
v_mfma_f32_16x16x32_bf16 v[140:143], v[92:95], a[116:119], v[140:143]
ds_read_b64_tr_b16 v[78:79], v30 offset:6144
s_waitcnt lgkmcnt(8)
v_mfma_f32_16x16x32_bf16 v[136:139], v[48:51], a[48:51], v[136:139]
ds_read_b64_tr_b16 v[80:81], v30 offset:8192
s_add_u32 s34, s29, 589824
v_mfma_f32_16x16x32_bf16 v[140:143], v[48:51], a[120:123], v[140:143]
ds_read_b64_tr_b16 v[82:83], v30 offset:10240
v_mul_f32 v97, v97, v129
v_mfma_f32_16x16x32_bf16 v[136:139], v[52:55], a[52:55], v[136:139]
ds_read_b64_tr_b16 v[84:85], v30 offset:12288
v_mul_f32 v98, v98, v130
v_mfma_f32_16x16x32_bf16 v[140:143], v[52:55], a[124:127], v[140:143]
ds_read_b64_tr_b16 v[86:87], v30 offset:14336
v_mul_f32 v99, v99, v131
v_mfma_f32_16x16x32_bf16 v[136:139], v[56:59], a[56:59], v[136:139]
ds_read_b64_tr_b16 v[88:89], v30 offset:16384
buffer_load_dwordx4 v40, s[12:15], s34 offen offset:0 lds
v_mfma_f32_16x16x32_bf16 v[140:143], v[56:59], a[128:131], v[140:143]
ds_read_b64_tr_b16 v[90:91], v30 offset:18432
v_cvt_pk_bf16_f32 v208, v96, v97
v_mfma_f32_16x16x32_bf16 v[136:139], v[60:63], a[60:63], v[136:139]
ds_read_b64_tr_b16 v[92:93], v30 offset:20480
v_cvt_pk_bf16_f32 v209, v98, v99
v_mfma_f32_16x16x32_bf16 v[140:143], v[60:63], a[132:135], v[140:143]
ds_read_b64_tr_b16 v[94:95], v30 offset:22528
s_waitcnt lgkmcnt(8)
v_mfma_f32_16x16x32_bf16 v[136:139], v[64:67], a[64:67], v[136:139]
ds_read_b64_tr_b16 v[48:49], v30 offset:24576
buffer_load_dwordx4 v41, s[12:15], s34 offen offset:1024 lds
v_mfma_f32_16x16x32_bf16 v[140:143], v[64:67], a[136:139], v[140:143]
ds_read_b64_tr_b16 v[50:51], v30 offset:26624
v_mul_f32 v100, v100, v132
v_mfma_f32_16x16x32_bf16 v[136:139], v[68:71], a[68:71], v[136:139]
ds_read_b64_tr_b16 v[52:53], v30 offset:28672
v_mul_f32 v101, v101, v133
v_mfma_f32_16x16x32_bf16 v[140:143], v[68:71], a[140:143], v[140:143]
ds_read_b64_tr_b16 v[54:55], v30 offset:30720
buffer_load_dwordx4 v42, s[12:15], s34 offen offset:2048 lds
v_mfma_f32_16x16x32_bf16 v[144:147], v[72:75], a[36:39], v[144:147]
ds_read_b64_tr_b16 v[56:57], v30 offset:32768
v_mul_f32 v102, v102, v134
v_mfma_f32_16x16x32_bf16 v[148:151], v[72:75], a[108:111], v[148:151]
ds_read_b64_tr_b16 v[58:59], v30 offset:34816
v_mul_f32 v103, v103, v135
v_mfma_f32_16x16x32_bf16 v[144:147], v[76:79], a[40:43], v[144:147]
ds_read_b64_tr_b16 v[60:61], v31 offset:0
buffer_load_dwordx4 v43, s[12:15], s34 offen offset:3072 lds
v_mfma_f32_16x16x32_bf16 v[148:151], v[76:79], a[112:115], v[148:151]
ds_read_b64_tr_b16 v[62:63], v31 offset:2048
s_waitcnt lgkmcnt(8)
v_mfma_f32_16x16x32_bf16 v[144:147], v[80:83], a[44:47], v[144:147]
ds_read_b64_tr_b16 v[64:65], v31 offset:4096
v_cvt_pk_bf16_f32 v212, v100, v101
v_mfma_f32_16x16x32_bf16 v[148:151], v[80:83], a[116:119], v[148:151]
ds_read_b64_tr_b16 v[66:67], v31 offset:6144
v_cvt_pk_bf16_f32 v213, v102, v103
v_mfma_f32_16x16x32_bf16 v[144:147], v[84:87], a[48:51], v[144:147]
ds_read_b64_tr_b16 v[68:69], v31 offset:8192
s_add_u32 m0, s32, 45056
v_mfma_f32_16x16x32_bf16 v[148:151], v[84:87], a[120:123], v[148:151]
ds_read_b64_tr_b16 v[70:71], v31 offset:10240
v_mul_f32 v104, v104, v136
v_mfma_f32_16x16x32_bf16 v[144:147], v[88:91], a[52:55], v[144:147]
ds_read_b64_tr_b16 v[72:73], v31 offset:12288
v_mul_f32 v105, v105, v137
v_mfma_f32_16x16x32_bf16 v[148:151], v[88:91], a[124:127], v[148:151]
ds_read_b64_tr_b16 v[74:75], v31 offset:14336
s_add_u32 s34, s29, 1179648
v_mfma_f32_16x16x32_bf16 v[144:147], v[92:95], a[56:59], v[144:147]
ds_read_b64_tr_b16 v[76:77], v31 offset:16384
v_mul_f32 v106, v106, v138
v_mfma_f32_16x16x32_bf16 v[148:151], v[92:95], a[128:131], v[148:151]
ds_read_b64_tr_b16 v[78:79], v31 offset:18432
s_waitcnt lgkmcnt(8)
v_mfma_f32_16x16x32_bf16 v[144:147], v[48:51], a[60:63], v[144:147]
ds_read_b64_tr_b16 v[80:81], v31 offset:20480
v_mul_f32 v107, v107, v139
v_mfma_f32_16x16x32_bf16 v[148:151], v[48:51], a[132:135], v[148:151]
ds_read_b64_tr_b16 v[82:83], v31 offset:22528
buffer_load_dwordx4 v40, s[12:15], s34 offen offset:0 lds
v_mfma_f32_16x16x32_bf16 v[144:147], v[52:55], a[64:67], v[144:147]
ds_read_b64_tr_b16 v[84:85], v31 offset:24576
v_cvt_pk_bf16_f32 v210, v104, v105
v_mfma_f32_16x16x32_bf16 v[148:151], v[52:55], a[136:139], v[148:151]
ds_read_b64_tr_b16 v[86:87], v31 offset:26624
v_cvt_pk_bf16_f32 v211, v106, v107
v_mfma_f32_16x16x32_bf16 v[144:147], v[56:59], a[68:71], v[144:147]
ds_read_b64_tr_b16 v[88:89], v31 offset:28672
v_mul_f32 v108, v108, v140
v_mfma_f32_16x16x32_bf16 v[148:151], v[56:59], a[140:143], v[148:151]
ds_read_b64_tr_b16 v[90:91], v31 offset:30720
s_waitcnt vmcnt(9)
v_mfma_f32_16x16x32_bf16 v[152:155], v[60:63], a[36:39], v[152:155]
ds_read_b64_tr_b16 v[92:93], v31 offset:32768
s_barrier
v_mfma_f32_16x16x32_bf16 v[156:159], v[60:63], a[108:111], v[156:159]
ds_read_b64_tr_b16 v[94:95], v31 offset:34816
s_waitcnt lgkmcnt(8)
v_mfma_f32_16x16x32_bf16 v[152:155], v[64:67], a[40:43], v[152:155]
ds_read_b64_tr_b16 v[48:49], v32 offset:0
v_mul_f32 v109, v109, v141
v_mfma_f32_16x16x32_bf16 v[156:159], v[64:67], a[112:115], v[156:159]
ds_read_b64_tr_b16 v[50:51], v32 offset:1024
v_mul_f32 v110, v110, v142
v_mfma_f32_16x16x32_bf16 v[152:155], v[68:71], a[44:47], v[152:155]
ds_read_b64_tr_b16 v[52:53], v32 offset:2048
v_mul_f32 v111, v111, v143
v_mfma_f32_16x16x32_bf16 v[156:159], v[68:71], a[116:119], v[156:159]
ds_read_b64_tr_b16 v[54:55], v32 offset:3072
v_cvt_pk_bf16_f32 v214, v108, v109
v_mfma_f32_16x16x32_bf16 v[152:155], v[72:75], a[48:51], v[152:155]
ds_read_b64_tr_b16 v[56:57], v32 offset:4096
v_cvt_pk_bf16_f32 v215, v110, v111
v_mfma_f32_16x16x32_bf16 v[156:159], v[72:75], a[120:123], v[156:159]
ds_read_b64_tr_b16 v[58:59], v32 offset:5120
v_mul_f32 v112, v112, v144
v_mfma_f32_16x16x32_bf16 v[152:155], v[76:79], a[52:55], v[152:155]
ds_read_b64_tr_b16 v[60:61], v32 offset:6144
v_mul_f32 v113, v113, v145
v_mfma_f32_16x16x32_bf16 v[156:159], v[76:79], a[124:127], v[156:159]
ds_read_b64_tr_b16 v[62:63], v32 offset:7168
s_waitcnt lgkmcnt(8)
v_mfma_f32_16x16x32_bf16 v[152:155], v[80:83], a[56:59], v[152:155]
ds_read_b64_tr_b16 v[64:65], v32 offset:8192
v_mul_f32 v114, v114, v146
v_mfma_f32_16x16x32_bf16 v[156:159], v[80:83], a[128:131], v[156:159]
ds_read_b64_tr_b16 v[66:67], v32 offset:9216
v_mul_f32 v115, v115, v147
v_mfma_f32_16x16x32_bf16 v[152:155], v[84:87], a[60:63], v[152:155]
ds_read_b64_tr_b16 v[68:69], v32 offset:10240
v_cvt_pk_bf16_f32 v216, v112, v113
v_mfma_f32_16x16x32_bf16 v[156:159], v[84:87], a[132:135], v[156:159]
ds_read_b64_tr_b16 v[70:71], v32 offset:11264
v_cvt_pk_bf16_f32 v217, v114, v115
v_mfma_f32_16x16x32_bf16 v[152:155], v[88:91], a[64:67], v[152:155]
ds_read_b64_tr_b16 v[72:73], v32 offset:12288
v_mul_f32 v116, v116, v148
v_mfma_f32_16x16x32_bf16 v[156:159], v[88:91], a[136:139], v[156:159]
ds_read_b64_tr_b16 v[74:75], v32 offset:13312
v_mul_f32 v117, v117, v149
v_mfma_f32_16x16x32_bf16 v[152:155], v[92:95], a[68:71], v[152:155]
ds_read_b64_tr_b16 v[76:77], v32 offset:14336
v_mul_f32 v118, v118, v150
v_mfma_f32_16x16x32_bf16 v[156:159], v[92:95], a[140:143], v[156:159]
ds_read_b64_tr_b16 v[78:79], v32 offset:15360
s_waitcnt lgkmcnt(8)
v_mfma_f32_16x16x32_bf16 v[96:99], v[48:51], a[0:3], 0
ds_read_b64_tr_b16 v[80:81], v32 offset:16384
v_mul_f32 v119, v119, v151
v_mfma_f32_16x16x32_bf16 v[100:103], v[48:51], a[72:75], 0
ds_read_b64_tr_b16 v[82:83], v32 offset:17408
v_cvt_pk_bf16_f32 v220, v116, v117
v_mfma_f32_16x16x32_bf16 v[96:99], v[52:55], a[4:7], v[96:99]
ds_read_b64_tr_b16 v[84:85], v32 offset:18432
v_cvt_pk_bf16_f32 v221, v118, v119
v_mfma_f32_16x16x32_bf16 v[100:103], v[52:55], a[76:79], v[100:103]
ds_read_b64_tr_b16 v[86:87], v32 offset:19456
s_add_u32 m0, s32, 73728
v_mfma_f32_16x16x32_bf16 v[96:99], v[56:59], a[8:11], v[96:99]
ds_read_b64_tr_b16 v[88:89], v32 offset:20480
v_mul_f32 v120, v120, v152
v_mfma_f32_16x16x32_bf16 v[100:103], v[56:59], a[80:83], v[100:103]
ds_read_b64_tr_b16 v[90:91], v32 offset:21504
v_mul_f32 v121, v121, v153
v_mfma_f32_16x16x32_bf16 v[96:99], v[60:63], a[12:15], v[96:99]
ds_read_b64_tr_b16 v[92:93], v32 offset:22528
v_mul_f32 v122, v122, v154
v_mfma_f32_16x16x32_bf16 v[100:103], v[60:63], a[84:87], v[100:103]
ds_read_b64_tr_b16 v[94:95], v32 offset:23552
s_waitcnt lgkmcnt(8)
v_mfma_f32_16x16x32_bf16 v[96:99], v[64:67], a[16:19], v[96:99]
ds_read_b64_tr_b16 v[48:49], v32 offset:24576
v_mul_f32 v123, v123, v155
v_mfma_f32_16x16x32_bf16 v[100:103], v[64:67], a[88:91], v[100:103]
ds_read_b64_tr_b16 v[50:51], v32 offset:25600
v_cvt_pk_bf16_f32 v218, v120, v121
v_mfma_f32_16x16x32_bf16 v[96:99], v[68:71], a[20:23], v[96:99]
ds_read_b64_tr_b16 v[52:53], v32 offset:26624
v_cvt_pk_bf16_f32 v219, v122, v123
v_mfma_f32_16x16x32_bf16 v[100:103], v[68:71], a[92:95], v[100:103]
ds_read_b64_tr_b16 v[54:55], v32 offset:27648
v_mul_f32 v124, v124, v156
v_mfma_f32_16x16x32_bf16 v[96:99], v[72:75], a[24:27], v[96:99]
ds_read_b64_tr_b16 v[56:57], v32 offset:28672
v_mul_f32 v125, v125, v157
v_mfma_f32_16x16x32_bf16 v[100:103], v[72:75], a[96:99], v[100:103]
ds_read_b64_tr_b16 v[58:59], v32 offset:29696
v_mul_f32 v126, v126, v158
v_mfma_f32_16x16x32_bf16 v[96:99], v[76:79], a[28:31], v[96:99]
ds_read_b64_tr_b16 v[60:61], v32 offset:30720
v_mul_f32 v127, v127, v159
v_mfma_f32_16x16x32_bf16 v[100:103], v[76:79], a[100:103], v[100:103]
ds_read_b64_tr_b16 v[62:63], v32 offset:31744
s_waitcnt lgkmcnt(8)
v_mfma_f32_16x16x32_bf16 v[96:99], v[80:83], a[32:35], v[96:99]
ds_read_b64_tr_b16 v[64:65], v32 offset:32768
v_cvt_pk_bf16_f32 v222, v124, v125
v_mfma_f32_16x16x32_bf16 v[100:103], v[80:83], a[104:107], v[100:103]
ds_read_b64_tr_b16 v[66:67], v32 offset:33792
v_cvt_pk_bf16_f32 v223, v126, v127
v_mfma_f32_16x16x32_bf16 v[96:99], v[84:87], a[36:39], v[96:99]
ds_read_b64_tr_b16 v[68:69], v32 offset:34816
v_mfma_f32_16x16x32_bf16 v[100:103], v[84:87], a[108:111], v[100:103]
ds_read_b64_tr_b16 v[70:71], v32 offset:35840
s_add_u32 s34, s30, 0
v_mfma_f32_16x16x32_bf16 v[96:99], v[88:91], a[40:43], v[96:99]
ds_read_b64_tr_b16 v[72:73], v33 offset:0
v_mfma_f32_16x16x32_bf16 v[100:103], v[88:91], a[112:115], v[100:103]
ds_read_b64_tr_b16 v[74:75], v33 offset:1024
buffer_load_dwordx4 v44, s[16:19], s34 offen offset:0 lds
v_mfma_f32_16x16x32_bf16 v[96:99], v[92:95], a[44:47], v[96:99]
ds_read_b64_tr_b16 v[76:77], v33 offset:2048
v_mfma_f32_16x16x32_bf16 v[100:103], v[92:95], a[116:119], v[100:103]
ds_read_b64_tr_b16 v[78:79], v33 offset:3072
s_waitcnt lgkmcnt(8)
v_mfma_f32_16x16x32_bf16 v[96:99], v[48:51], a[48:51], v[96:99]
ds_read_b64_tr_b16 v[80:81], v33 offset:4096
buffer_load_dwordx4 v45, s[16:19], s34 offen offset:1024 lds
v_mfma_f32_16x16x32_bf16 v[100:103], v[48:51], a[120:123], v[100:103]
ds_read_b64_tr_b16 v[82:83], v33 offset:5120
v_mfma_f32_16x16x32_bf16 v[96:99], v[52:55], a[52:55], v[96:99]
ds_read_b64_tr_b16 v[84:85], v33 offset:6144
buffer_load_dwordx4 v46, s[16:19], s34 offen offset:2048 lds
v_mfma_f32_16x16x32_bf16 v[100:103], v[52:55], a[124:127], v[100:103]
ds_read_b64_tr_b16 v[86:87], v33 offset:7168
v_mfma_f32_16x16x32_bf16 v[96:99], v[56:59], a[56:59], v[96:99]
ds_read_b64_tr_b16 v[88:89], v33 offset:8192
buffer_load_dwordx4 v47, s[16:19], s34 offen offset:3072 lds
v_mfma_f32_16x16x32_bf16 v[100:103], v[56:59], a[128:131], v[100:103]
ds_read_b64_tr_b16 v[90:91], v33 offset:9216
v_mfma_f32_16x16x32_bf16 v[96:99], v[60:63], a[60:63], v[96:99]
ds_read_b64_tr_b16 v[92:93], v33 offset:10240
s_add_u32 m0, s32, 77824
v_mfma_f32_16x16x32_bf16 v[100:103], v[60:63], a[132:135], v[100:103]
ds_read_b64_tr_b16 v[94:95], v33 offset:11264
s_waitcnt lgkmcnt(8)
v_mfma_f32_16x16x32_bf16 v[96:99], v[64:67], a[64:67], v[96:99]
ds_read_b64_tr_b16 v[48:49], v33 offset:12288
v_mfma_f32_16x16x32_bf16 v[100:103], v[64:67], a[136:139], v[100:103]
ds_read_b64_tr_b16 v[50:51], v33 offset:13312
s_add_u32 s34, s30, 36864
v_mfma_f32_16x16x32_bf16 v[96:99], v[68:71], a[68:71], v[96:99]
ds_read_b64_tr_b16 v[52:53], v33 offset:14336
v_mfma_f32_16x16x32_bf16 v[100:103], v[68:71], a[140:143], v[100:103]
ds_read_b64_tr_b16 v[54:55], v33 offset:15360
v_mfma_f32_16x16x32_bf16 v[104:107], v[72:75], a[0:3], 0
ds_read_b64_tr_b16 v[56:57], v33 offset:16384
buffer_load_dwordx4 v44, s[16:19], s34 offen offset:0 lds
v_mfma_f32_16x16x32_bf16 v[108:111], v[72:75], a[72:75], 0
ds_read_b64_tr_b16 v[58:59], v33 offset:17408
v_mfma_f32_16x16x32_bf16 v[104:107], v[76:79], a[4:7], v[104:107]
ds_read_b64_tr_b16 v[60:61], v33 offset:18432
s_add_u32 m0, s32, 78848
v_mfma_f32_16x16x32_bf16 v[108:111], v[76:79], a[76:79], v[108:111]
ds_read_b64_tr_b16 v[62:63], v33 offset:19456
s_waitcnt lgkmcnt(8)
v_mfma_f32_16x16x32_bf16 v[104:107], v[80:83], a[8:11], v[104:107]
ds_read_b64_tr_b16 v[64:65], v33 offset:20480
v_mfma_f32_16x16x32_bf16 v[108:111], v[80:83], a[80:83], v[108:111]
ds_read_b64_tr_b16 v[66:67], v33 offset:21504
s_add_u32 s34, s31, 0
v_mfma_f32_16x16x32_bf16 v[104:107], v[84:87], a[12:15], v[104:107]
ds_read_b64_tr_b16 v[68:69], v33 offset:22528
v_mfma_f32_16x16x32_bf16 v[108:111], v[84:87], a[84:87], v[108:111]
ds_read_b64_tr_b16 v[70:71], v33 offset:23552
buffer_load_dwordx4 v44, s[16:19], s34 offen offset:0 lds
v_mfma_f32_16x16x32_bf16 v[104:107], v[88:91], a[16:19], v[104:107]
ds_read_b64_tr_b16 v[72:73], v33 offset:24576
v_mfma_f32_16x16x32_bf16 v[108:111], v[88:91], a[88:91], v[108:111]
ds_read_b64_tr_b16 v[74:75], v33 offset:25600
buffer_load_dwordx4 v45, s[16:19], s34 offen offset:1024 lds
v_mfma_f32_16x16x32_bf16 v[104:107], v[92:95], a[20:23], v[104:107]
ds_read_b64_tr_b16 v[76:77], v33 offset:26624
v_mfma_f32_16x16x32_bf16 v[108:111], v[92:95], a[92:95], v[108:111]
ds_read_b64_tr_b16 v[78:79], v33 offset:27648
s_waitcnt lgkmcnt(8)
v_mfma_f32_16x16x32_bf16 v[104:107], v[48:51], a[24:27], v[104:107]
ds_read_b64_tr_b16 v[80:81], v33 offset:28672
buffer_load_dwordx4 v46, s[16:19], s34 offen offset:2048 lds
v_mfma_f32_16x16x32_bf16 v[108:111], v[48:51], a[96:99], v[108:111]
ds_read_b64_tr_b16 v[82:83], v33 offset:29696
v_mfma_f32_16x16x32_bf16 v[104:107], v[52:55], a[28:31], v[104:107]
ds_read_b64_tr_b16 v[84:85], v33 offset:30720
buffer_load_dwordx4 v47, s[16:19], s34 offen offset:3072 lds
v_mfma_f32_16x16x32_bf16 v[108:111], v[52:55], a[100:103], v[108:111]
ds_read_b64_tr_b16 v[86:87], v33 offset:31744
v_mfma_f32_16x16x32_bf16 v[104:107], v[56:59], a[32:35], v[104:107]
ds_read_b64_tr_b16 v[88:89], v33 offset:32768
v_mfma_f32_16x16x32_bf16 v[108:111], v[56:59], a[104:107], v[108:111]
ds_read_b64_tr_b16 v[90:91], v33 offset:33792
s_waitcnt vmcnt(9)
v_mfma_f32_16x16x32_bf16 v[104:107], v[60:63], a[36:39], v[104:107]
ds_read_b64_tr_b16 v[92:93], v33 offset:34816
s_barrier
v_mfma_f32_16x16x32_bf16 v[108:111], v[60:63], a[108:111], v[108:111]
ds_read_b64_tr_b16 v[94:95], v33 offset:35840
s_waitcnt lgkmcnt(8)
v_mfma_f32_16x16x32_bf16 v[104:107], v[64:67], a[40:43], v[104:107]
ds_read_b64_tr_b16 v[48:49], v34 offset:0
v_mfma_f32_16x16x32_bf16 v[108:111], v[64:67], a[112:115], v[108:111]
ds_read_b64_tr_b16 v[50:51], v34 offset:1024
v_mfma_f32_16x16x32_bf16 v[104:107], v[68:71], a[44:47], v[104:107]
ds_read_b64_tr_b16 v[52:53], v34 offset:2048
v_mfma_f32_16x16x32_bf16 v[108:111], v[68:71], a[116:119], v[108:111]
ds_read_b64_tr_b16 v[54:55], v34 offset:3072
v_mfma_f32_16x16x32_bf16 v[104:107], v[72:75], a[48:51], v[104:107]
ds_read_b64_tr_b16 v[56:57], v34 offset:4096
v_mfma_f32_16x16x32_bf16 v[108:111], v[72:75], a[120:123], v[108:111]
ds_read_b64_tr_b16 v[58:59], v34 offset:5120
v_mfma_f32_16x16x32_bf16 v[104:107], v[76:79], a[52:55], v[104:107]
ds_read_b64_tr_b16 v[60:61], v34 offset:6144
v_mfma_f32_16x16x32_bf16 v[108:111], v[76:79], a[124:127], v[108:111]
ds_read_b64_tr_b16 v[62:63], v34 offset:7168
s_waitcnt lgkmcnt(8)
v_mfma_f32_16x16x32_bf16 v[104:107], v[80:83], a[56:59], v[104:107]
ds_read_b64_tr_b16 v[64:65], v34 offset:8192
v_mfma_f32_16x16x32_bf16 v[108:111], v[80:83], a[128:131], v[108:111]
ds_read_b64_tr_b16 v[66:67], v34 offset:9216
v_mfma_f32_16x16x32_bf16 v[104:107], v[84:87], a[60:63], v[104:107]
ds_read_b64_tr_b16 v[68:69], v34 offset:10240
v_mfma_f32_16x16x32_bf16 v[108:111], v[84:87], a[132:135], v[108:111]
ds_read_b64_tr_b16 v[70:71], v34 offset:11264
v_mfma_f32_16x16x32_bf16 v[104:107], v[88:91], a[64:67], v[104:107]
ds_read_b64_tr_b16 v[72:73], v34 offset:12288
v_mfma_f32_16x16x32_bf16 v[108:111], v[88:91], a[136:139], v[108:111]
ds_read_b64_tr_b16 v[74:75], v34 offset:13312
v_mfma_f32_16x16x32_bf16 v[104:107], v[92:95], a[68:71], v[104:107]
ds_read_b64_tr_b16 v[76:77], v34 offset:14336
v_mfma_f32_16x16x32_bf16 v[108:111], v[92:95], a[140:143], v[108:111]
ds_read_b64_tr_b16 v[78:79], v34 offset:15360
s_waitcnt lgkmcnt(8)
v_mfma_f32_16x16x32_bf16 v[128:131], v[48:51], a[0:3], 0
ds_read_b64_tr_b16 v[80:81], v34 offset:16384
s_add_u32 m0, s32, 110592
v_mfma_f32_16x16x32_bf16 v[132:135], v[48:51], a[72:75], 0
ds_read_b64_tr_b16 v[82:83], v34 offset:17408
v_mfma_f32_16x16x32_bf16 v[128:131], v[52:55], a[4:7], v[128:131]
ds_read_b64_tr_b16 v[84:85], v34 offset:18432
s_add_u32 s34, s30, 128
v_mfma_f32_16x16x32_bf16 v[132:135], v[52:55], a[76:79], v[132:135]
ds_read_b64_tr_b16 v[86:87], v34 offset:19456
v_mfma_f32_16x16x32_bf16 v[128:131], v[56:59], a[8:11], v[128:131]
ds_read_b64_tr_b16 v[88:89], v34 offset:20480
buffer_load_dwordx4 v44, s[16:19], s34 offen offset:0 lds
v_mfma_f32_16x16x32_bf16 v[132:135], v[56:59], a[80:83], v[132:135]
ds_read_b64_tr_b16 v[90:91], v34 offset:21504
v_mfma_f32_16x16x32_bf16 v[128:131], v[60:63], a[12:15], v[128:131]
ds_read_b64_tr_b16 v[92:93], v34 offset:22528
v_mfma_f32_16x16x32_bf16 v[132:135], v[60:63], a[84:87], v[132:135]
ds_read_b64_tr_b16 v[94:95], v34 offset:23552
s_waitcnt lgkmcnt(8)
v_mfma_f32_16x16x32_bf16 v[128:131], v[64:67], a[16:19], v[128:131]
ds_read_b64_tr_b16 v[48:49], v34 offset:24576
buffer_load_dwordx4 v45, s[16:19], s34 offen offset:1024 lds
v_mfma_f32_16x16x32_bf16 v[132:135], v[64:67], a[88:91], v[132:135]
ds_read_b64_tr_b16 v[50:51], v34 offset:25600
v_mfma_f32_16x16x32_bf16 v[128:131], v[68:71], a[20:23], v[128:131]
ds_read_b64_tr_b16 v[52:53], v34 offset:26624
buffer_load_dwordx4 v46, s[16:19], s34 offen offset:2048 lds
v_mfma_f32_16x16x32_bf16 v[132:135], v[68:71], a[92:95], v[132:135]
ds_read_b64_tr_b16 v[54:55], v34 offset:27648
v_mfma_f32_16x16x32_bf16 v[128:131], v[72:75], a[24:27], v[128:131]
ds_read_b64_tr_b16 v[56:57], v34 offset:28672
buffer_load_dwordx4 v47, s[16:19], s34 offen offset:3072 lds
v_mfma_f32_16x16x32_bf16 v[132:135], v[72:75], a[96:99], v[132:135]
ds_read_b64_tr_b16 v[58:59], v34 offset:29696
v_mfma_f32_16x16x32_bf16 v[128:131], v[76:79], a[28:31], v[128:131]
ds_read_b64_tr_b16 v[60:61], v34 offset:30720
v_mfma_f32_16x16x32_bf16 v[132:135], v[76:79], a[100:103], v[132:135]
ds_read_b64_tr_b16 v[62:63], v34 offset:31744
s_waitcnt lgkmcnt(8)
v_mfma_f32_16x16x32_bf16 v[128:131], v[80:83], a[32:35], v[128:131]
ds_read_b64_tr_b16 v[64:65], v34 offset:32768
s_add_u32 m0, s32, 114688
v_mfma_f32_16x16x32_bf16 v[132:135], v[80:83], a[104:107], v[132:135]
ds_read_b64_tr_b16 v[66:67], v34 offset:33792
v_mfma_f32_16x16x32_bf16 v[128:131], v[84:87], a[36:39], v[128:131]
ds_read_b64_tr_b16 v[68:69], v34 offset:34816
s_add_u32 s34, s30, 36992
v_mfma_f32_16x16x32_bf16 v[132:135], v[84:87], a[108:111], v[132:135]
ds_read_b64_tr_b16 v[70:71], v34 offset:35840
v_mfma_f32_16x16x32_bf16 v[128:131], v[88:91], a[40:43], v[128:131]
ds_read_b64_tr_b16 v[72:73], v35 offset:0
buffer_load_dwordx4 v44, s[16:19], s34 offen offset:0 lds
v_mfma_f32_16x16x32_bf16 v[132:135], v[88:91], a[112:115], v[132:135]
ds_read_b64_tr_b16 v[74:75], v35 offset:1024
v_mfma_f32_16x16x32_bf16 v[128:131], v[92:95], a[44:47], v[128:131]
ds_read_b64_tr_b16 v[76:77], v35 offset:2048
v_mfma_f32_16x16x32_bf16 v[132:135], v[92:95], a[116:119], v[132:135]
ds_read_b64_tr_b16 v[78:79], v35 offset:3072
s_waitcnt lgkmcnt(8)
v_mfma_f32_16x16x32_bf16 v[128:131], v[48:51], a[48:51], v[128:131]
ds_read_b64_tr_b16 v[80:81], v35 offset:4096
s_add_u32 m0, s32, 115712
v_mfma_f32_16x16x32_bf16 v[132:135], v[48:51], a[120:123], v[132:135]
ds_read_b64_tr_b16 v[82:83], v35 offset:5120
v_mfma_f32_16x16x32_bf16 v[128:131], v[52:55], a[52:55], v[128:131]
ds_read_b64_tr_b16 v[84:85], v35 offset:6144
s_add_u32 s34, s31, 128
v_mfma_f32_16x16x32_bf16 v[132:135], v[52:55], a[124:127], v[132:135]
ds_read_b64_tr_b16 v[86:87], v35 offset:7168
v_mfma_f32_16x16x32_bf16 v[128:131], v[56:59], a[56:59], v[128:131]
ds_read_b64_tr_b16 v[88:89], v35 offset:8192
buffer_load_dwordx4 v44, s[16:19], s34 offen offset:0 lds
v_mfma_f32_16x16x32_bf16 v[132:135], v[56:59], a[128:131], v[132:135]
ds_read_b64_tr_b16 v[90:91], v35 offset:9216
v_mfma_f32_16x16x32_bf16 v[128:131], v[60:63], a[60:63], v[128:131]
ds_read_b64_tr_b16 v[92:93], v35 offset:10240
v_mfma_f32_16x16x32_bf16 v[132:135], v[60:63], a[132:135], v[132:135]
ds_read_b64_tr_b16 v[94:95], v35 offset:11264
s_waitcnt lgkmcnt(8)
v_mfma_f32_16x16x32_bf16 v[128:131], v[64:67], a[64:67], v[128:131]
ds_read_b64_tr_b16 v[48:49], v35 offset:12288
buffer_load_dwordx4 v45, s[16:19], s34 offen offset:1024 lds
v_mfma_f32_16x16x32_bf16 v[132:135], v[64:67], a[136:139], v[132:135]
ds_read_b64_tr_b16 v[50:51], v35 offset:13312
v_mfma_f32_16x16x32_bf16 v[128:131], v[68:71], a[68:71], v[128:131]
ds_read_b64_tr_b16 v[52:53], v35 offset:14336
buffer_load_dwordx4 v46, s[16:19], s34 offen offset:2048 lds
v_mfma_f32_16x16x32_bf16 v[132:135], v[68:71], a[140:143], v[132:135]
ds_read_b64_tr_b16 v[54:55], v35 offset:15360
v_mfma_f32_16x16x32_bf16 v[136:139], v[72:75], a[0:3], 0
ds_read_b64_tr_b16 v[56:57], v35 offset:16384
buffer_load_dwordx4 v47, s[16:19], s34 offen offset:3072 lds
v_mfma_f32_16x16x32_bf16 v[140:143], v[72:75], a[72:75], 0
ds_read_b64_tr_b16 v[58:59], v35 offset:17408
v_mfma_f32_16x16x32_bf16 v[136:139], v[76:79], a[4:7], v[136:139]
ds_read_b64_tr_b16 v[60:61], v35 offset:18432
v_mfma_f32_16x16x32_bf16 v[140:143], v[76:79], a[76:79], v[140:143]
ds_read_b64_tr_b16 v[62:63], v35 offset:19456
s_waitcnt lgkmcnt(8)
v_mfma_f32_16x16x32_bf16 v[136:139], v[80:83], a[8:11], v[136:139]
ds_read_b64_tr_b16 v[64:65], v35 offset:20480
v_mul_f32 v96, v96, v128
v_mfma_f32_16x16x32_bf16 v[140:143], v[80:83], a[80:83], v[140:143]
ds_read_b64_tr_b16 v[66:67], v35 offset:21504
v_mul_f32 v97, v97, v129
v_mfma_f32_16x16x32_bf16 v[136:139], v[84:87], a[12:15], v[136:139]
ds_read_b64_tr_b16 v[68:69], v35 offset:22528
v_mul_f32 v98, v98, v130
v_mfma_f32_16x16x32_bf16 v[140:143], v[84:87], a[84:87], v[140:143]
ds_read_b64_tr_b16 v[70:71], v35 offset:23552
v_mul_f32 v99, v99, v131
v_mfma_f32_16x16x32_bf16 v[136:139], v[88:91], a[16:19], v[136:139]
L_mlp_pad6:
s_cbranch_execz L_mlp_padret
ds_read_b64_tr_b16 v[72:73], v35 offset:24576
v_cvt_pk_bf16_f32 v224, v96, v97
v_mfma_f32_16x16x32_bf16 v[140:143], v[88:91], a[88:91], v[140:143]
ds_read_b64_tr_b16 v[74:75], v35 offset:25600
v_cvt_pk_bf16_f32 v225, v98, v99
v_mfma_f32_16x16x32_bf16 v[136:139], v[92:95], a[20:23], v[136:139]
ds_read_b64_tr_b16 v[76:77], v35 offset:26624
v_mul_f32 v100, v100, v132
v_mfma_f32_16x16x32_bf16 v[140:143], v[92:95], a[92:95], v[140:143]
ds_read_b64_tr_b16 v[78:79], v35 offset:27648
s_waitcnt lgkmcnt(8)
v_mfma_f32_16x16x32_bf16 v[136:139], v[48:51], a[24:27], v[136:139]
ds_read_b64_tr_b16 v[80:81], v35 offset:28672
v_mul_f32 v101, v101, v133
v_mfma_f32_16x16x32_bf16 v[140:143], v[48:51], a[96:99], v[140:143]
ds_read_b64_tr_b16 v[82:83], v35 offset:29696
v_mul_f32 v102, v102, v134
v_mfma_f32_16x16x32_bf16 v[136:139], v[52:55], a[28:31], v[136:139]
ds_read_b64_tr_b16 v[84:85], v35 offset:30720
v_mul_f32 v103, v103, v135
v_mfma_f32_16x16x32_bf16 v[140:143], v[52:55], a[100:103], v[140:143]
ds_read_b64_tr_b16 v[86:87], v35 offset:31744
v_cvt_pk_bf16_f32 v228, v100, v101
v_mfma_f32_16x16x32_bf16 v[136:139], v[56:59], a[32:35], v[136:139]
ds_read_b64_tr_b16 v[88:89], v35 offset:32768
v_cvt_pk_bf16_f32 v229, v102, v103
v_mfma_f32_16x16x32_bf16 v[140:143], v[56:59], a[104:107], v[140:143]
ds_read_b64_tr_b16 v[90:91], v35 offset:33792
s_waitcnt vmcnt(9)
v_mfma_f32_16x16x32_bf16 v[136:139], v[60:63], a[36:39], v[136:139]
ds_read_b64_tr_b16 v[92:93], v35 offset:34816
s_barrier
v_mfma_f32_16x16x32_bf16 v[140:143], v[60:63], a[108:111], v[140:143]
ds_read_b64_tr_b16 v[94:95], v35 offset:35840
s_waitcnt lgkmcnt(8)
v_mfma_f32_16x16x32_bf16 v[136:139], v[64:67], a[40:43], v[136:139]
ds_read_b64_tr_b16 v[48:49], v24 offset:0
v_mfma_f32_16x16x32_bf16 v[140:143], v[64:67], a[112:115], v[140:143]
ds_read_b64_tr_b16 v[50:51], v24 offset:2048
v_mfma_f32_16x16x32_bf16 v[136:139], v[68:71], a[44:47], v[136:139]
ds_read_b64_tr_b16 v[52:53], v25 offset:0
v_mfma_f32_16x16x32_bf16 v[140:143], v[68:71], a[116:119], v[140:143]
ds_read_b64_tr_b16 v[54:55], v25 offset:2048
v_mfma_f32_16x16x32_bf16 v[136:139], v[72:75], a[48:51], v[136:139]
ds_read_b64_tr_b16 v[56:57], v24 offset:4096
v_mfma_f32_16x16x32_bf16 v[140:143], v[72:75], a[120:123], v[140:143]
ds_read_b64_tr_b16 v[58:59], v24 offset:6144
v_mfma_f32_16x16x32_bf16 v[136:139], v[76:79], a[52:55], v[136:139]
ds_read_b64_tr_b16 v[60:61], v25 offset:4096
v_mfma_f32_16x16x32_bf16 v[140:143], v[76:79], a[124:127], v[140:143]
ds_read_b64_tr_b16 v[62:63], v25 offset:6144
s_waitcnt lgkmcnt(8)
v_mfma_f32_16x16x32_bf16 v[136:139], v[80:83], a[56:59], v[136:139]
ds_read_b64_tr_b16 v[64:65], v24 offset:8192
v_mfma_f32_16x16x32_bf16 v[140:143], v[80:83], a[128:131], v[140:143]
ds_read_b64_tr_b16 v[66:67], v24 offset:10240
v_mfma_f32_16x16x32_bf16 v[136:139], v[84:87], a[60:63], v[136:139]
ds_read_b64_tr_b16 v[68:69], v25 offset:8192
v_mfma_f32_16x16x32_bf16 v[140:143], v[84:87], a[132:135], v[140:143]
ds_read_b64_tr_b16 v[70:71], v25 offset:10240
v_mfma_f32_16x16x32_bf16 v[136:139], v[88:91], a[64:67], v[136:139]
ds_read_b64_tr_b16 v[72:73], v24 offset:12288
v_mfma_f32_16x16x32_bf16 v[140:143], v[88:91], a[136:139], v[140:143]
ds_read_b64_tr_b16 v[74:75], v24 offset:14336
v_mfma_f32_16x16x32_bf16 v[136:139], v[92:95], a[68:71], v[136:139]
ds_read_b64_tr_b16 v[76:77], v25 offset:12288
v_mfma_f32_16x16x32_bf16 v[140:143], v[92:95], a[140:143], v[140:143]
ds_read_b64_tr_b16 v[78:79], v25 offset:14336
s_waitcnt lgkmcnt(8)
v_mfma_f32_16x16x32_bf16 v[112:115], v[48:51], v[160:163], 0
ds_read_b64_tr_b16 v[80:81], v24 offset:16384
s_add_u32 m0, s32, 0
v_mfma_f32_16x16x32_bf16 v[116:119], v[48:51], v[164:167], 0
ds_read_b64_tr_b16 v[82:83], v24 offset:18432
s_add_u32 s34, s30, 256
v_mfma_f32_16x16x32_bf16 v[120:123], v[52:55], v[160:163], 0
ds_read_b64_tr_b16 v[84:85], v25 offset:16384
v_mfma_f32_16x16x32_bf16 v[124:127], v[52:55], v[164:167], 0
ds_read_b64_tr_b16 v[86:87], v25 offset:18432
buffer_load_dwordx4 v44, s[16:19], s34 offen offset:0 lds
v_mfma_f32_16x16x32_bf16 v[112:115], v[56:59], v[168:171], v[112:115]
ds_read_b64_tr_b16 v[88:89], v24 offset:20480
v_mul_f32 v104, v104, v136
v_mfma_f32_16x16x32_bf16 v[116:119], v[56:59], v[172:175], v[116:119]
ds_read_b64_tr_b16 v[90:91], v24 offset:22528
v_mul_f32 v105, v105, v137
v_mfma_f32_16x16x32_bf16 v[120:123], v[60:63], v[168:171], v[120:123]
ds_read_b64_tr_b16 v[92:93], v25 offset:20480
v_mul_f32 v106, v106, v138
v_mfma_f32_16x16x32_bf16 v[124:127], v[60:63], v[172:175], v[124:127]
ds_read_b64_tr_b16 v[94:95], v25 offset:22528
s_waitcnt lgkmcnt(8)
v_mfma_f32_16x16x32_bf16 v[112:115], v[64:67], v[176:179], v[112:115]
ds_read_b64_tr_b16 v[48:49], v24 offset:24576
v_mul_f32 v107, v107, v139
v_mfma_f32_16x16x32_bf16 v[116:119], v[64:67], v[180:183], v[116:119]
ds_read_b64_tr_b16 v[50:51], v24 offset:26624
v_cvt_pk_bf16_f32 v226, v104, v105
v_mfma_f32_16x16x32_bf16 v[120:123], v[68:71], v[176:179], v[120:123]
ds_read_b64_tr_b16 v[52:53], v25 offset:24576
v_cvt_pk_bf16_f32 v227, v106, v107
v_mfma_f32_16x16x32_bf16 v[124:127], v[68:71], v[180:183], v[124:127]
ds_read_b64_tr_b16 v[54:55], v25 offset:26624
v_mul_f32 v108, v108, v140
v_mfma_f32_16x16x32_bf16 v[112:115], v[72:75], v[184:187], v[112:115]
ds_read_b64_tr_b16 v[56:57], v24 offset:28672
v_mul_f32 v109, v109, v141
v_mfma_f32_16x16x32_bf16 v[116:119], v[72:75], v[188:191], v[116:119]
ds_read_b64_tr_b16 v[58:59], v24 offset:30720
v_mul_f32 v110, v110, v142
v_mfma_f32_16x16x32_bf16 v[120:123], v[76:79], v[184:187], v[120:123]
ds_read_b64_tr_b16 v[60:61], v25 offset:28672
v_mul_f32 v111, v111, v143
v_mfma_f32_16x16x32_bf16 v[124:127], v[76:79], v[188:191], v[124:127]
ds_read_b64_tr_b16 v[62:63], v25 offset:30720
s_waitcnt lgkmcnt(8)
v_mfma_f32_16x16x32_bf16 v[112:115], v[80:83], v[192:195], v[112:115]
ds_read_b64_tr_b16 v[64:65], v24 offset:32768
v_cvt_pk_bf16_f32 v230, v108, v109
v_mfma_f32_16x16x32_bf16 v[116:119], v[80:83], v[196:199], v[116:119]
ds_read_b64_tr_b16 v[66:67], v24 offset:34816
v_cvt_pk_bf16_f32 v231, v110, v111
v_mfma_f32_16x16x32_bf16 v[120:123], v[84:87], v[192:195], v[120:123]
ds_read_b64_tr_b16 v[68:69], v25 offset:32768
buffer_load_dwordx4 v45, s[16:19], s34 offen offset:1024 lds
v_mfma_f32_16x16x32_bf16 v[124:127], v[84:87], v[196:199], v[124:127]
ds_read_b64_tr_b16 v[70:71], v25 offset:34816
v_mfma_f32_16x16x32_bf16 v[112:115], v[88:91], v[200:203], v[112:115]
ds_read_b64_tr_b16 v[72:73], v26 offset:0
buffer_load_dwordx4 v46, s[16:19], s34 offen offset:2048 lds
v_mfma_f32_16x16x32_bf16 v[116:119], v[88:91], v[204:207], v[116:119]
ds_read_b64_tr_b16 v[74:75], v26 offset:2048
buffer_load_dwordx4 v47, s[16:19], s34 offen offset:3072 lds
v_mfma_f32_16x16x32_bf16 v[120:123], v[92:95], v[200:203], v[120:123]
ds_read_b64_tr_b16 v[76:77], v26 offset:4096
v_mfma_f32_16x16x32_bf16 v[124:127], v[92:95], v[204:207], v[124:127]
ds_read_b64_tr_b16 v[78:79], v26 offset:6144
s_waitcnt lgkmcnt(8)
v_mfma_f32_16x16x32_bf16 v[112:115], v[48:51], v[208:211], v[112:115]
ds_read_b64_tr_b16 v[80:81], v26 offset:8192
s_add_u32 m0, s32, 4096
v_mfma_f32_16x16x32_bf16 v[116:119], v[48:51], v[212:215], v[116:119]
ds_read_b64_tr_b16 v[82:83], v26 offset:10240
s_add_u32 s34, s30, 37120
v_mfma_f32_16x16x32_bf16 v[120:123], v[52:55], v[208:211], v[120:123]
ds_read_b64_tr_b16 v[84:85], v26 offset:12288
v_mfma_f32_16x16x32_bf16 v[124:127], v[52:55], v[212:215], v[124:127]
ds_read_b64_tr_b16 v[86:87], v26 offset:14336
buffer_load_dwordx4 v44, s[16:19], s34 offen offset:0 lds
v_mfma_f32_16x16x32_bf16 v[112:115], v[56:59], v[216:219], v[112:115]
ds_read_b64_tr_b16 v[88:89], v26 offset:16384
s_add_u32 m0, s32, 5120
v_mfma_f32_16x16x32_bf16 v[116:119], v[56:59], v[220:223], v[116:119]
ds_read_b64_tr_b16 v[90:91], v26 offset:18432
v_mfma_f32_16x16x32_bf16 v[120:123], v[60:63], v[216:219], v[120:123]
ds_read_b64_tr_b16 v[92:93], v26 offset:20480
s_add_u32 s34, s31, 256
v_mfma_f32_16x16x32_bf16 v[124:127], v[60:63], v[220:223], v[124:127]
ds_read_b64_tr_b16 v[94:95], v26 offset:22528
s_waitcnt lgkmcnt(8)
v_mfma_f32_16x16x32_bf16 v[112:115], v[64:67], v[224:227], v[112:115]
ds_read_b64_tr_b16 v[48:49], v26 offset:24576
buffer_load_dwordx4 v44, s[16:19], s34 offen offset:0 lds
v_mfma_f32_16x16x32_bf16 v[116:119], v[64:67], v[228:231], v[116:119]
ds_read_b64_tr_b16 v[50:51], v26 offset:26624
v_mfma_f32_16x16x32_bf16 v[120:123], v[68:71], v[224:227], v[120:123]
ds_read_b64_tr_b16 v[52:53], v26 offset:28672
buffer_load_dwordx4 v45, s[16:19], s34 offen offset:1024 lds
v_mfma_f32_16x16x32_bf16 v[124:127], v[68:71], v[228:231], v[124:127]
ds_read_b64_tr_b16 v[54:55], v26 offset:30720
buffer_load_dwordx4 v46, s[16:19], s34 offen offset:2048 lds
v_mfma_f32_16x16x32_bf16 v[144:147], v[72:75], v[160:163], 0
ds_read_b64_tr_b16 v[56:57], v26 offset:32768
v_mfma_f32_16x16x32_bf16 v[148:151], v[72:75], v[164:167], 0
ds_read_b64_tr_b16 v[58:59], v26 offset:34816
buffer_load_dwordx4 v47, s[16:19], s34 offen offset:3072 lds
v_mfma_f32_16x16x32_bf16 v[144:147], v[76:79], v[168:171], v[144:147]
ds_read_b64_tr_b16 v[60:61], v27 offset:0
v_cvt_pk_bf16_f32 v232, v112, v113
v_mfma_f32_16x16x32_bf16 v[148:151], v[76:79], v[172:175], v[148:151]
ds_read_b64_tr_b16 v[62:63], v27 offset:2048
s_waitcnt lgkmcnt(8)
v_mfma_f32_16x16x32_bf16 v[144:147], v[80:83], v[176:179], v[144:147]
ds_read_b64_tr_b16 v[64:65], v27 offset:4096
v_cvt_pk_bf16_f32 v233, v114, v115
v_mfma_f32_16x16x32_bf16 v[148:151], v[80:83], v[180:183], v[148:151]
ds_read_b64_tr_b16 v[66:67], v27 offset:6144
v_cvt_pk_bf16_f32 v234, v116, v117
v_mfma_f32_16x16x32_bf16 v[144:147], v[84:87], v[184:187], v[144:147]
ds_read_b64_tr_b16 v[68:69], v27 offset:8192
v_cvt_pk_bf16_f32 v235, v118, v119
v_mfma_f32_16x16x32_bf16 v[148:151], v[84:87], v[188:191], v[148:151]
ds_read_b64_tr_b16 v[70:71], v27 offset:10240
s_add_u32 s36, s33, 0
v_mfma_f32_16x16x32_bf16 v[144:147], v[88:91], v[192:195], v[144:147]
ds_read_b64_tr_b16 v[72:73], v27 offset:12288
buffer_store_dwordx4 v[232:235], v240, s[20:23], s36 offen sc0 sc1
v_mfma_f32_16x16x32_bf16 v[148:151], v[88:91], v[196:199], v[148:151]
ds_read_b64_tr_b16 v[74:75], v27 offset:14336
v_cvt_pk_bf16_f32 v236, v120, v121
v_mfma_f32_16x16x32_bf16 v[144:147], v[92:95], v[200:203], v[144:147]
ds_read_b64_tr_b16 v[76:77], v27 offset:16384
v_cvt_pk_bf16_f32 v237, v122, v123
v_mfma_f32_16x16x32_bf16 v[148:151], v[92:95], v[204:207], v[148:151]
ds_read_b64_tr_b16 v[78:79], v27 offset:18432
s_waitcnt lgkmcnt(8)
v_mfma_f32_16x16x32_bf16 v[144:147], v[48:51], v[208:211], v[144:147]
ds_read_b64_tr_b16 v[80:81], v27 offset:20480
v_cvt_pk_bf16_f32 v238, v124, v125
v_mfma_f32_16x16x32_bf16 v[148:151], v[48:51], v[212:215], v[148:151]
ds_read_b64_tr_b16 v[82:83], v27 offset:22528
v_cvt_pk_bf16_f32 v239, v126, v127
v_mfma_f32_16x16x32_bf16 v[144:147], v[52:55], v[216:219], v[144:147]
ds_read_b64_tr_b16 v[84:85], v27 offset:24576
s_add_u32 s36, s33, 16384
v_mfma_f32_16x16x32_bf16 v[148:151], v[52:55], v[220:223], v[148:151]
ds_read_b64_tr_b16 v[86:87], v27 offset:26624
buffer_store_dwordx4 v[236:239], v240, s[20:23], s36 offen sc0 sc1
v_mfma_f32_16x16x32_bf16 v[144:147], v[56:59], v[224:227], v[144:147]
ds_read_b64_tr_b16 v[88:89], v27 offset:28672
v_mfma_f32_16x16x32_bf16 v[148:151], v[56:59], v[228:231], v[148:151]
ds_read_b64_tr_b16 v[90:91], v27 offset:30720
s_waitcnt vmcnt(11)
v_mfma_f32_16x16x32_bf16 v[152:155], v[60:63], v[160:163], 0
ds_read_b64_tr_b16 v[92:93], v27 offset:32768
s_barrier
v_mfma_f32_16x16x32_bf16 v[156:159], v[60:63], v[164:167], 0
ds_read_b64_tr_b16 v[94:95], v27 offset:34816
s_waitcnt lgkmcnt(8)
v_mfma_f32_16x16x32_bf16 v[152:155], v[64:67], v[168:171], v[152:155]
ds_read_b64_tr_b16 v[48:49], v28 offset:0
v_mfma_f32_16x16x32_bf16 v[156:159], v[64:67], v[172:175], v[156:159]
ds_read_b64_tr_b16 v[50:51], v28 offset:2048
v_mfma_f32_16x16x32_bf16 v[152:155], v[68:71], v[176:179], v[152:155]
ds_read_b64_tr_b16 v[52:53], v28 offset:4096
v_cvt_pk_bf16_f32 v232, v144, v145
v_mfma_f32_16x16x32_bf16 v[156:159], v[68:71], v[180:183], v[156:159]
ds_read_b64_tr_b16 v[54:55], v28 offset:6144
v_cvt_pk_bf16_f32 v233, v146, v147
v_mfma_f32_16x16x32_bf16 v[152:155], v[72:75], v[184:187], v[152:155]
ds_read_b64_tr_b16 v[56:57], v28 offset:8192
v_cvt_pk_bf16_f32 v234, v148, v149
v_mfma_f32_16x16x32_bf16 v[156:159], v[72:75], v[188:191], v[156:159]
ds_read_b64_tr_b16 v[58:59], v28 offset:10240
v_cvt_pk_bf16_f32 v235, v150, v151
v_mfma_f32_16x16x32_bf16 v[152:155], v[76:79], v[192:195], v[152:155]
ds_read_b64_tr_b16 v[60:61], v28 offset:12288
s_add_u32 s36, s33, 32768
v_mfma_f32_16x16x32_bf16 v[156:159], v[76:79], v[196:199], v[156:159]
ds_read_b64_tr_b16 v[62:63], v28 offset:14336
s_waitcnt lgkmcnt(8)
v_mfma_f32_16x16x32_bf16 v[152:155], v[80:83], v[200:203], v[152:155]
ds_read_b64_tr_b16 v[64:65], v28 offset:16384
buffer_store_dwordx4 v[232:235], v240, s[20:23], s36 offen sc0 sc1
v_mfma_f32_16x16x32_bf16 v[156:159], v[80:83], v[204:207], v[156:159]
ds_read_b64_tr_b16 v[66:67], v28 offset:18432
v_mfma_f32_16x16x32_bf16 v[152:155], v[84:87], v[208:211], v[152:155]
ds_read_b64_tr_b16 v[68:69], v28 offset:20480
v_mfma_f32_16x16x32_bf16 v[156:159], v[84:87], v[212:215], v[156:159]
ds_read_b64_tr_b16 v[70:71], v28 offset:22528
v_mfma_f32_16x16x32_bf16 v[152:155], v[88:91], v[216:219], v[152:155]
ds_read_b64_tr_b16 v[72:73], v28 offset:24576
v_mfma_f32_16x16x32_bf16 v[156:159], v[88:91], v[220:223], v[156:159]
ds_read_b64_tr_b16 v[74:75], v28 offset:26624
v_mfma_f32_16x16x32_bf16 v[152:155], v[92:95], v[224:227], v[152:155]
ds_read_b64_tr_b16 v[76:77], v28 offset:28672
v_mfma_f32_16x16x32_bf16 v[156:159], v[92:95], v[228:231], v[156:159]
ds_read_b64_tr_b16 v[78:79], v28 offset:30720
s_waitcnt lgkmcnt(8)
v_mfma_f32_16x16x32_bf16 v[112:115], v[48:51], v[160:163], 0
ds_read_b64_tr_b16 v[80:81], v28 offset:32768
s_add_u32 m0, s32, 36864
v_mfma_f32_16x16x32_bf16 v[116:119], v[48:51], v[164:167], 0
ds_read_b64_tr_b16 v[82:83], v28 offset:34816
s_add_u32 s34, s30, 384
v_mfma_f32_16x16x32_bf16 v[112:115], v[52:55], v[168:171], v[112:115]
ds_read_b64_tr_b16 v[84:85], v29 offset:0
v_mfma_f32_16x16x32_bf16 v[116:119], v[52:55], v[172:175], v[116:119]
ds_read_b64_tr_b16 v[86:87], v29 offset:2048
buffer_load_dwordx4 v44, s[16:19], s34 offen offset:0 lds
v_mfma_f32_16x16x32_bf16 v[112:115], v[56:59], v[176:179], v[112:115]
ds_read_b64_tr_b16 v[88:89], v29 offset:4096
v_cvt_pk_bf16_f32 v236, v152, v153
v_mfma_f32_16x16x32_bf16 v[116:119], v[56:59], v[180:183], v[116:119]
ds_read_b64_tr_b16 v[90:91], v29 offset:6144
v_cvt_pk_bf16_f32 v237, v154, v155
v_mfma_f32_16x16x32_bf16 v[112:115], v[60:63], v[184:187], v[112:115]
ds_read_b64_tr_b16 v[92:93], v29 offset:8192
v_cvt_pk_bf16_f32 v238, v156, v157
v_mfma_f32_16x16x32_bf16 v[116:119], v[60:63], v[188:191], v[116:119]
ds_read_b64_tr_b16 v[94:95], v29 offset:10240
s_waitcnt lgkmcnt(8)
v_mfma_f32_16x16x32_bf16 v[112:115], v[64:67], v[192:195], v[112:115]
ds_read_b64_tr_b16 v[48:49], v29 offset:12288
v_cvt_pk_bf16_f32 v239, v158, v159
v_mfma_f32_16x16x32_bf16 v[116:119], v[64:67], v[196:199], v[116:119]
ds_read_b64_tr_b16 v[50:51], v29 offset:14336
s_add_u32 s36, s33, 49152
v_mfma_f32_16x16x32_bf16 v[112:115], v[68:71], v[200:203], v[112:115]
ds_read_b64_tr_b16 v[52:53], v29 offset:16384
buffer_store_dwordx4 v[236:239], v240, s[20:23], s36 offen sc0 sc1
v_mfma_f32_16x16x32_bf16 v[116:119], v[68:71], v[204:207], v[116:119]
ds_read_b64_tr_b16 v[54:55], v29 offset:18432
v_mfma_f32_16x16x32_bf16 v[112:115], v[72:75], v[208:211], v[112:115]
ds_read_b64_tr_b16 v[56:57], v29 offset:20480
buffer_load_dwordx4 v45, s[16:19], s34 offen offset:1024 lds
v_mfma_f32_16x16x32_bf16 v[116:119], v[72:75], v[212:215], v[116:119]
ds_read_b64_tr_b16 v[58:59], v29 offset:22528
v_mfma_f32_16x16x32_bf16 v[112:115], v[76:79], v[216:219], v[112:115]
ds_read_b64_tr_b16 v[60:61], v29 offset:24576
buffer_load_dwordx4 v46, s[16:19], s34 offen offset:2048 lds
v_mfma_f32_16x16x32_bf16 v[116:119], v[76:79], v[220:223], v[116:119]
ds_read_b64_tr_b16 v[62:63], v29 offset:26624
s_waitcnt lgkmcnt(8)
v_mfma_f32_16x16x32_bf16 v[112:115], v[80:83], v[224:227], v[112:115]
ds_read_b64_tr_b16 v[64:65], v29 offset:28672
v_mfma_f32_16x16x32_bf16 v[116:119], v[80:83], v[228:231], v[116:119]
ds_read_b64_tr_b16 v[66:67], v29 offset:30720
buffer_load_dwordx4 v47, s[16:19], s34 offen offset:3072 lds
v_mfma_f32_16x16x32_bf16 v[120:123], v[84:87], v[160:163], 0
ds_read_b64_tr_b16 v[68:69], v29 offset:32768
v_mfma_f32_16x16x32_bf16 v[124:127], v[84:87], v[164:167], 0
ds_read_b64_tr_b16 v[70:71], v29 offset:34816
s_add_u32 m0, s32, 40960
v_mfma_f32_16x16x32_bf16 v[120:123], v[88:91], v[168:171], v[120:123]
ds_read_b64_tr_b16 v[72:73], v30 offset:0
v_mfma_f32_16x16x32_bf16 v[124:127], v[88:91], v[172:175], v[124:127]
ds_read_b64_tr_b16 v[74:75], v30 offset:2048
s_add_u32 s34, s30, 37248
v_mfma_f32_16x16x32_bf16 v[120:123], v[92:95], v[176:179], v[120:123]
ds_read_b64_tr_b16 v[76:77], v30 offset:4096
v_cvt_pk_bf16_f32 v232, v112, v113
v_mfma_f32_16x16x32_bf16 v[124:127], v[92:95], v[180:183], v[124:127]
ds_read_b64_tr_b16 v[78:79], v30 offset:6144
s_waitcnt lgkmcnt(8)
v_mfma_f32_16x16x32_bf16 v[120:123], v[48:51], v[184:187], v[120:123]
ds_read_b64_tr_b16 v[80:81], v30 offset:8192
buffer_load_dwordx4 v44, s[16:19], s34 offen offset:0 lds
v_mfma_f32_16x16x32_bf16 v[124:127], v[48:51], v[188:191], v[124:127]
ds_read_b64_tr_b16 v[82:83], v30 offset:10240
v_cvt_pk_bf16_f32 v233, v114, v115
v_mfma_f32_16x16x32_bf16 v[120:123], v[52:55], v[192:195], v[120:123]
ds_read_b64_tr_b16 v[84:85], v30 offset:12288
s_add_u32 m0, s32, 41984
v_mfma_f32_16x16x32_bf16 v[124:127], v[52:55], v[196:199], v[124:127]
ds_read_b64_tr_b16 v[86:87], v30 offset:14336
v_cvt_pk_bf16_f32 v234, v116, v117
v_mfma_f32_16x16x32_bf16 v[120:123], v[56:59], v[200:203], v[120:123]
ds_read_b64_tr_b16 v[88:89], v30 offset:16384
s_add_u32 s34, s31, 384
v_mfma_f32_16x16x32_bf16 v[124:127], v[56:59], v[204:207], v[124:127]
ds_read_b64_tr_b16 v[90:91], v30 offset:18432
v_cvt_pk_bf16_f32 v235, v118, v119
v_mfma_f32_16x16x32_bf16 v[120:123], v[60:63], v[208:211], v[120:123]
ds_read_b64_tr_b16 v[92:93], v30 offset:20480
buffer_load_dwordx4 v44, s[16:19], s34 offen offset:0 lds
v_mfma_f32_16x16x32_bf16 v[124:127], v[60:63], v[212:215], v[124:127]
ds_read_b64_tr_b16 v[94:95], v30 offset:22528
s_waitcnt lgkmcnt(8)
v_mfma_f32_16x16x32_bf16 v[120:123], v[64:67], v[216:219], v[120:123]
ds_read_b64_tr_b16 v[48:49], v30 offset:24576
s_add_u32 s36, s33, 65536
v_mfma_f32_16x16x32_bf16 v[124:127], v[64:67], v[220:223], v[124:127]
ds_read_b64_tr_b16 v[50:51], v30 offset:26624
buffer_load_dwordx4 v45, s[16:19], s34 offen offset:1024 lds
v_mfma_f32_16x16x32_bf16 v[120:123], v[68:71], v[224:227], v[120:123]
ds_read_b64_tr_b16 v[52:53], v30 offset:28672
buffer_store_dwordx4 v[232:235], v240, s[20:23], s36 offen sc0 sc1
v_mfma_f32_16x16x32_bf16 v[124:127], v[68:71], v[228:231], v[124:127]
ds_read_b64_tr_b16 v[54:55], v30 offset:30720
buffer_load_dwordx4 v46, s[16:19], s34 offen offset:2048 lds
v_mfma_f32_16x16x32_bf16 v[144:147], v[72:75], v[160:163], 0
ds_read_b64_tr_b16 v[56:57], v30 offset:32768
v_mfma_f32_16x16x32_bf16 v[148:151], v[72:75], v[164:167], 0
ds_read_b64_tr_b16 v[58:59], v30 offset:34816
buffer_load_dwordx4 v47, s[16:19], s34 offen offset:3072 lds
v_mfma_f32_16x16x32_bf16 v[144:147], v[76:79], v[168:171], v[144:147]
ds_read_b64_tr_b16 v[60:61], v31 offset:0
v_mfma_f32_16x16x32_bf16 v[148:151], v[76:79], v[172:175], v[148:151]
ds_read_b64_tr_b16 v[62:63], v31 offset:2048
s_waitcnt lgkmcnt(8)
v_mfma_f32_16x16x32_bf16 v[144:147], v[80:83], v[176:179], v[144:147]
ds_read_b64_tr_b16 v[64:65], v31 offset:4096
v_cvt_pk_bf16_f32 v236, v120, v121
v_mfma_f32_16x16x32_bf16 v[148:151], v[80:83], v[180:183], v[148:151]
ds_read_b64_tr_b16 v[66:67], v31 offset:6144
v_cvt_pk_bf16_f32 v237, v122, v123
v_mfma_f32_16x16x32_bf16 v[144:147], v[84:87], v[184:187], v[144:147]
ds_read_b64_tr_b16 v[68:69], v31 offset:8192
v_cvt_pk_bf16_f32 v238, v124, v125
v_mfma_f32_16x16x32_bf16 v[148:151], v[84:87], v[188:191], v[148:151]
ds_read_b64_tr_b16 v[70:71], v31 offset:10240
v_cvt_pk_bf16_f32 v239, v126, v127
v_mfma_f32_16x16x32_bf16 v[144:147], v[88:91], v[192:195], v[144:147]
ds_read_b64_tr_b16 v[72:73], v31 offset:12288
s_add_u32 s36, s33, 81920
v_mfma_f32_16x16x32_bf16 v[148:151], v[88:91], v[196:199], v[148:151]
ds_read_b64_tr_b16 v[74:75], v31 offset:14336
buffer_store_dwordx4 v[236:239], v240, s[20:23], s36 offen sc0 sc1
v_mfma_f32_16x16x32_bf16 v[144:147], v[92:95], v[200:203], v[144:147]
ds_read_b64_tr_b16 v[76:77], v31 offset:16384
v_mfma_f32_16x16x32_bf16 v[148:151], v[92:95], v[204:207], v[148:151]
ds_read_b64_tr_b16 v[78:79], v31 offset:18432
s_waitcnt lgkmcnt(8)
v_mfma_f32_16x16x32_bf16 v[144:147], v[48:51], v[208:211], v[144:147]
ds_read_b64_tr_b16 v[80:81], v31 offset:20480
v_mfma_f32_16x16x32_bf16 v[148:151], v[48:51], v[212:215], v[148:151]
ds_read_b64_tr_b16 v[82:83], v31 offset:22528
v_mfma_f32_16x16x32_bf16 v[144:147], v[52:55], v[216:219], v[144:147]
ds_read_b64_tr_b16 v[84:85], v31 offset:24576
v_mfma_f32_16x16x32_bf16 v[148:151], v[52:55], v[220:223], v[148:151]
ds_read_b64_tr_b16 v[86:87], v31 offset:26624
v_mfma_f32_16x16x32_bf16 v[144:147], v[56:59], v[224:227], v[144:147]
ds_read_b64_tr_b16 v[88:89], v31 offset:28672
v_mfma_f32_16x16x32_bf16 v[148:151], v[56:59], v[228:231], v[148:151]
ds_read_b64_tr_b16 v[90:91], v31 offset:30720
s_waitcnt vmcnt(15)
v_mfma_f32_16x16x32_bf16 v[152:155], v[60:63], v[160:163], 0
ds_read_b64_tr_b16 v[92:93], v31 offset:32768
s_barrier
v_mfma_f32_16x16x32_bf16 v[156:159], v[60:63], v[164:167], 0
ds_read_b64_tr_b16 v[94:95], v31 offset:34816
s_waitcnt lgkmcnt(8)
v_mfma_f32_16x16x32_bf16 v[152:155], v[64:67], v[168:171], v[152:155]
ds_read_b64_tr_b16 v[48:49], v16 offset:0
v_mfma_f32_16x16x32_bf16 v[156:159], v[64:67], v[172:175], v[156:159]
ds_read_b64_tr_b16 v[50:51], v16 offset:2048
v_mfma_f32_16x16x32_bf16 v[152:155], v[68:71], v[176:179], v[152:155]
ds_read_b64_tr_b16 v[52:53], v16 offset:4096
v_cvt_pk_bf16_f32 v232, v144, v145
v_mfma_f32_16x16x32_bf16 v[156:159], v[68:71], v[180:183], v[156:159]
ds_read_b64_tr_b16 v[54:55], v16 offset:6144
v_cvt_pk_bf16_f32 v233, v146, v147
v_mfma_f32_16x16x32_bf16 v[152:155], v[72:75], v[184:187], v[152:155]
ds_read_b64_tr_b16 v[56:57], v16 offset:8192
v_cvt_pk_bf16_f32 v234, v148, v149
v_mfma_f32_16x16x32_bf16 v[156:159], v[72:75], v[188:191], v[156:159]
ds_read_b64_tr_b16 v[58:59], v16 offset:10240
v_cvt_pk_bf16_f32 v235, v150, v151
v_mfma_f32_16x16x32_bf16 v[152:155], v[76:79], v[192:195], v[152:155]
ds_read_b64_tr_b16 v[60:61], v16 offset:12288
s_add_u32 s36, s33, 98304
v_mfma_f32_16x16x32_bf16 v[156:159], v[76:79], v[196:199], v[156:159]
ds_read_b64_tr_b16 v[62:63], v16 offset:14336
s_waitcnt lgkmcnt(8)
v_mfma_f32_16x16x32_bf16 v[152:155], v[80:83], v[200:203], v[152:155]
ds_read_b64_tr_b16 v[64:65], v16 offset:16384
buffer_store_dwordx4 v[232:235], v240, s[20:23], s36 offen sc0 sc1
v_mfma_f32_16x16x32_bf16 v[156:159], v[80:83], v[204:207], v[156:159]
ds_read_b64_tr_b16 v[66:67], v16 offset:18432
v_mfma_f32_16x16x32_bf16 v[152:155], v[84:87], v[208:211], v[152:155]
ds_read_b64_tr_b16 v[68:69], v16 offset:20480
v_mfma_f32_16x16x32_bf16 v[156:159], v[84:87], v[212:215], v[156:159]
ds_read_b64_tr_b16 v[70:71], v16 offset:22528
v_mfma_f32_16x16x32_bf16 v[152:155], v[88:91], v[216:219], v[152:155]
ds_read_b64_tr_b16 v[72:73], v16 offset:24576
v_mfma_f32_16x16x32_bf16 v[156:159], v[88:91], v[220:223], v[156:159]
ds_read_b64_tr_b16 v[74:75], v16 offset:26624
v_mfma_f32_16x16x32_bf16 v[152:155], v[92:95], v[224:227], v[152:155]
ds_read_b64_tr_b16 v[76:77], v16 offset:28672
v_mfma_f32_16x16x32_bf16 v[156:159], v[92:95], v[228:231], v[156:159]
ds_read_b64_tr_b16 v[78:79], v16 offset:30720
s_waitcnt lgkmcnt(8)
v_mfma_f32_16x16x32_bf16 v[112:115], v[48:51], v[160:163], 0
ds_read_b64_tr_b16 v[80:81], v16 offset:32768
s_add_u32 m0, s32, 73728
v_mfma_f32_16x16x32_bf16 v[116:119], v[48:51], v[164:167], 0
ds_read_b64_tr_b16 v[82:83], v16 offset:34816
s_add_u32 s34, s30, 512
v_mfma_f32_16x16x32_bf16 v[112:115], v[52:55], v[168:171], v[112:115]
ds_read_b64_tr_b16 v[84:85], v17 offset:0
v_mfma_f32_16x16x32_bf16 v[116:119], v[52:55], v[172:175], v[116:119]
ds_read_b64_tr_b16 v[86:87], v17 offset:2048
buffer_load_dwordx4 v44, s[16:19], s34 offen offset:0 lds
v_mfma_f32_16x16x32_bf16 v[112:115], v[56:59], v[176:179], v[112:115]
ds_read_b64_tr_b16 v[88:89], v17 offset:4096
v_cvt_pk_bf16_f32 v236, v152, v153
v_mfma_f32_16x16x32_bf16 v[116:119], v[56:59], v[180:183], v[116:119]
ds_read_b64_tr_b16 v[90:91], v17 offset:6144
v_cvt_pk_bf16_f32 v237, v154, v155
v_mfma_f32_16x16x32_bf16 v[112:115], v[60:63], v[184:187], v[112:115]
ds_read_b64_tr_b16 v[92:93], v17 offset:8192
v_cvt_pk_bf16_f32 v238, v156, v157
v_mfma_f32_16x16x32_bf16 v[116:119], v[60:63], v[188:191], v[116:119]
ds_read_b64_tr_b16 v[94:95], v17 offset:10240
s_waitcnt lgkmcnt(8)
v_mfma_f32_16x16x32_bf16 v[112:115], v[64:67], v[192:195], v[112:115]
ds_read_b64_tr_b16 v[48:49], v17 offset:12288
v_cvt_pk_bf16_f32 v239, v158, v159
v_mfma_f32_16x16x32_bf16 v[116:119], v[64:67], v[196:199], v[116:119]
ds_read_b64_tr_b16 v[50:51], v17 offset:14336
s_add_u32 s36, s33, 114688
v_mfma_f32_16x16x32_bf16 v[112:115], v[68:71], v[200:203], v[112:115]
ds_read_b64_tr_b16 v[52:53], v17 offset:16384
buffer_store_dwordx4 v[236:239], v240, s[20:23], s36 offen sc0 sc1
v_mfma_f32_16x16x32_bf16 v[116:119], v[68:71], v[204:207], v[116:119]
ds_read_b64_tr_b16 v[54:55], v17 offset:18432
v_mfma_f32_16x16x32_bf16 v[112:115], v[72:75], v[208:211], v[112:115]
ds_read_b64_tr_b16 v[56:57], v17 offset:20480
buffer_load_dwordx4 v45, s[16:19], s34 offen offset:1024 lds
v_mfma_f32_16x16x32_bf16 v[116:119], v[72:75], v[212:215], v[116:119]
ds_read_b64_tr_b16 v[58:59], v17 offset:22528
v_mfma_f32_16x16x32_bf16 v[112:115], v[76:79], v[216:219], v[112:115]
ds_read_b64_tr_b16 v[60:61], v17 offset:24576
buffer_load_dwordx4 v46, s[16:19], s34 offen offset:2048 lds
v_mfma_f32_16x16x32_bf16 v[116:119], v[76:79], v[220:223], v[116:119]
ds_read_b64_tr_b16 v[62:63], v17 offset:26624
s_waitcnt lgkmcnt(8)
v_mfma_f32_16x16x32_bf16 v[112:115], v[80:83], v[224:227], v[112:115]
ds_read_b64_tr_b16 v[64:65], v17 offset:28672
v_mfma_f32_16x16x32_bf16 v[116:119], v[80:83], v[228:231], v[116:119]
ds_read_b64_tr_b16 v[66:67], v17 offset:30720
buffer_load_dwordx4 v47, s[16:19], s34 offen offset:3072 lds
v_mfma_f32_16x16x32_bf16 v[120:123], v[84:87], v[160:163], 0
ds_read_b64_tr_b16 v[68:69], v17 offset:32768
v_mfma_f32_16x16x32_bf16 v[124:127], v[84:87], v[164:167], 0
ds_read_b64_tr_b16 v[70:71], v17 offset:34816
s_add_u32 m0, s32, 77824
v_mfma_f32_16x16x32_bf16 v[120:123], v[88:91], v[168:171], v[120:123]
ds_read_b64_tr_b16 v[72:73], v18 offset:0
v_mfma_f32_16x16x32_bf16 v[124:127], v[88:91], v[172:175], v[124:127]
ds_read_b64_tr_b16 v[74:75], v18 offset:2048
s_add_u32 s34, s30, 37376
v_mfma_f32_16x16x32_bf16 v[120:123], v[92:95], v[176:179], v[120:123]
ds_read_b64_tr_b16 v[76:77], v18 offset:4096
v_cvt_pk_bf16_f32 v232, v112, v113
v_mfma_f32_16x16x32_bf16 v[124:127], v[92:95], v[180:183], v[124:127]
ds_read_b64_tr_b16 v[78:79], v18 offset:6144
s_waitcnt lgkmcnt(8)
v_mfma_f32_16x16x32_bf16 v[120:123], v[48:51], v[184:187], v[120:123]
ds_read_b64_tr_b16 v[80:81], v18 offset:8192
buffer_load_dwordx4 v44, s[16:19], s34 offen offset:0 lds
v_mfma_f32_16x16x32_bf16 v[124:127], v[48:51], v[188:191], v[124:127]
ds_read_b64_tr_b16 v[82:83], v18 offset:10240
L_mlp_pad7:
s_cbranch_execz L_mlp_padret
v_cvt_pk_bf16_f32 v233, v114, v115
v_mfma_f32_16x16x32_bf16 v[120:123], v[52:55], v[192:195], v[120:123]
ds_read_b64_tr_b16 v[84:85], v18 offset:12288
s_add_u32 m0, s32, 78848
v_mfma_f32_16x16x32_bf16 v[124:127], v[52:55], v[196:199], v[124:127]
ds_read_b64_tr_b16 v[86:87], v18 offset:14336
v_cvt_pk_bf16_f32 v234, v116, v117
v_mfma_f32_16x16x32_bf16 v[120:123], v[56:59], v[200:203], v[120:123]
ds_read_b64_tr_b16 v[88:89], v18 offset:16384
s_add_u32 s34, s31, 512
v_mfma_f32_16x16x32_bf16 v[124:127], v[56:59], v[204:207], v[124:127]
ds_read_b64_tr_b16 v[90:91], v18 offset:18432
v_cvt_pk_bf16_f32 v235, v118, v119
v_mfma_f32_16x16x32_bf16 v[120:123], v[60:63], v[208:211], v[120:123]
ds_read_b64_tr_b16 v[92:93], v18 offset:20480
buffer_load_dwordx4 v44, s[16:19], s34 offen offset:0 lds
v_mfma_f32_16x16x32_bf16 v[124:127], v[60:63], v[212:215], v[124:127]
ds_read_b64_tr_b16 v[94:95], v18 offset:22528
s_waitcnt lgkmcnt(8)
v_mfma_f32_16x16x32_bf16 v[120:123], v[64:67], v[216:219], v[120:123]
ds_read_b64_tr_b16 v[48:49], v18 offset:24576
s_add_u32 s36, s33, 131072
v_mfma_f32_16x16x32_bf16 v[124:127], v[64:67], v[220:223], v[124:127]
ds_read_b64_tr_b16 v[50:51], v18 offset:26624
buffer_load_dwordx4 v45, s[16:19], s34 offen offset:1024 lds
v_mfma_f32_16x16x32_bf16 v[120:123], v[68:71], v[224:227], v[120:123]
ds_read_b64_tr_b16 v[52:53], v18 offset:28672
buffer_store_dwordx4 v[232:235], v240, s[20:23], s36 offen sc0 sc1
v_mfma_f32_16x16x32_bf16 v[124:127], v[68:71], v[228:231], v[124:127]
ds_read_b64_tr_b16 v[54:55], v18 offset:30720
buffer_load_dwordx4 v46, s[16:19], s34 offen offset:2048 lds
v_mfma_f32_16x16x32_bf16 v[144:147], v[72:75], v[160:163], 0
ds_read_b64_tr_b16 v[56:57], v18 offset:32768
v_mfma_f32_16x16x32_bf16 v[148:151], v[72:75], v[164:167], 0
ds_read_b64_tr_b16 v[58:59], v18 offset:34816
buffer_load_dwordx4 v47, s[16:19], s34 offen offset:3072 lds
v_mfma_f32_16x16x32_bf16 v[144:147], v[76:79], v[168:171], v[144:147]
ds_read_b64_tr_b16 v[60:61], v19 offset:0
v_mfma_f32_16x16x32_bf16 v[148:151], v[76:79], v[172:175], v[148:151]
ds_read_b64_tr_b16 v[62:63], v19 offset:2048
s_waitcnt lgkmcnt(8)
v_mfma_f32_16x16x32_bf16 v[144:147], v[80:83], v[176:179], v[144:147]
ds_read_b64_tr_b16 v[64:65], v19 offset:4096
v_cvt_pk_bf16_f32 v236, v120, v121
v_mfma_f32_16x16x32_bf16 v[148:151], v[80:83], v[180:183], v[148:151]
ds_read_b64_tr_b16 v[66:67], v19 offset:6144
v_cvt_pk_bf16_f32 v237, v122, v123
v_mfma_f32_16x16x32_bf16 v[144:147], v[84:87], v[184:187], v[144:147]
ds_read_b64_tr_b16 v[68:69], v19 offset:8192
v_cvt_pk_bf16_f32 v238, v124, v125
v_mfma_f32_16x16x32_bf16 v[148:151], v[84:87], v[188:191], v[148:151]
ds_read_b64_tr_b16 v[70:71], v19 offset:10240
v_cvt_pk_bf16_f32 v239, v126, v127
v_mfma_f32_16x16x32_bf16 v[144:147], v[88:91], v[192:195], v[144:147]
ds_read_b64_tr_b16 v[72:73], v19 offset:12288
s_add_u32 s36, s33, 147456
v_mfma_f32_16x16x32_bf16 v[148:151], v[88:91], v[196:199], v[148:151]
ds_read_b64_tr_b16 v[74:75], v19 offset:14336
buffer_store_dwordx4 v[236:239], v240, s[20:23], s36 offen sc0 sc1
v_mfma_f32_16x16x32_bf16 v[144:147], v[92:95], v[200:203], v[144:147]
ds_read_b64_tr_b16 v[76:77], v19 offset:16384
v_mfma_f32_16x16x32_bf16 v[148:151], v[92:95], v[204:207], v[148:151]
ds_read_b64_tr_b16 v[78:79], v19 offset:18432
s_waitcnt lgkmcnt(8)
v_mfma_f32_16x16x32_bf16 v[144:147], v[48:51], v[208:211], v[144:147]
ds_read_b64_tr_b16 v[80:81], v19 offset:20480
v_mfma_f32_16x16x32_bf16 v[148:151], v[48:51], v[212:215], v[148:151]
ds_read_b64_tr_b16 v[82:83], v19 offset:22528
v_mfma_f32_16x16x32_bf16 v[144:147], v[52:55], v[216:219], v[144:147]
ds_read_b64_tr_b16 v[84:85], v19 offset:24576
v_mfma_f32_16x16x32_bf16 v[148:151], v[52:55], v[220:223], v[148:151]
ds_read_b64_tr_b16 v[86:87], v19 offset:26624
v_mfma_f32_16x16x32_bf16 v[144:147], v[56:59], v[224:227], v[144:147]
ds_read_b64_tr_b16 v[88:89], v19 offset:28672
v_mfma_f32_16x16x32_bf16 v[148:151], v[56:59], v[228:231], v[148:151]
ds_read_b64_tr_b16 v[90:91], v19 offset:30720
s_waitcnt vmcnt(14)
v_mfma_f32_16x16x32_bf16 v[152:155], v[60:63], v[160:163], 0
ds_read_b64_tr_b16 v[92:93], v19 offset:32768
s_barrier
v_mfma_f32_16x16x32_bf16 v[156:159], v[60:63], v[164:167], 0
ds_read_b64_tr_b16 v[94:95], v19 offset:34816
s_waitcnt lgkmcnt(8)
v_mfma_f32_16x16x32_bf16 v[152:155], v[64:67], v[168:171], v[152:155]
ds_read_b64_tr_b16 v[48:49], v20 offset:0
v_mfma_f32_16x16x32_bf16 v[156:159], v[64:67], v[172:175], v[156:159]
ds_read_b64_tr_b16 v[50:51], v20 offset:2048
v_mfma_f32_16x16x32_bf16 v[152:155], v[68:71], v[176:179], v[152:155]
ds_read_b64_tr_b16 v[52:53], v20 offset:4096
v_cvt_pk_bf16_f32 v232, v144, v145
v_mfma_f32_16x16x32_bf16 v[156:159], v[68:71], v[180:183], v[156:159]
ds_read_b64_tr_b16 v[54:55], v20 offset:6144
v_cvt_pk_bf16_f32 v233, v146, v147
v_mfma_f32_16x16x32_bf16 v[152:155], v[72:75], v[184:187], v[152:155]
ds_read_b64_tr_b16 v[56:57], v20 offset:8192
v_cvt_pk_bf16_f32 v234, v148, v149
v_mfma_f32_16x16x32_bf16 v[156:159], v[72:75], v[188:191], v[156:159]
ds_read_b64_tr_b16 v[58:59], v20 offset:10240
v_cvt_pk_bf16_f32 v235, v150, v151
v_mfma_f32_16x16x32_bf16 v[152:155], v[76:79], v[192:195], v[152:155]
ds_read_b64_tr_b16 v[60:61], v20 offset:12288
s_add_u32 s36, s33, 163840
v_mfma_f32_16x16x32_bf16 v[156:159], v[76:79], v[196:199], v[156:159]
ds_read_b64_tr_b16 v[62:63], v20 offset:14336
s_waitcnt lgkmcnt(8)
v_mfma_f32_16x16x32_bf16 v[152:155], v[80:83], v[200:203], v[152:155]
ds_read_b64_tr_b16 v[64:65], v20 offset:16384
buffer_store_dwordx4 v[232:235], v240, s[20:23], s36 offen sc0 sc1
v_mfma_f32_16x16x32_bf16 v[156:159], v[80:83], v[204:207], v[156:159]
ds_read_b64_tr_b16 v[66:67], v20 offset:18432
v_mfma_f32_16x16x32_bf16 v[152:155], v[84:87], v[208:211], v[152:155]
ds_read_b64_tr_b16 v[68:69], v20 offset:20480
v_mfma_f32_16x16x32_bf16 v[156:159], v[84:87], v[212:215], v[156:159]
ds_read_b64_tr_b16 v[70:71], v20 offset:22528
v_mfma_f32_16x16x32_bf16 v[152:155], v[88:91], v[216:219], v[152:155]
ds_read_b64_tr_b16 v[72:73], v20 offset:24576
v_mfma_f32_16x16x32_bf16 v[156:159], v[88:91], v[220:223], v[156:159]
ds_read_b64_tr_b16 v[74:75], v20 offset:26624
v_mfma_f32_16x16x32_bf16 v[152:155], v[92:95], v[224:227], v[152:155]
ds_read_b64_tr_b16 v[76:77], v20 offset:28672
v_mfma_f32_16x16x32_bf16 v[156:159], v[92:95], v[228:231], v[156:159]
ds_read_b64_tr_b16 v[78:79], v20 offset:30720
s_waitcnt lgkmcnt(8)
v_mfma_f32_16x16x32_bf16 v[112:115], v[48:51], v[160:163], 0
ds_read_b64_tr_b16 v[80:81], v20 offset:32768
s_add_u32 m0, s32, 110592
v_mfma_f32_16x16x32_bf16 v[116:119], v[48:51], v[164:167], 0
ds_read_b64_tr_b16 v[82:83], v20 offset:34816
s_add_u32 s34, s30, 640
v_mfma_f32_16x16x32_bf16 v[112:115], v[52:55], v[168:171], v[112:115]
ds_read_b64_tr_b16 v[84:85], v21 offset:0
v_mfma_f32_16x16x32_bf16 v[116:119], v[52:55], v[172:175], v[116:119]
ds_read_b64_tr_b16 v[86:87], v21 offset:2048
buffer_load_dwordx4 v44, s[16:19], s34 offen offset:0 lds
v_mfma_f32_16x16x32_bf16 v[112:115], v[56:59], v[176:179], v[112:115]
ds_read_b64_tr_b16 v[88:89], v21 offset:4096
v_cvt_pk_bf16_f32 v236, v152, v153
v_mfma_f32_16x16x32_bf16 v[116:119], v[56:59], v[180:183], v[116:119]
ds_read_b64_tr_b16 v[90:91], v21 offset:6144
v_cvt_pk_bf16_f32 v237, v154, v155
v_mfma_f32_16x16x32_bf16 v[112:115], v[60:63], v[184:187], v[112:115]
ds_read_b64_tr_b16 v[92:93], v21 offset:8192
v_cvt_pk_bf16_f32 v238, v156, v157
v_mfma_f32_16x16x32_bf16 v[116:119], v[60:63], v[188:191], v[116:119]
ds_read_b64_tr_b16 v[94:95], v21 offset:10240
s_waitcnt lgkmcnt(8)
v_mfma_f32_16x16x32_bf16 v[112:115], v[64:67], v[192:195], v[112:115]
ds_read_b64_tr_b16 v[48:49], v21 offset:12288
v_cvt_pk_bf16_f32 v239, v158, v159
v_mfma_f32_16x16x32_bf16 v[116:119], v[64:67], v[196:199], v[116:119]
ds_read_b64_tr_b16 v[50:51], v21 offset:14336
s_add_u32 s36, s33, 180224
v_mfma_f32_16x16x32_bf16 v[112:115], v[68:71], v[200:203], v[112:115]
ds_read_b64_tr_b16 v[52:53], v21 offset:16384
buffer_store_dwordx4 v[236:239], v240, s[20:23], s36 offen sc0 sc1
v_mfma_f32_16x16x32_bf16 v[116:119], v[68:71], v[204:207], v[116:119]
ds_read_b64_tr_b16 v[54:55], v21 offset:18432
v_mfma_f32_16x16x32_bf16 v[112:115], v[72:75], v[208:211], v[112:115]
ds_read_b64_tr_b16 v[56:57], v21 offset:20480
buffer_load_dwordx4 v45, s[16:19], s34 offen offset:1024 lds
v_mfma_f32_16x16x32_bf16 v[116:119], v[72:75], v[212:215], v[116:119]
ds_read_b64_tr_b16 v[58:59], v21 offset:22528
v_mfma_f32_16x16x32_bf16 v[112:115], v[76:79], v[216:219], v[112:115]
ds_read_b64_tr_b16 v[60:61], v21 offset:24576
buffer_load_dwordx4 v46, s[16:19], s34 offen offset:2048 lds
v_mfma_f32_16x16x32_bf16 v[116:119], v[76:79], v[220:223], v[116:119]
ds_read_b64_tr_b16 v[62:63], v21 offset:26624
s_waitcnt lgkmcnt(8)
v_mfma_f32_16x16x32_bf16 v[112:115], v[80:83], v[224:227], v[112:115]
ds_read_b64_tr_b16 v[64:65], v21 offset:28672
v_mfma_f32_16x16x32_bf16 v[116:119], v[80:83], v[228:231], v[116:119]
ds_read_b64_tr_b16 v[66:67], v21 offset:30720
buffer_load_dwordx4 v47, s[16:19], s34 offen offset:3072 lds
v_mfma_f32_16x16x32_bf16 v[120:123], v[84:87], v[160:163], 0
ds_read_b64_tr_b16 v[68:69], v21 offset:32768
v_mfma_f32_16x16x32_bf16 v[124:127], v[84:87], v[164:167], 0
ds_read_b64_tr_b16 v[70:71], v21 offset:34816
s_add_u32 m0, s32, 114688
v_mfma_f32_16x16x32_bf16 v[120:123], v[88:91], v[168:171], v[120:123]
ds_read_b64_tr_b16 v[72:73], v22 offset:0
v_mfma_f32_16x16x32_bf16 v[124:127], v[88:91], v[172:175], v[124:127]
ds_read_b64_tr_b16 v[74:75], v22 offset:2048
s_add_u32 s34, s30, 37504
v_mfma_f32_16x16x32_bf16 v[120:123], v[92:95], v[176:179], v[120:123]
ds_read_b64_tr_b16 v[76:77], v22 offset:4096
v_cvt_pk_bf16_f32 v232, v112, v113
v_mfma_f32_16x16x32_bf16 v[124:127], v[92:95], v[180:183], v[124:127]
ds_read_b64_tr_b16 v[78:79], v22 offset:6144
s_waitcnt lgkmcnt(8)
v_mfma_f32_16x16x32_bf16 v[120:123], v[48:51], v[184:187], v[120:123]
ds_read_b64_tr_b16 v[80:81], v22 offset:8192
buffer_load_dwordx4 v44, s[16:19], s34 offen offset:0 lds
v_mfma_f32_16x16x32_bf16 v[124:127], v[48:51], v[188:191], v[124:127]
ds_read_b64_tr_b16 v[82:83], v22 offset:10240
v_cvt_pk_bf16_f32 v233, v114, v115
v_mfma_f32_16x16x32_bf16 v[120:123], v[52:55], v[192:195], v[120:123]
ds_read_b64_tr_b16 v[84:85], v22 offset:12288
s_add_u32 m0, s32, 115712
v_mfma_f32_16x16x32_bf16 v[124:127], v[52:55], v[196:199], v[124:127]
ds_read_b64_tr_b16 v[86:87], v22 offset:14336
v_cvt_pk_bf16_f32 v234, v116, v117
v_mfma_f32_16x16x32_bf16 v[120:123], v[56:59], v[200:203], v[120:123]
ds_read_b64_tr_b16 v[88:89], v22 offset:16384
s_add_u32 s34, s31, 640
v_mfma_f32_16x16x32_bf16 v[124:127], v[56:59], v[204:207], v[124:127]
ds_read_b64_tr_b16 v[90:91], v22 offset:18432
v_cvt_pk_bf16_f32 v235, v118, v119
v_mfma_f32_16x16x32_bf16 v[120:123], v[60:63], v[208:211], v[120:123]
ds_read_b64_tr_b16 v[92:93], v22 offset:20480
buffer_load_dwordx4 v44, s[16:19], s34 offen offset:0 lds
v_mfma_f32_16x16x32_bf16 v[124:127], v[60:63], v[212:215], v[124:127]
ds_read_b64_tr_b16 v[94:95], v22 offset:22528
s_waitcnt lgkmcnt(8)
v_mfma_f32_16x16x32_bf16 v[120:123], v[64:67], v[216:219], v[120:123]
ds_read_b64_tr_b16 v[48:49], v22 offset:24576
s_add_u32 s36, s33, 196608
v_mfma_f32_16x16x32_bf16 v[124:127], v[64:67], v[220:223], v[124:127]
ds_read_b64_tr_b16 v[50:51], v22 offset:26624
buffer_load_dwordx4 v45, s[16:19], s34 offen offset:1024 lds
v_mfma_f32_16x16x32_bf16 v[120:123], v[68:71], v[224:227], v[120:123]
ds_read_b64_tr_b16 v[52:53], v22 offset:28672
buffer_store_dwordx4 v[232:235], v240, s[20:23], s36 offen sc0 sc1
v_mfma_f32_16x16x32_bf16 v[124:127], v[68:71], v[228:231], v[124:127]
ds_read_b64_tr_b16 v[54:55], v22 offset:30720
buffer_load_dwordx4 v46, s[16:19], s34 offen offset:2048 lds
v_mfma_f32_16x16x32_bf16 v[144:147], v[72:75], v[160:163], 0
ds_read_b64_tr_b16 v[56:57], v22 offset:32768
v_mfma_f32_16x16x32_bf16 v[148:151], v[72:75], v[164:167], 0
ds_read_b64_tr_b16 v[58:59], v22 offset:34816
buffer_load_dwordx4 v47, s[16:19], s34 offen offset:3072 lds
v_mfma_f32_16x16x32_bf16 v[144:147], v[76:79], v[168:171], v[144:147]
ds_read_b64_tr_b16 v[60:61], v23 offset:0
v_mfma_f32_16x16x32_bf16 v[148:151], v[76:79], v[172:175], v[148:151]
ds_read_b64_tr_b16 v[62:63], v23 offset:2048
s_waitcnt lgkmcnt(8)
v_mfma_f32_16x16x32_bf16 v[144:147], v[80:83], v[176:179], v[144:147]
ds_read_b64_tr_b16 v[64:65], v23 offset:4096
v_cvt_pk_bf16_f32 v236, v120, v121
v_mfma_f32_16x16x32_bf16 v[148:151], v[80:83], v[180:183], v[148:151]
ds_read_b64_tr_b16 v[66:67], v23 offset:6144
v_cvt_pk_bf16_f32 v237, v122, v123
v_mfma_f32_16x16x32_bf16 v[144:147], v[84:87], v[184:187], v[144:147]
ds_read_b64_tr_b16 v[68:69], v23 offset:8192
v_cvt_pk_bf16_f32 v238, v124, v125
v_mfma_f32_16x16x32_bf16 v[148:151], v[84:87], v[188:191], v[148:151]
ds_read_b64_tr_b16 v[70:71], v23 offset:10240
v_cvt_pk_bf16_f32 v239, v126, v127
v_mfma_f32_16x16x32_bf16 v[144:147], v[88:91], v[192:195], v[144:147]
ds_read_b64_tr_b16 v[72:73], v23 offset:12288
s_add_u32 s36, s33, 212992
v_mfma_f32_16x16x32_bf16 v[148:151], v[88:91], v[196:199], v[148:151]
ds_read_b64_tr_b16 v[74:75], v23 offset:14336
buffer_store_dwordx4 v[236:239], v240, s[20:23], s36 offen sc0 sc1
v_mfma_f32_16x16x32_bf16 v[144:147], v[92:95], v[200:203], v[144:147]
ds_read_b64_tr_b16 v[76:77], v23 offset:16384
v_mfma_f32_16x16x32_bf16 v[148:151], v[92:95], v[204:207], v[148:151]
ds_read_b64_tr_b16 v[78:79], v23 offset:18432
s_waitcnt lgkmcnt(8)
v_mfma_f32_16x16x32_bf16 v[144:147], v[48:51], v[208:211], v[144:147]
ds_read_b64_tr_b16 v[80:81], v23 offset:20480
v_mfma_f32_16x16x32_bf16 v[148:151], v[48:51], v[212:215], v[148:151]
ds_read_b64_tr_b16 v[82:83], v23 offset:22528
v_mfma_f32_16x16x32_bf16 v[144:147], v[52:55], v[216:219], v[144:147]
ds_read_b64_tr_b16 v[84:85], v23 offset:24576
v_mfma_f32_16x16x32_bf16 v[148:151], v[52:55], v[220:223], v[148:151]
ds_read_b64_tr_b16 v[86:87], v23 offset:26624
v_mfma_f32_16x16x32_bf16 v[144:147], v[56:59], v[224:227], v[144:147]
ds_read_b64_tr_b16 v[88:89], v23 offset:28672
v_mfma_f32_16x16x32_bf16 v[148:151], v[56:59], v[228:231], v[148:151]
ds_read_b64_tr_b16 v[90:91], v23 offset:30720
s_waitcnt vmcnt(14)
v_mfma_f32_16x16x32_bf16 v[152:155], v[60:63], v[160:163], 0
ds_read_b64_tr_b16 v[92:93], v23 offset:32768
s_barrier
v_mfma_f32_16x16x32_bf16 v[156:159], v[60:63], v[164:167], 0
ds_read_b64_tr_b16 v[94:95], v23 offset:34816
s_waitcnt lgkmcnt(8)
v_mfma_f32_16x16x32_bf16 v[152:155], v[64:67], v[168:171], v[152:155]
ds_read_b64_tr_b16 v[48:49], v24 offset:0
v_mfma_f32_16x16x32_bf16 v[156:159], v[64:67], v[172:175], v[156:159]
ds_read_b64_tr_b16 v[50:51], v24 offset:2048
v_mfma_f32_16x16x32_bf16 v[152:155], v[68:71], v[176:179], v[152:155]
ds_read_b64_tr_b16 v[52:53], v24 offset:4096
v_cvt_pk_bf16_f32 v232, v144, v145
v_mfma_f32_16x16x32_bf16 v[156:159], v[68:71], v[180:183], v[156:159]
ds_read_b64_tr_b16 v[54:55], v24 offset:6144
v_cvt_pk_bf16_f32 v233, v146, v147
v_mfma_f32_16x16x32_bf16 v[152:155], v[72:75], v[184:187], v[152:155]
ds_read_b64_tr_b16 v[56:57], v24 offset:8192
v_cvt_pk_bf16_f32 v234, v148, v149
v_mfma_f32_16x16x32_bf16 v[156:159], v[72:75], v[188:191], v[156:159]
ds_read_b64_tr_b16 v[58:59], v24 offset:10240
v_cvt_pk_bf16_f32 v235, v150, v151
v_mfma_f32_16x16x32_bf16 v[152:155], v[76:79], v[192:195], v[152:155]
ds_read_b64_tr_b16 v[60:61], v24 offset:12288
s_add_u32 s36, s33, 229376
v_mfma_f32_16x16x32_bf16 v[156:159], v[76:79], v[196:199], v[156:159]
ds_read_b64_tr_b16 v[62:63], v24 offset:14336
s_waitcnt lgkmcnt(8)
v_mfma_f32_16x16x32_bf16 v[152:155], v[80:83], v[200:203], v[152:155]
ds_read_b64_tr_b16 v[64:65], v24 offset:16384
buffer_store_dwordx4 v[232:235], v240, s[20:23], s36 offen sc0 sc1
v_mfma_f32_16x16x32_bf16 v[156:159], v[80:83], v[204:207], v[156:159]
ds_read_b64_tr_b16 v[66:67], v24 offset:18432
v_mfma_f32_16x16x32_bf16 v[152:155], v[84:87], v[208:211], v[152:155]
ds_read_b64_tr_b16 v[68:69], v24 offset:20480
v_mfma_f32_16x16x32_bf16 v[156:159], v[84:87], v[212:215], v[156:159]
ds_read_b64_tr_b16 v[70:71], v24 offset:22528
v_mfma_f32_16x16x32_bf16 v[152:155], v[88:91], v[216:219], v[152:155]
ds_read_b64_tr_b16 v[72:73], v24 offset:24576
v_mfma_f32_16x16x32_bf16 v[156:159], v[88:91], v[220:223], v[156:159]
ds_read_b64_tr_b16 v[74:75], v24 offset:26624
v_mfma_f32_16x16x32_bf16 v[152:155], v[92:95], v[224:227], v[152:155]
ds_read_b64_tr_b16 v[76:77], v24 offset:28672
v_mfma_f32_16x16x32_bf16 v[156:159], v[92:95], v[228:231], v[156:159]
ds_read_b64_tr_b16 v[78:79], v24 offset:30720
s_waitcnt lgkmcnt(8)
v_mfma_f32_16x16x32_bf16 v[112:115], v[48:51], v[160:163], 0
ds_read_b64_tr_b16 v[80:81], v24 offset:32768
s_add_u32 m0, s32, 0
v_mfma_f32_16x16x32_bf16 v[116:119], v[48:51], v[164:167], 0
ds_read_b64_tr_b16 v[82:83], v24 offset:34816
s_add_u32 s34, s30, 768
v_mfma_f32_16x16x32_bf16 v[112:115], v[52:55], v[168:171], v[112:115]
ds_read_b64_tr_b16 v[84:85], v25 offset:0
v_mfma_f32_16x16x32_bf16 v[116:119], v[52:55], v[172:175], v[116:119]
ds_read_b64_tr_b16 v[86:87], v25 offset:2048
buffer_load_dwordx4 v44, s[16:19], s34 offen offset:0 lds
v_mfma_f32_16x16x32_bf16 v[112:115], v[56:59], v[176:179], v[112:115]
ds_read_b64_tr_b16 v[88:89], v25 offset:4096
v_cvt_pk_bf16_f32 v236, v152, v153
v_mfma_f32_16x16x32_bf16 v[116:119], v[56:59], v[180:183], v[116:119]
ds_read_b64_tr_b16 v[90:91], v25 offset:6144
v_cvt_pk_bf16_f32 v237, v154, v155
v_mfma_f32_16x16x32_bf16 v[112:115], v[60:63], v[184:187], v[112:115]
ds_read_b64_tr_b16 v[92:93], v25 offset:8192
v_cvt_pk_bf16_f32 v238, v156, v157
v_mfma_f32_16x16x32_bf16 v[116:119], v[60:63], v[188:191], v[116:119]
ds_read_b64_tr_b16 v[94:95], v25 offset:10240
s_waitcnt lgkmcnt(8)
v_mfma_f32_16x16x32_bf16 v[112:115], v[64:67], v[192:195], v[112:115]
ds_read_b64_tr_b16 v[48:49], v25 offset:12288
v_cvt_pk_bf16_f32 v239, v158, v159
v_mfma_f32_16x16x32_bf16 v[116:119], v[64:67], v[196:199], v[116:119]
ds_read_b64_tr_b16 v[50:51], v25 offset:14336
s_add_u32 s36, s33, 245760
v_mfma_f32_16x16x32_bf16 v[112:115], v[68:71], v[200:203], v[112:115]
ds_read_b64_tr_b16 v[52:53], v25 offset:16384
buffer_store_dwordx4 v[236:239], v240, s[20:23], s36 offen sc0 sc1
v_mfma_f32_16x16x32_bf16 v[116:119], v[68:71], v[204:207], v[116:119]
ds_read_b64_tr_b16 v[54:55], v25 offset:18432
v_mfma_f32_16x16x32_bf16 v[112:115], v[72:75], v[208:211], v[112:115]
ds_read_b64_tr_b16 v[56:57], v25 offset:20480
buffer_load_dwordx4 v45, s[16:19], s34 offen offset:1024 lds
v_mfma_f32_16x16x32_bf16 v[116:119], v[72:75], v[212:215], v[116:119]
ds_read_b64_tr_b16 v[58:59], v25 offset:22528
v_mfma_f32_16x16x32_bf16 v[112:115], v[76:79], v[216:219], v[112:115]
ds_read_b64_tr_b16 v[60:61], v25 offset:24576
buffer_load_dwordx4 v46, s[16:19], s34 offen offset:2048 lds
v_mfma_f32_16x16x32_bf16 v[116:119], v[76:79], v[220:223], v[116:119]
ds_read_b64_tr_b16 v[62:63], v25 offset:26624
s_waitcnt lgkmcnt(8)
v_mfma_f32_16x16x32_bf16 v[112:115], v[80:83], v[224:227], v[112:115]
ds_read_b64_tr_b16 v[64:65], v25 offset:28672
v_mfma_f32_16x16x32_bf16 v[116:119], v[80:83], v[228:231], v[116:119]
ds_read_b64_tr_b16 v[66:67], v25 offset:30720
buffer_load_dwordx4 v47, s[16:19], s34 offen offset:3072 lds
v_mfma_f32_16x16x32_bf16 v[120:123], v[84:87], v[160:163], 0
ds_read_b64_tr_b16 v[68:69], v25 offset:32768
v_mfma_f32_16x16x32_bf16 v[124:127], v[84:87], v[164:167], 0
ds_read_b64_tr_b16 v[70:71], v25 offset:34816
s_add_u32 m0, s32, 4096
v_mfma_f32_16x16x32_bf16 v[120:123], v[88:91], v[168:171], v[120:123]
ds_read_b64_tr_b16 v[72:73], v26 offset:0
v_mfma_f32_16x16x32_bf16 v[124:127], v[88:91], v[172:175], v[124:127]
ds_read_b64_tr_b16 v[74:75], v26 offset:2048
s_add_u32 s34, s30, 37632
v_mfma_f32_16x16x32_bf16 v[120:123], v[92:95], v[176:179], v[120:123]
ds_read_b64_tr_b16 v[76:77], v26 offset:4096
v_cvt_pk_bf16_f32 v232, v112, v113
v_mfma_f32_16x16x32_bf16 v[124:127], v[92:95], v[180:183], v[124:127]
ds_read_b64_tr_b16 v[78:79], v26 offset:6144
s_waitcnt lgkmcnt(8)
v_mfma_f32_16x16x32_bf16 v[120:123], v[48:51], v[184:187], v[120:123]
ds_read_b64_tr_b16 v[80:81], v26 offset:8192
buffer_load_dwordx4 v44, s[16:19], s34 offen offset:0 lds
v_mfma_f32_16x16x32_bf16 v[124:127], v[48:51], v[188:191], v[124:127]
ds_read_b64_tr_b16 v[82:83], v26 offset:10240
v_cvt_pk_bf16_f32 v233, v114, v115
v_mfma_f32_16x16x32_bf16 v[120:123], v[52:55], v[192:195], v[120:123]
ds_read_b64_tr_b16 v[84:85], v26 offset:12288
s_add_u32 m0, s32, 5120
v_mfma_f32_16x16x32_bf16 v[124:127], v[52:55], v[196:199], v[124:127]
ds_read_b64_tr_b16 v[86:87], v26 offset:14336
v_cvt_pk_bf16_f32 v234, v116, v117
v_mfma_f32_16x16x32_bf16 v[120:123], v[56:59], v[200:203], v[120:123]
ds_read_b64_tr_b16 v[88:89], v26 offset:16384
s_add_u32 s34, s31, 768
v_mfma_f32_16x16x32_bf16 v[124:127], v[56:59], v[204:207], v[124:127]
ds_read_b64_tr_b16 v[90:91], v26 offset:18432
v_cvt_pk_bf16_f32 v235, v118, v119
v_mfma_f32_16x16x32_bf16 v[120:123], v[60:63], v[208:211], v[120:123]
ds_read_b64_tr_b16 v[92:93], v26 offset:20480
buffer_load_dwordx4 v44, s[16:19], s34 offen offset:0 lds
v_mfma_f32_16x16x32_bf16 v[124:127], v[60:63], v[212:215], v[124:127]
ds_read_b64_tr_b16 v[94:95], v26 offset:22528
s_waitcnt lgkmcnt(8)
v_mfma_f32_16x16x32_bf16 v[120:123], v[64:67], v[216:219], v[120:123]
ds_read_b64_tr_b16 v[48:49], v26 offset:24576
s_add_u32 s36, s33, 262144
v_mfma_f32_16x16x32_bf16 v[124:127], v[64:67], v[220:223], v[124:127]
ds_read_b64_tr_b16 v[50:51], v26 offset:26624
buffer_load_dwordx4 v45, s[16:19], s34 offen offset:1024 lds
v_mfma_f32_16x16x32_bf16 v[120:123], v[68:71], v[224:227], v[120:123]
ds_read_b64_tr_b16 v[52:53], v26 offset:28672
buffer_store_dwordx4 v[232:235], v240, s[20:23], s36 offen sc0 sc1
v_mfma_f32_16x16x32_bf16 v[124:127], v[68:71], v[228:231], v[124:127]
ds_read_b64_tr_b16 v[54:55], v26 offset:30720
buffer_load_dwordx4 v46, s[16:19], s34 offen offset:2048 lds
v_mfma_f32_16x16x32_bf16 v[144:147], v[72:75], v[160:163], 0
ds_read_b64_tr_b16 v[56:57], v26 offset:32768
v_mfma_f32_16x16x32_bf16 v[148:151], v[72:75], v[164:167], 0
ds_read_b64_tr_b16 v[58:59], v26 offset:34816
buffer_load_dwordx4 v47, s[16:19], s34 offen offset:3072 lds
v_mfma_f32_16x16x32_bf16 v[144:147], v[76:79], v[168:171], v[144:147]
ds_read_b64_tr_b16 v[60:61], v27 offset:0
v_mfma_f32_16x16x32_bf16 v[148:151], v[76:79], v[172:175], v[148:151]
ds_read_b64_tr_b16 v[62:63], v27 offset:2048
s_waitcnt lgkmcnt(8)
v_mfma_f32_16x16x32_bf16 v[144:147], v[80:83], v[176:179], v[144:147]
ds_read_b64_tr_b16 v[64:65], v27 offset:4096
v_cvt_pk_bf16_f32 v236, v120, v121
v_mfma_f32_16x16x32_bf16 v[148:151], v[80:83], v[180:183], v[148:151]
ds_read_b64_tr_b16 v[66:67], v27 offset:6144
v_cvt_pk_bf16_f32 v237, v122, v123
v_mfma_f32_16x16x32_bf16 v[144:147], v[84:87], v[184:187], v[144:147]
ds_read_b64_tr_b16 v[68:69], v27 offset:8192
v_cvt_pk_bf16_f32 v238, v124, v125
v_mfma_f32_16x16x32_bf16 v[148:151], v[84:87], v[188:191], v[148:151]
ds_read_b64_tr_b16 v[70:71], v27 offset:10240
v_cvt_pk_bf16_f32 v239, v126, v127
v_mfma_f32_16x16x32_bf16 v[144:147], v[88:91], v[192:195], v[144:147]
ds_read_b64_tr_b16 v[72:73], v27 offset:12288
s_add_u32 s36, s33, 278528
v_mfma_f32_16x16x32_bf16 v[148:151], v[88:91], v[196:199], v[148:151]
ds_read_b64_tr_b16 v[74:75], v27 offset:14336
buffer_store_dwordx4 v[236:239], v240, s[20:23], s36 offen sc0 sc1
v_mfma_f32_16x16x32_bf16 v[144:147], v[92:95], v[200:203], v[144:147]
ds_read_b64_tr_b16 v[76:77], v27 offset:16384
v_mfma_f32_16x16x32_bf16 v[148:151], v[92:95], v[204:207], v[148:151]
ds_read_b64_tr_b16 v[78:79], v27 offset:18432
s_waitcnt lgkmcnt(8)
v_mfma_f32_16x16x32_bf16 v[144:147], v[48:51], v[208:211], v[144:147]
ds_read_b64_tr_b16 v[80:81], v27 offset:20480
v_mfma_f32_16x16x32_bf16 v[148:151], v[48:51], v[212:215], v[148:151]
ds_read_b64_tr_b16 v[82:83], v27 offset:22528
v_mfma_f32_16x16x32_bf16 v[144:147], v[52:55], v[216:219], v[144:147]
ds_read_b64_tr_b16 v[84:85], v27 offset:24576
v_mfma_f32_16x16x32_bf16 v[148:151], v[52:55], v[220:223], v[148:151]
ds_read_b64_tr_b16 v[86:87], v27 offset:26624
v_mfma_f32_16x16x32_bf16 v[144:147], v[56:59], v[224:227], v[144:147]
ds_read_b64_tr_b16 v[88:89], v27 offset:28672
v_mfma_f32_16x16x32_bf16 v[148:151], v[56:59], v[228:231], v[148:151]
ds_read_b64_tr_b16 v[90:91], v27 offset:30720
s_waitcnt vmcnt(14)
v_mfma_f32_16x16x32_bf16 v[152:155], v[60:63], v[160:163], 0
ds_read_b64_tr_b16 v[92:93], v27 offset:32768
s_barrier
v_mfma_f32_16x16x32_bf16 v[156:159], v[60:63], v[164:167], 0
ds_read_b64_tr_b16 v[94:95], v27 offset:34816
s_waitcnt lgkmcnt(8)
v_mfma_f32_16x16x32_bf16 v[152:155], v[64:67], v[168:171], v[152:155]
ds_read_b64_tr_b16 v[48:49], v28 offset:0
v_mfma_f32_16x16x32_bf16 v[156:159], v[64:67], v[172:175], v[156:159]
ds_read_b64_tr_b16 v[50:51], v28 offset:2048
v_mfma_f32_16x16x32_bf16 v[152:155], v[68:71], v[176:179], v[152:155]
ds_read_b64_tr_b16 v[52:53], v28 offset:4096
v_cvt_pk_bf16_f32 v232, v144, v145
v_mfma_f32_16x16x32_bf16 v[156:159], v[68:71], v[180:183], v[156:159]
ds_read_b64_tr_b16 v[54:55], v28 offset:6144
v_cvt_pk_bf16_f32 v233, v146, v147
v_mfma_f32_16x16x32_bf16 v[152:155], v[72:75], v[184:187], v[152:155]
ds_read_b64_tr_b16 v[56:57], v28 offset:8192
v_cvt_pk_bf16_f32 v234, v148, v149
v_mfma_f32_16x16x32_bf16 v[156:159], v[72:75], v[188:191], v[156:159]
ds_read_b64_tr_b16 v[58:59], v28 offset:10240
v_cvt_pk_bf16_f32 v235, v150, v151
v_mfma_f32_16x16x32_bf16 v[152:155], v[76:79], v[192:195], v[152:155]
ds_read_b64_tr_b16 v[60:61], v28 offset:12288
s_add_u32 s36, s33, 294912
v_mfma_f32_16x16x32_bf16 v[156:159], v[76:79], v[196:199], v[156:159]
ds_read_b64_tr_b16 v[62:63], v28 offset:14336
s_waitcnt lgkmcnt(8)
v_mfma_f32_16x16x32_bf16 v[152:155], v[80:83], v[200:203], v[152:155]
ds_read_b64_tr_b16 v[64:65], v28 offset:16384
buffer_store_dwordx4 v[232:235], v240, s[20:23], s36 offen sc0 sc1
v_mfma_f32_16x16x32_bf16 v[156:159], v[80:83], v[204:207], v[156:159]
ds_read_b64_tr_b16 v[66:67], v28 offset:18432
v_mfma_f32_16x16x32_bf16 v[152:155], v[84:87], v[208:211], v[152:155]
ds_read_b64_tr_b16 v[68:69], v28 offset:20480
v_mfma_f32_16x16x32_bf16 v[156:159], v[84:87], v[212:215], v[156:159]
ds_read_b64_tr_b16 v[70:71], v28 offset:22528
v_mfma_f32_16x16x32_bf16 v[152:155], v[88:91], v[216:219], v[152:155]
ds_read_b64_tr_b16 v[72:73], v28 offset:24576
v_mfma_f32_16x16x32_bf16 v[156:159], v[88:91], v[220:223], v[156:159]
ds_read_b64_tr_b16 v[74:75], v28 offset:26624
v_mfma_f32_16x16x32_bf16 v[152:155], v[92:95], v[224:227], v[152:155]
ds_read_b64_tr_b16 v[76:77], v28 offset:28672
v_mfma_f32_16x16x32_bf16 v[156:159], v[92:95], v[228:231], v[156:159]
ds_read_b64_tr_b16 v[78:79], v28 offset:30720
s_waitcnt lgkmcnt(8)
v_mfma_f32_16x16x32_bf16 v[112:115], v[48:51], v[160:163], 0
ds_read_b64_tr_b16 v[80:81], v28 offset:32768
s_add_u32 m0, s32, 36864
v_mfma_f32_16x16x32_bf16 v[116:119], v[48:51], v[164:167], 0
ds_read_b64_tr_b16 v[82:83], v28 offset:34816
s_add_u32 s34, s30, 896
v_mfma_f32_16x16x32_bf16 v[112:115], v[52:55], v[168:171], v[112:115]
ds_read_b64_tr_b16 v[84:85], v29 offset:0
v_mfma_f32_16x16x32_bf16 v[116:119], v[52:55], v[172:175], v[116:119]
ds_read_b64_tr_b16 v[86:87], v29 offset:2048
buffer_load_dwordx4 v44, s[16:19], s34 offen offset:0 lds
v_mfma_f32_16x16x32_bf16 v[112:115], v[56:59], v[176:179], v[112:115]
ds_read_b64_tr_b16 v[88:89], v29 offset:4096
v_cvt_pk_bf16_f32 v236, v152, v153
v_mfma_f32_16x16x32_bf16 v[116:119], v[56:59], v[180:183], v[116:119]
ds_read_b64_tr_b16 v[90:91], v29 offset:6144
L_mlp_pad8:
s_cbranch_execz L_mlp_padret
v_cvt_pk_bf16_f32 v237, v154, v155
v_mfma_f32_16x16x32_bf16 v[112:115], v[60:63], v[184:187], v[112:115]
ds_read_b64_tr_b16 v[92:93], v29 offset:8192
v_cvt_pk_bf16_f32 v238, v156, v157
v_mfma_f32_16x16x32_bf16 v[116:119], v[60:63], v[188:191], v[116:119]
ds_read_b64_tr_b16 v[94:95], v29 offset:10240
s_waitcnt lgkmcnt(8)
v_mfma_f32_16x16x32_bf16 v[112:115], v[64:67], v[192:195], v[112:115]
ds_read_b64_tr_b16 v[48:49], v29 offset:12288
v_cvt_pk_bf16_f32 v239, v158, v159
v_mfma_f32_16x16x32_bf16 v[116:119], v[64:67], v[196:199], v[116:119]
ds_read_b64_tr_b16 v[50:51], v29 offset:14336
s_add_u32 s36, s33, 311296
v_mfma_f32_16x16x32_bf16 v[112:115], v[68:71], v[200:203], v[112:115]
ds_read_b64_tr_b16 v[52:53], v29 offset:16384
buffer_store_dwordx4 v[236:239], v240, s[20:23], s36 offen sc0 sc1
v_mfma_f32_16x16x32_bf16 v[116:119], v[68:71], v[204:207], v[116:119]
ds_read_b64_tr_b16 v[54:55], v29 offset:18432
v_mfma_f32_16x16x32_bf16 v[112:115], v[72:75], v[208:211], v[112:115]
ds_read_b64_tr_b16 v[56:57], v29 offset:20480
buffer_load_dwordx4 v45, s[16:19], s34 offen offset:1024 lds
v_mfma_f32_16x16x32_bf16 v[116:119], v[72:75], v[212:215], v[116:119]
ds_read_b64_tr_b16 v[58:59], v29 offset:22528
v_mfma_f32_16x16x32_bf16 v[112:115], v[76:79], v[216:219], v[112:115]
ds_read_b64_tr_b16 v[60:61], v29 offset:24576
buffer_load_dwordx4 v46, s[16:19], s34 offen offset:2048 lds
v_mfma_f32_16x16x32_bf16 v[116:119], v[76:79], v[220:223], v[116:119]
ds_read_b64_tr_b16 v[62:63], v29 offset:26624
s_waitcnt lgkmcnt(8)
v_mfma_f32_16x16x32_bf16 v[112:115], v[80:83], v[224:227], v[112:115]
ds_read_b64_tr_b16 v[64:65], v29 offset:28672
v_mfma_f32_16x16x32_bf16 v[116:119], v[80:83], v[228:231], v[116:119]
ds_read_b64_tr_b16 v[66:67], v29 offset:30720
buffer_load_dwordx4 v47, s[16:19], s34 offen offset:3072 lds
v_mfma_f32_16x16x32_bf16 v[120:123], v[84:87], v[160:163], 0
ds_read_b64_tr_b16 v[68:69], v29 offset:32768
v_mfma_f32_16x16x32_bf16 v[124:127], v[84:87], v[164:167], 0
ds_read_b64_tr_b16 v[70:71], v29 offset:34816
s_add_u32 m0, s32, 40960
v_mfma_f32_16x16x32_bf16 v[120:123], v[88:91], v[168:171], v[120:123]
ds_read_b64_tr_b16 v[72:73], v30 offset:0
v_mfma_f32_16x16x32_bf16 v[124:127], v[88:91], v[172:175], v[124:127]
ds_read_b64_tr_b16 v[74:75], v30 offset:2048
s_add_u32 s34, s30, 37760
v_mfma_f32_16x16x32_bf16 v[120:123], v[92:95], v[176:179], v[120:123]
ds_read_b64_tr_b16 v[76:77], v30 offset:4096
v_cvt_pk_bf16_f32 v232, v112, v113
v_mfma_f32_16x16x32_bf16 v[124:127], v[92:95], v[180:183], v[124:127]
ds_read_b64_tr_b16 v[78:79], v30 offset:6144
s_waitcnt lgkmcnt(8)
v_mfma_f32_16x16x32_bf16 v[120:123], v[48:51], v[184:187], v[120:123]
ds_read_b64_tr_b16 v[80:81], v30 offset:8192
buffer_load_dwordx4 v44, s[16:19], s34 offen offset:0 lds
v_mfma_f32_16x16x32_bf16 v[124:127], v[48:51], v[188:191], v[124:127]
ds_read_b64_tr_b16 v[82:83], v30 offset:10240
v_cvt_pk_bf16_f32 v233, v114, v115
v_mfma_f32_16x16x32_bf16 v[120:123], v[52:55], v[192:195], v[120:123]
ds_read_b64_tr_b16 v[84:85], v30 offset:12288
s_add_u32 m0, s32, 41984
v_mfma_f32_16x16x32_bf16 v[124:127], v[52:55], v[196:199], v[124:127]
ds_read_b64_tr_b16 v[86:87], v30 offset:14336
v_cvt_pk_bf16_f32 v234, v116, v117
v_mfma_f32_16x16x32_bf16 v[120:123], v[56:59], v[200:203], v[120:123]
ds_read_b64_tr_b16 v[88:89], v30 offset:16384
s_add_u32 s34, s31, 896
v_mfma_f32_16x16x32_bf16 v[124:127], v[56:59], v[204:207], v[124:127]
ds_read_b64_tr_b16 v[90:91], v30 offset:18432
v_cvt_pk_bf16_f32 v235, v118, v119
v_mfma_f32_16x16x32_bf16 v[120:123], v[60:63], v[208:211], v[120:123]
ds_read_b64_tr_b16 v[92:93], v30 offset:20480
buffer_load_dwordx4 v44, s[16:19], s34 offen offset:0 lds
v_mfma_f32_16x16x32_bf16 v[124:127], v[60:63], v[212:215], v[124:127]
ds_read_b64_tr_b16 v[94:95], v30 offset:22528
s_waitcnt lgkmcnt(8)
v_mfma_f32_16x16x32_bf16 v[120:123], v[64:67], v[216:219], v[120:123]
ds_read_b64_tr_b16 v[48:49], v30 offset:24576
s_add_u32 s36, s33, 327680
v_mfma_f32_16x16x32_bf16 v[124:127], v[64:67], v[220:223], v[124:127]
ds_read_b64_tr_b16 v[50:51], v30 offset:26624
buffer_load_dwordx4 v45, s[16:19], s34 offen offset:1024 lds
v_mfma_f32_16x16x32_bf16 v[120:123], v[68:71], v[224:227], v[120:123]
ds_read_b64_tr_b16 v[52:53], v30 offset:28672
buffer_store_dwordx4 v[232:235], v240, s[20:23], s36 offen sc0 sc1
v_mfma_f32_16x16x32_bf16 v[124:127], v[68:71], v[228:231], v[124:127]
ds_read_b64_tr_b16 v[54:55], v30 offset:30720
buffer_load_dwordx4 v46, s[16:19], s34 offen offset:2048 lds
v_mfma_f32_16x16x32_bf16 v[144:147], v[72:75], v[160:163], 0
ds_read_b64_tr_b16 v[56:57], v30 offset:32768
v_mfma_f32_16x16x32_bf16 v[148:151], v[72:75], v[164:167], 0
ds_read_b64_tr_b16 v[58:59], v30 offset:34816
buffer_load_dwordx4 v47, s[16:19], s34 offen offset:3072 lds
v_mfma_f32_16x16x32_bf16 v[144:147], v[76:79], v[168:171], v[144:147]
ds_read_b64_tr_b16 v[60:61], v31 offset:0
v_mfma_f32_16x16x32_bf16 v[148:151], v[76:79], v[172:175], v[148:151]
ds_read_b64_tr_b16 v[62:63], v31 offset:2048
s_waitcnt lgkmcnt(8)
v_mfma_f32_16x16x32_bf16 v[144:147], v[80:83], v[176:179], v[144:147]
ds_read_b64_tr_b16 v[64:65], v31 offset:4096
v_cvt_pk_bf16_f32 v236, v120, v121
v_mfma_f32_16x16x32_bf16 v[148:151], v[80:83], v[180:183], v[148:151]
ds_read_b64_tr_b16 v[66:67], v31 offset:6144
v_cvt_pk_bf16_f32 v237, v122, v123
v_mfma_f32_16x16x32_bf16 v[144:147], v[84:87], v[184:187], v[144:147]
ds_read_b64_tr_b16 v[68:69], v31 offset:8192
v_cvt_pk_bf16_f32 v238, v124, v125
v_mfma_f32_16x16x32_bf16 v[148:151], v[84:87], v[188:191], v[148:151]
ds_read_b64_tr_b16 v[70:71], v31 offset:10240
v_cvt_pk_bf16_f32 v239, v126, v127
v_mfma_f32_16x16x32_bf16 v[144:147], v[88:91], v[192:195], v[144:147]
ds_read_b64_tr_b16 v[72:73], v31 offset:12288
s_add_u32 s36, s33, 344064
v_mfma_f32_16x16x32_bf16 v[148:151], v[88:91], v[196:199], v[148:151]
ds_read_b64_tr_b16 v[74:75], v31 offset:14336
buffer_store_dwordx4 v[236:239], v240, s[20:23], s36 offen sc0 sc1
v_mfma_f32_16x16x32_bf16 v[144:147], v[92:95], v[200:203], v[144:147]
ds_read_b64_tr_b16 v[76:77], v31 offset:16384
v_mfma_f32_16x16x32_bf16 v[148:151], v[92:95], v[204:207], v[148:151]
ds_read_b64_tr_b16 v[78:79], v31 offset:18432
s_waitcnt lgkmcnt(8)
v_mfma_f32_16x16x32_bf16 v[144:147], v[48:51], v[208:211], v[144:147]
ds_read_b64_tr_b16 v[80:81], v31 offset:20480
v_mfma_f32_16x16x32_bf16 v[148:151], v[48:51], v[212:215], v[148:151]
ds_read_b64_tr_b16 v[82:83], v31 offset:22528
v_mfma_f32_16x16x32_bf16 v[144:147], v[52:55], v[216:219], v[144:147]
ds_read_b64_tr_b16 v[84:85], v31 offset:24576
v_mfma_f32_16x16x32_bf16 v[148:151], v[52:55], v[220:223], v[148:151]
ds_read_b64_tr_b16 v[86:87], v31 offset:26624
v_mfma_f32_16x16x32_bf16 v[144:147], v[56:59], v[224:227], v[144:147]
ds_read_b64_tr_b16 v[88:89], v31 offset:28672
v_mfma_f32_16x16x32_bf16 v[148:151], v[56:59], v[228:231], v[148:151]
ds_read_b64_tr_b16 v[90:91], v31 offset:30720
s_waitcnt vmcnt(14)
v_mfma_f32_16x16x32_bf16 v[152:155], v[60:63], v[160:163], 0
ds_read_b64_tr_b16 v[92:93], v31 offset:32768
s_barrier
v_mfma_f32_16x16x32_bf16 v[156:159], v[60:63], v[164:167], 0
ds_read_b64_tr_b16 v[94:95], v31 offset:34816
s_waitcnt lgkmcnt(8)
v_mfma_f32_16x16x32_bf16 v[152:155], v[64:67], v[168:171], v[152:155]
ds_read_b64_tr_b16 v[48:49], v16 offset:0
v_mfma_f32_16x16x32_bf16 v[156:159], v[64:67], v[172:175], v[156:159]
ds_read_b64_tr_b16 v[50:51], v16 offset:2048
v_mfma_f32_16x16x32_bf16 v[152:155], v[68:71], v[176:179], v[152:155]
ds_read_b64_tr_b16 v[52:53], v16 offset:4096
v_cvt_pk_bf16_f32 v232, v144, v145
v_mfma_f32_16x16x32_bf16 v[156:159], v[68:71], v[180:183], v[156:159]
ds_read_b64_tr_b16 v[54:55], v16 offset:6144
v_cvt_pk_bf16_f32 v233, v146, v147
v_mfma_f32_16x16x32_bf16 v[152:155], v[72:75], v[184:187], v[152:155]
ds_read_b64_tr_b16 v[56:57], v16 offset:8192
v_cvt_pk_bf16_f32 v234, v148, v149
v_mfma_f32_16x16x32_bf16 v[156:159], v[72:75], v[188:191], v[156:159]
ds_read_b64_tr_b16 v[58:59], v16 offset:10240
v_cvt_pk_bf16_f32 v235, v150, v151
v_mfma_f32_16x16x32_bf16 v[152:155], v[76:79], v[192:195], v[152:155]
ds_read_b64_tr_b16 v[60:61], v16 offset:12288
s_add_u32 s36, s33, 360448
v_mfma_f32_16x16x32_bf16 v[156:159], v[76:79], v[196:199], v[156:159]
ds_read_b64_tr_b16 v[62:63], v16 offset:14336
s_waitcnt lgkmcnt(8)
v_mfma_f32_16x16x32_bf16 v[152:155], v[80:83], v[200:203], v[152:155]
ds_read_b64_tr_b16 v[64:65], v16 offset:16384
buffer_store_dwordx4 v[232:235], v240, s[20:23], s36 offen sc0 sc1
v_mfma_f32_16x16x32_bf16 v[156:159], v[80:83], v[204:207], v[156:159]
ds_read_b64_tr_b16 v[66:67], v16 offset:18432
v_mfma_f32_16x16x32_bf16 v[152:155], v[84:87], v[208:211], v[152:155]
ds_read_b64_tr_b16 v[68:69], v16 offset:20480
v_mfma_f32_16x16x32_bf16 v[156:159], v[84:87], v[212:215], v[156:159]
ds_read_b64_tr_b16 v[70:71], v16 offset:22528
v_mfma_f32_16x16x32_bf16 v[152:155], v[88:91], v[216:219], v[152:155]
ds_read_b64_tr_b16 v[72:73], v16 offset:24576
v_mfma_f32_16x16x32_bf16 v[156:159], v[88:91], v[220:223], v[156:159]
ds_read_b64_tr_b16 v[74:75], v16 offset:26624
v_mfma_f32_16x16x32_bf16 v[152:155], v[92:95], v[224:227], v[152:155]
ds_read_b64_tr_b16 v[76:77], v16 offset:28672
v_mfma_f32_16x16x32_bf16 v[156:159], v[92:95], v[228:231], v[156:159]
ds_read_b64_tr_b16 v[78:79], v16 offset:30720
s_waitcnt lgkmcnt(8)
v_mfma_f32_16x16x32_bf16 v[112:115], v[48:51], v[160:163], 0
ds_read_b64_tr_b16 v[80:81], v16 offset:32768
s_add_u32 m0, s32, 73728
v_mfma_f32_16x16x32_bf16 v[116:119], v[48:51], v[164:167], 0
ds_read_b64_tr_b16 v[82:83], v16 offset:34816
s_add_u32 s34, s30, 1024
v_mfma_f32_16x16x32_bf16 v[112:115], v[52:55], v[168:171], v[112:115]
ds_read_b64_tr_b16 v[84:85], v17 offset:0
v_mfma_f32_16x16x32_bf16 v[116:119], v[52:55], v[172:175], v[116:119]
ds_read_b64_tr_b16 v[86:87], v17 offset:2048
buffer_load_dwordx4 v44, s[16:19], s34 offen offset:0 lds
v_mfma_f32_16x16x32_bf16 v[112:115], v[56:59], v[176:179], v[112:115]
ds_read_b64_tr_b16 v[88:89], v17 offset:4096
v_cvt_pk_bf16_f32 v236, v152, v153
v_mfma_f32_16x16x32_bf16 v[116:119], v[56:59], v[180:183], v[116:119]
ds_read_b64_tr_b16 v[90:91], v17 offset:6144
v_cvt_pk_bf16_f32 v237, v154, v155
v_mfma_f32_16x16x32_bf16 v[112:115], v[60:63], v[184:187], v[112:115]
ds_read_b64_tr_b16 v[92:93], v17 offset:8192
v_cvt_pk_bf16_f32 v238, v156, v157
v_mfma_f32_16x16x32_bf16 v[116:119], v[60:63], v[188:191], v[116:119]
ds_read_b64_tr_b16 v[94:95], v17 offset:10240
s_waitcnt lgkmcnt(8)
v_mfma_f32_16x16x32_bf16 v[112:115], v[64:67], v[192:195], v[112:115]
ds_read_b64_tr_b16 v[48:49], v17 offset:12288
v_cvt_pk_bf16_f32 v239, v158, v159
v_mfma_f32_16x16x32_bf16 v[116:119], v[64:67], v[196:199], v[116:119]
ds_read_b64_tr_b16 v[50:51], v17 offset:14336
s_add_u32 s36, s33, 376832
v_mfma_f32_16x16x32_bf16 v[112:115], v[68:71], v[200:203], v[112:115]
ds_read_b64_tr_b16 v[52:53], v17 offset:16384
buffer_store_dwordx4 v[236:239], v240, s[20:23], s36 offen sc0 sc1
v_mfma_f32_16x16x32_bf16 v[116:119], v[68:71], v[204:207], v[116:119]
ds_read_b64_tr_b16 v[54:55], v17 offset:18432
v_mfma_f32_16x16x32_bf16 v[112:115], v[72:75], v[208:211], v[112:115]
ds_read_b64_tr_b16 v[56:57], v17 offset:20480
buffer_load_dwordx4 v45, s[16:19], s34 offen offset:1024 lds
v_mfma_f32_16x16x32_bf16 v[116:119], v[72:75], v[212:215], v[116:119]
ds_read_b64_tr_b16 v[58:59], v17 offset:22528
v_mfma_f32_16x16x32_bf16 v[112:115], v[76:79], v[216:219], v[112:115]
ds_read_b64_tr_b16 v[60:61], v17 offset:24576
buffer_load_dwordx4 v46, s[16:19], s34 offen offset:2048 lds
v_mfma_f32_16x16x32_bf16 v[116:119], v[76:79], v[220:223], v[116:119]
ds_read_b64_tr_b16 v[62:63], v17 offset:26624
s_waitcnt lgkmcnt(8)
v_mfma_f32_16x16x32_bf16 v[112:115], v[80:83], v[224:227], v[112:115]
ds_read_b64_tr_b16 v[64:65], v17 offset:28672
v_mfma_f32_16x16x32_bf16 v[116:119], v[80:83], v[228:231], v[116:119]
ds_read_b64_tr_b16 v[66:67], v17 offset:30720
buffer_load_dwordx4 v47, s[16:19], s34 offen offset:3072 lds
v_mfma_f32_16x16x32_bf16 v[120:123], v[84:87], v[160:163], 0
ds_read_b64_tr_b16 v[68:69], v17 offset:32768
v_mfma_f32_16x16x32_bf16 v[124:127], v[84:87], v[164:167], 0
ds_read_b64_tr_b16 v[70:71], v17 offset:34816
s_add_u32 m0, s32, 77824
v_mfma_f32_16x16x32_bf16 v[120:123], v[88:91], v[168:171], v[120:123]
ds_read_b64_tr_b16 v[72:73], v18 offset:0
v_mfma_f32_16x16x32_bf16 v[124:127], v[88:91], v[172:175], v[124:127]
ds_read_b64_tr_b16 v[74:75], v18 offset:2048
s_add_u32 s34, s30, 37888
v_mfma_f32_16x16x32_bf16 v[120:123], v[92:95], v[176:179], v[120:123]
ds_read_b64_tr_b16 v[76:77], v18 offset:4096
v_cvt_pk_bf16_f32 v232, v112, v113
v_mfma_f32_16x16x32_bf16 v[124:127], v[92:95], v[180:183], v[124:127]
ds_read_b64_tr_b16 v[78:79], v18 offset:6144
s_waitcnt lgkmcnt(8)
v_mfma_f32_16x16x32_bf16 v[120:123], v[48:51], v[184:187], v[120:123]
ds_read_b64_tr_b16 v[80:81], v18 offset:8192
buffer_load_dwordx4 v44, s[16:19], s34 offen offset:0 lds
v_mfma_f32_16x16x32_bf16 v[124:127], v[48:51], v[188:191], v[124:127]
ds_read_b64_tr_b16 v[82:83], v18 offset:10240
v_cvt_pk_bf16_f32 v233, v114, v115
v_mfma_f32_16x16x32_bf16 v[120:123], v[52:55], v[192:195], v[120:123]
ds_read_b64_tr_b16 v[84:85], v18 offset:12288
s_add_u32 m0, s32, 78848
v_mfma_f32_16x16x32_bf16 v[124:127], v[52:55], v[196:199], v[124:127]
ds_read_b64_tr_b16 v[86:87], v18 offset:14336
v_cvt_pk_bf16_f32 v234, v116, v117
v_mfma_f32_16x16x32_bf16 v[120:123], v[56:59], v[200:203], v[120:123]
ds_read_b64_tr_b16 v[88:89], v18 offset:16384
s_add_u32 s34, s31, 1024
v_mfma_f32_16x16x32_bf16 v[124:127], v[56:59], v[204:207], v[124:127]
ds_read_b64_tr_b16 v[90:91], v18 offset:18432
v_cvt_pk_bf16_f32 v235, v118, v119
v_mfma_f32_16x16x32_bf16 v[120:123], v[60:63], v[208:211], v[120:123]
ds_read_b64_tr_b16 v[92:93], v18 offset:20480
buffer_load_dwordx4 v44, s[16:19], s34 offen offset:0 lds
v_mfma_f32_16x16x32_bf16 v[124:127], v[60:63], v[212:215], v[124:127]
ds_read_b64_tr_b16 v[94:95], v18 offset:22528
s_waitcnt lgkmcnt(8)
v_mfma_f32_16x16x32_bf16 v[120:123], v[64:67], v[216:219], v[120:123]
ds_read_b64_tr_b16 v[48:49], v18 offset:24576
s_add_u32 s36, s33, 393216
v_mfma_f32_16x16x32_bf16 v[124:127], v[64:67], v[220:223], v[124:127]
ds_read_b64_tr_b16 v[50:51], v18 offset:26624
buffer_load_dwordx4 v45, s[16:19], s34 offen offset:1024 lds
v_mfma_f32_16x16x32_bf16 v[120:123], v[68:71], v[224:227], v[120:123]
ds_read_b64_tr_b16 v[52:53], v18 offset:28672
buffer_store_dwordx4 v[232:235], v240, s[20:23], s36 offen sc0 sc1
v_mfma_f32_16x16x32_bf16 v[124:127], v[68:71], v[228:231], v[124:127]
ds_read_b64_tr_b16 v[54:55], v18 offset:30720
buffer_load_dwordx4 v46, s[16:19], s34 offen offset:2048 lds
v_mfma_f32_16x16x32_bf16 v[144:147], v[72:75], v[160:163], 0
ds_read_b64_tr_b16 v[56:57], v18 offset:32768
v_mfma_f32_16x16x32_bf16 v[148:151], v[72:75], v[164:167], 0
ds_read_b64_tr_b16 v[58:59], v18 offset:34816
buffer_load_dwordx4 v47, s[16:19], s34 offen offset:3072 lds
v_mfma_f32_16x16x32_bf16 v[144:147], v[76:79], v[168:171], v[144:147]
ds_read_b64_tr_b16 v[60:61], v19 offset:0
v_mfma_f32_16x16x32_bf16 v[148:151], v[76:79], v[172:175], v[148:151]
ds_read_b64_tr_b16 v[62:63], v19 offset:2048
s_waitcnt lgkmcnt(8)
v_mfma_f32_16x16x32_bf16 v[144:147], v[80:83], v[176:179], v[144:147]
ds_read_b64_tr_b16 v[64:65], v19 offset:4096
v_cvt_pk_bf16_f32 v236, v120, v121
v_mfma_f32_16x16x32_bf16 v[148:151], v[80:83], v[180:183], v[148:151]
ds_read_b64_tr_b16 v[66:67], v19 offset:6144
v_cvt_pk_bf16_f32 v237, v122, v123
v_mfma_f32_16x16x32_bf16 v[144:147], v[84:87], v[184:187], v[144:147]
ds_read_b64_tr_b16 v[68:69], v19 offset:8192
v_cvt_pk_bf16_f32 v238, v124, v125
v_mfma_f32_16x16x32_bf16 v[148:151], v[84:87], v[188:191], v[148:151]
ds_read_b64_tr_b16 v[70:71], v19 offset:10240
v_cvt_pk_bf16_f32 v239, v126, v127
v_mfma_f32_16x16x32_bf16 v[144:147], v[88:91], v[192:195], v[144:147]
ds_read_b64_tr_b16 v[72:73], v19 offset:12288
s_add_u32 s36, s33, 409600
v_mfma_f32_16x16x32_bf16 v[148:151], v[88:91], v[196:199], v[148:151]
ds_read_b64_tr_b16 v[74:75], v19 offset:14336
buffer_store_dwordx4 v[236:239], v240, s[20:23], s36 offen sc0 sc1
v_mfma_f32_16x16x32_bf16 v[144:147], v[92:95], v[200:203], v[144:147]
ds_read_b64_tr_b16 v[76:77], v19 offset:16384
v_mfma_f32_16x16x32_bf16 v[148:151], v[92:95], v[204:207], v[148:151]
ds_read_b64_tr_b16 v[78:79], v19 offset:18432
s_waitcnt lgkmcnt(8)
v_mfma_f32_16x16x32_bf16 v[144:147], v[48:51], v[208:211], v[144:147]
ds_read_b64_tr_b16 v[80:81], v19 offset:20480
v_mfma_f32_16x16x32_bf16 v[148:151], v[48:51], v[212:215], v[148:151]
ds_read_b64_tr_b16 v[82:83], v19 offset:22528
v_mfma_f32_16x16x32_bf16 v[144:147], v[52:55], v[216:219], v[144:147]
ds_read_b64_tr_b16 v[84:85], v19 offset:24576
v_mfma_f32_16x16x32_bf16 v[148:151], v[52:55], v[220:223], v[148:151]
ds_read_b64_tr_b16 v[86:87], v19 offset:26624
v_mfma_f32_16x16x32_bf16 v[144:147], v[56:59], v[224:227], v[144:147]
ds_read_b64_tr_b16 v[88:89], v19 offset:28672
v_mfma_f32_16x16x32_bf16 v[148:151], v[56:59], v[228:231], v[148:151]
ds_read_b64_tr_b16 v[90:91], v19 offset:30720
s_waitcnt vmcnt(14)
v_mfma_f32_16x16x32_bf16 v[152:155], v[60:63], v[160:163], 0
ds_read_b64_tr_b16 v[92:93], v19 offset:32768
s_barrier
v_mfma_f32_16x16x32_bf16 v[156:159], v[60:63], v[164:167], 0
ds_read_b64_tr_b16 v[94:95], v19 offset:34816
s_waitcnt lgkmcnt(8)
v_mfma_f32_16x16x32_bf16 v[152:155], v[64:67], v[168:171], v[152:155]
ds_read_b64_tr_b16 v[48:49], v20 offset:0
v_mfma_f32_16x16x32_bf16 v[156:159], v[64:67], v[172:175], v[156:159]
ds_read_b64_tr_b16 v[50:51], v20 offset:2048
v_mfma_f32_16x16x32_bf16 v[152:155], v[68:71], v[176:179], v[152:155]
ds_read_b64_tr_b16 v[52:53], v20 offset:4096
v_cvt_pk_bf16_f32 v232, v144, v145
v_mfma_f32_16x16x32_bf16 v[156:159], v[68:71], v[180:183], v[156:159]
ds_read_b64_tr_b16 v[54:55], v20 offset:6144
v_cvt_pk_bf16_f32 v233, v146, v147
v_mfma_f32_16x16x32_bf16 v[152:155], v[72:75], v[184:187], v[152:155]
ds_read_b64_tr_b16 v[56:57], v20 offset:8192
v_cvt_pk_bf16_f32 v234, v148, v149
v_mfma_f32_16x16x32_bf16 v[156:159], v[72:75], v[188:191], v[156:159]
ds_read_b64_tr_b16 v[58:59], v20 offset:10240
v_cvt_pk_bf16_f32 v235, v150, v151
v_mfma_f32_16x16x32_bf16 v[152:155], v[76:79], v[192:195], v[152:155]
ds_read_b64_tr_b16 v[60:61], v20 offset:12288
s_add_u32 s36, s33, 425984
v_mfma_f32_16x16x32_bf16 v[156:159], v[76:79], v[196:199], v[156:159]
ds_read_b64_tr_b16 v[62:63], v20 offset:14336
s_waitcnt lgkmcnt(8)
v_mfma_f32_16x16x32_bf16 v[152:155], v[80:83], v[200:203], v[152:155]
ds_read_b64_tr_b16 v[64:65], v20 offset:16384
buffer_store_dwordx4 v[232:235], v240, s[20:23], s36 offen sc0 sc1
v_mfma_f32_16x16x32_bf16 v[156:159], v[80:83], v[204:207], v[156:159]
ds_read_b64_tr_b16 v[66:67], v20 offset:18432
v_mfma_f32_16x16x32_bf16 v[152:155], v[84:87], v[208:211], v[152:155]
ds_read_b64_tr_b16 v[68:69], v20 offset:20480
v_mfma_f32_16x16x32_bf16 v[156:159], v[84:87], v[212:215], v[156:159]
ds_read_b64_tr_b16 v[70:71], v20 offset:22528
v_mfma_f32_16x16x32_bf16 v[152:155], v[88:91], v[216:219], v[152:155]
ds_read_b64_tr_b16 v[72:73], v20 offset:24576
v_mfma_f32_16x16x32_bf16 v[156:159], v[88:91], v[220:223], v[156:159]
ds_read_b64_tr_b16 v[74:75], v20 offset:26624
v_mfma_f32_16x16x32_bf16 v[152:155], v[92:95], v[224:227], v[152:155]
ds_read_b64_tr_b16 v[76:77], v20 offset:28672
v_mfma_f32_16x16x32_bf16 v[156:159], v[92:95], v[228:231], v[156:159]
ds_read_b64_tr_b16 v[78:79], v20 offset:30720
s_waitcnt lgkmcnt(8)
v_mfma_f32_16x16x32_bf16 v[112:115], v[48:51], v[160:163], 0
ds_read_b64_tr_b16 v[80:81], v20 offset:32768
v_mfma_f32_16x16x32_bf16 v[116:119], v[48:51], v[164:167], 0
ds_read_b64_tr_b16 v[82:83], v20 offset:34816
v_mfma_f32_16x16x32_bf16 v[112:115], v[52:55], v[168:171], v[112:115]
ds_read_b64_tr_b16 v[84:85], v21 offset:0
v_mfma_f32_16x16x32_bf16 v[116:119], v[52:55], v[172:175], v[116:119]
ds_read_b64_tr_b16 v[86:87], v21 offset:2048
v_mfma_f32_16x16x32_bf16 v[112:115], v[56:59], v[176:179], v[112:115]
ds_read_b64_tr_b16 v[88:89], v21 offset:4096
v_cvt_pk_bf16_f32 v236, v152, v153
v_mfma_f32_16x16x32_bf16 v[116:119], v[56:59], v[180:183], v[116:119]
ds_read_b64_tr_b16 v[90:91], v21 offset:6144
v_cvt_pk_bf16_f32 v237, v154, v155
v_mfma_f32_16x16x32_bf16 v[112:115], v[60:63], v[184:187], v[112:115]
ds_read_b64_tr_b16 v[92:93], v21 offset:8192
v_cvt_pk_bf16_f32 v238, v156, v157
v_mfma_f32_16x16x32_bf16 v[116:119], v[60:63], v[188:191], v[116:119]
ds_read_b64_tr_b16 v[94:95], v21 offset:10240
s_waitcnt lgkmcnt(8)
v_mfma_f32_16x16x32_bf16 v[112:115], v[64:67], v[192:195], v[112:115]
ds_read_b64_tr_b16 v[48:49], v21 offset:12288
v_cvt_pk_bf16_f32 v239, v158, v159
v_mfma_f32_16x16x32_bf16 v[116:119], v[64:67], v[196:199], v[116:119]
ds_read_b64_tr_b16 v[50:51], v21 offset:14336
s_add_u32 s36, s33, 442368
v_mfma_f32_16x16x32_bf16 v[112:115], v[68:71], v[200:203], v[112:115]
ds_read_b64_tr_b16 v[52:53], v21 offset:16384
buffer_store_dwordx4 v[236:239], v240, s[20:23], s36 offen sc0 sc1
v_mfma_f32_16x16x32_bf16 v[116:119], v[68:71], v[204:207], v[116:119]
ds_read_b64_tr_b16 v[54:55], v21 offset:18432
v_mfma_f32_16x16x32_bf16 v[112:115], v[72:75], v[208:211], v[112:115]
ds_read_b64_tr_b16 v[56:57], v21 offset:20480
v_mfma_f32_16x16x32_bf16 v[116:119], v[72:75], v[212:215], v[116:119]
ds_read_b64_tr_b16 v[58:59], v21 offset:22528
v_mfma_f32_16x16x32_bf16 v[112:115], v[76:79], v[216:219], v[112:115]
ds_read_b64_tr_b16 v[60:61], v21 offset:24576
v_mfma_f32_16x16x32_bf16 v[116:119], v[76:79], v[220:223], v[116:119]
ds_read_b64_tr_b16 v[62:63], v21 offset:26624
s_waitcnt lgkmcnt(8)
v_mfma_f32_16x16x32_bf16 v[112:115], v[80:83], v[224:227], v[112:115]
ds_read_b64_tr_b16 v[64:65], v21 offset:28672
v_mfma_f32_16x16x32_bf16 v[116:119], v[80:83], v[228:231], v[116:119]
ds_read_b64_tr_b16 v[66:67], v21 offset:30720
v_mfma_f32_16x16x32_bf16 v[120:123], v[84:87], v[160:163], 0
ds_read_b64_tr_b16 v[68:69], v21 offset:32768
v_mfma_f32_16x16x32_bf16 v[124:127], v[84:87], v[164:167], 0
ds_read_b64_tr_b16 v[70:71], v21 offset:34816
v_mfma_f32_16x16x32_bf16 v[120:123], v[88:91], v[168:171], v[120:123]
ds_read_b64_tr_b16 v[72:73], v22 offset:0
v_mfma_f32_16x16x32_bf16 v[124:127], v[88:91], v[172:175], v[124:127]
ds_read_b64_tr_b16 v[74:75], v22 offset:2048
v_mfma_f32_16x16x32_bf16 v[120:123], v[92:95], v[176:179], v[120:123]
ds_read_b64_tr_b16 v[76:77], v22 offset:4096
v_cvt_pk_bf16_f32 v232, v112, v113
v_mfma_f32_16x16x32_bf16 v[124:127], v[92:95], v[180:183], v[124:127]
ds_read_b64_tr_b16 v[78:79], v22 offset:6144
s_waitcnt lgkmcnt(8)
v_mfma_f32_16x16x32_bf16 v[120:123], v[48:51], v[184:187], v[120:123]
ds_read_b64_tr_b16 v[80:81], v22 offset:8192
v_cvt_pk_bf16_f32 v233, v114, v115
v_mfma_f32_16x16x32_bf16 v[124:127], v[48:51], v[188:191], v[124:127]
ds_read_b64_tr_b16 v[82:83], v22 offset:10240
v_cvt_pk_bf16_f32 v234, v116, v117
v_mfma_f32_16x16x32_bf16 v[120:123], v[52:55], v[192:195], v[120:123]
ds_read_b64_tr_b16 v[84:85], v22 offset:12288
v_cvt_pk_bf16_f32 v235, v118, v119
v_mfma_f32_16x16x32_bf16 v[124:127], v[52:55], v[196:199], v[124:127]
ds_read_b64_tr_b16 v[86:87], v22 offset:14336
s_add_u32 s36, s33, 458752
v_mfma_f32_16x16x32_bf16 v[120:123], v[56:59], v[200:203], v[120:123]
ds_read_b64_tr_b16 v[88:89], v22 offset:16384
buffer_store_dwordx4 v[232:235], v240, s[20:23], s36 offen sc0 sc1
v_mfma_f32_16x16x32_bf16 v[124:127], v[56:59], v[204:207], v[124:127]
ds_read_b64_tr_b16 v[90:91], v22 offset:18432
v_mfma_f32_16x16x32_bf16 v[120:123], v[60:63], v[208:211], v[120:123]
ds_read_b64_tr_b16 v[92:93], v22 offset:20480
v_mfma_f32_16x16x32_bf16 v[124:127], v[60:63], v[212:215], v[124:127]
ds_read_b64_tr_b16 v[94:95], v22 offset:22528
s_waitcnt lgkmcnt(8)
v_mfma_f32_16x16x32_bf16 v[120:123], v[64:67], v[216:219], v[120:123]
ds_read_b64_tr_b16 v[48:49], v22 offset:24576
v_mfma_f32_16x16x32_bf16 v[124:127], v[64:67], v[220:223], v[124:127]
ds_read_b64_tr_b16 v[50:51], v22 offset:26624
v_mfma_f32_16x16x32_bf16 v[120:123], v[68:71], v[224:227], v[120:123]
ds_read_b64_tr_b16 v[52:53], v22 offset:28672
v_mfma_f32_16x16x32_bf16 v[124:127], v[68:71], v[228:231], v[124:127]
ds_read_b64_tr_b16 v[54:55], v22 offset:30720
v_mfma_f32_16x16x32_bf16 v[144:147], v[72:75], v[160:163], 0
ds_read_b64_tr_b16 v[56:57], v22 offset:32768
v_mfma_f32_16x16x32_bf16 v[148:151], v[72:75], v[164:167], 0
ds_read_b64_tr_b16 v[58:59], v22 offset:34816
v_mfma_f32_16x16x32_bf16 v[144:147], v[76:79], v[168:171], v[144:147]
ds_read_b64_tr_b16 v[60:61], v23 offset:0
v_mfma_f32_16x16x32_bf16 v[148:151], v[76:79], v[172:175], v[148:151]
ds_read_b64_tr_b16 v[62:63], v23 offset:2048
s_waitcnt lgkmcnt(8)
v_mfma_f32_16x16x32_bf16 v[144:147], v[80:83], v[176:179], v[144:147]
ds_read_b64_tr_b16 v[64:65], v23 offset:4096
v_cvt_pk_bf16_f32 v236, v120, v121
v_mfma_f32_16x16x32_bf16 v[148:151], v[80:83], v[180:183], v[148:151]
ds_read_b64_tr_b16 v[66:67], v23 offset:6144
v_cvt_pk_bf16_f32 v237, v122, v123
v_mfma_f32_16x16x32_bf16 v[144:147], v[84:87], v[184:187], v[144:147]
ds_read_b64_tr_b16 v[68:69], v23 offset:8192
v_cvt_pk_bf16_f32 v238, v124, v125
v_mfma_f32_16x16x32_bf16 v[148:151], v[84:87], v[188:191], v[148:151]
ds_read_b64_tr_b16 v[70:71], v23 offset:10240
v_cvt_pk_bf16_f32 v239, v126, v127
v_mfma_f32_16x16x32_bf16 v[144:147], v[88:91], v[192:195], v[144:147]
ds_read_b64_tr_b16 v[72:73], v23 offset:12288
s_add_u32 s36, s33, 475136
v_mfma_f32_16x16x32_bf16 v[148:151], v[88:91], v[196:199], v[148:151]
ds_read_b64_tr_b16 v[74:75], v23 offset:14336
buffer_store_dwordx4 v[236:239], v240, s[20:23], s36 offen sc0 sc1
v_mfma_f32_16x16x32_bf16 v[144:147], v[92:95], v[200:203], v[144:147]
ds_read_b64_tr_b16 v[76:77], v23 offset:16384
v_mfma_f32_16x16x32_bf16 v[148:151], v[92:95], v[204:207], v[148:151]
ds_read_b64_tr_b16 v[78:79], v23 offset:18432
s_waitcnt lgkmcnt(8)
v_mfma_f32_16x16x32_bf16 v[144:147], v[48:51], v[208:211], v[144:147]
ds_read_b64_tr_b16 v[80:81], v23 offset:20480
v_mfma_f32_16x16x32_bf16 v[148:151], v[48:51], v[212:215], v[148:151]
ds_read_b64_tr_b16 v[82:83], v23 offset:22528
v_mfma_f32_16x16x32_bf16 v[144:147], v[52:55], v[216:219], v[144:147]
ds_read_b64_tr_b16 v[84:85], v23 offset:24576
v_mfma_f32_16x16x32_bf16 v[148:151], v[52:55], v[220:223], v[148:151]
ds_read_b64_tr_b16 v[86:87], v23 offset:26624
v_mfma_f32_16x16x32_bf16 v[144:147], v[56:59], v[224:227], v[144:147]
ds_read_b64_tr_b16 v[88:89], v23 offset:28672
v_mfma_f32_16x16x32_bf16 v[148:151], v[56:59], v[228:231], v[148:151]
ds_read_b64_tr_b16 v[90:91], v23 offset:30720
s_waitcnt vmcnt(5)
v_mfma_f32_16x16x32_bf16 v[152:155], v[60:63], v[160:163], 0
ds_read_b64_tr_b16 v[92:93], v23 offset:32768
s_barrier
v_mfma_f32_16x16x32_bf16 v[156:159], v[60:63], v[164:167], 0
ds_read_b64_tr_b16 v[94:95], v23 offset:34816
s_waitcnt lgkmcnt(8)
v_mfma_f32_16x16x32_bf16 v[152:155], v[64:67], v[168:171], v[152:155]
ds_read_b64_tr_b16 v[48:49], v24 offset:0
v_mfma_f32_16x16x32_bf16 v[156:159], v[64:67], v[172:175], v[156:159]
ds_read_b64_tr_b16 v[50:51], v24 offset:2048
v_mfma_f32_16x16x32_bf16 v[152:155], v[68:71], v[176:179], v[152:155]
ds_read_b64_tr_b16 v[52:53], v24 offset:4096
v_cvt_pk_bf16_f32 v232, v144, v145
v_mfma_f32_16x16x32_bf16 v[156:159], v[68:71], v[180:183], v[156:159]
ds_read_b64_tr_b16 v[54:55], v24 offset:6144
v_cvt_pk_bf16_f32 v233, v146, v147
v_mfma_f32_16x16x32_bf16 v[152:155], v[72:75], v[184:187], v[152:155]
ds_read_b64_tr_b16 v[56:57], v24 offset:8192
v_cvt_pk_bf16_f32 v234, v148, v149
v_mfma_f32_16x16x32_bf16 v[156:159], v[72:75], v[188:191], v[156:159]
ds_read_b64_tr_b16 v[58:59], v24 offset:10240
v_cvt_pk_bf16_f32 v235, v150, v151
L_mlp_pad9:
s_cbranch_execz L_mlp_padret
v_mfma_f32_16x16x32_bf16 v[152:155], v[76:79], v[192:195], v[152:155]
ds_read_b64_tr_b16 v[60:61], v24 offset:12288
s_add_u32 s36, s33, 491520
v_mfma_f32_16x16x32_bf16 v[156:159], v[76:79], v[196:199], v[156:159]
ds_read_b64_tr_b16 v[62:63], v24 offset:14336
s_waitcnt lgkmcnt(8)
v_mfma_f32_16x16x32_bf16 v[152:155], v[80:83], v[200:203], v[152:155]
ds_read_b64_tr_b16 v[64:65], v24 offset:16384
buffer_store_dwordx4 v[232:235], v240, s[20:23], s36 offen sc0 sc1
v_mfma_f32_16x16x32_bf16 v[156:159], v[80:83], v[204:207], v[156:159]
ds_read_b64_tr_b16 v[66:67], v24 offset:18432
v_mfma_f32_16x16x32_bf16 v[152:155], v[84:87], v[208:211], v[152:155]
ds_read_b64_tr_b16 v[68:69], v24 offset:20480
v_mfma_f32_16x16x32_bf16 v[156:159], v[84:87], v[212:215], v[156:159]
ds_read_b64_tr_b16 v[70:71], v24 offset:22528
v_mfma_f32_16x16x32_bf16 v[152:155], v[88:91], v[216:219], v[152:155]
ds_read_b64_tr_b16 v[72:73], v24 offset:24576
v_mfma_f32_16x16x32_bf16 v[156:159], v[88:91], v[220:223], v[156:159]
ds_read_b64_tr_b16 v[74:75], v24 offset:26624
v_mfma_f32_16x16x32_bf16 v[152:155], v[92:95], v[224:227], v[152:155]
ds_read_b64_tr_b16 v[76:77], v24 offset:28672
v_mfma_f32_16x16x32_bf16 v[156:159], v[92:95], v[228:231], v[156:159]
ds_read_b64_tr_b16 v[78:79], v24 offset:30720
s_waitcnt lgkmcnt(8)
v_mfma_f32_16x16x32_bf16 v[112:115], v[48:51], v[160:163], 0
ds_read_b64_tr_b16 v[80:81], v24 offset:32768
v_mfma_f32_16x16x32_bf16 v[116:119], v[48:51], v[164:167], 0
ds_read_b64_tr_b16 v[82:83], v24 offset:34816
v_mfma_f32_16x16x32_bf16 v[112:115], v[52:55], v[168:171], v[112:115]
ds_read_b64_tr_b16 v[84:85], v25 offset:0
v_mfma_f32_16x16x32_bf16 v[116:119], v[52:55], v[172:175], v[116:119]
ds_read_b64_tr_b16 v[86:87], v25 offset:2048
v_mfma_f32_16x16x32_bf16 v[112:115], v[56:59], v[176:179], v[112:115]
ds_read_b64_tr_b16 v[88:89], v25 offset:4096
v_cvt_pk_bf16_f32 v236, v152, v153
v_mfma_f32_16x16x32_bf16 v[116:119], v[56:59], v[180:183], v[116:119]
ds_read_b64_tr_b16 v[90:91], v25 offset:6144
v_cvt_pk_bf16_f32 v237, v154, v155
v_mfma_f32_16x16x32_bf16 v[112:115], v[60:63], v[184:187], v[112:115]
ds_read_b64_tr_b16 v[92:93], v25 offset:8192
v_cvt_pk_bf16_f32 v238, v156, v157
v_mfma_f32_16x16x32_bf16 v[116:119], v[60:63], v[188:191], v[116:119]
ds_read_b64_tr_b16 v[94:95], v25 offset:10240
s_waitcnt lgkmcnt(8)
v_mfma_f32_16x16x32_bf16 v[112:115], v[64:67], v[192:195], v[112:115]
ds_read_b64_tr_b16 v[48:49], v25 offset:12288
v_cvt_pk_bf16_f32 v239, v158, v159
v_mfma_f32_16x16x32_bf16 v[116:119], v[64:67], v[196:199], v[116:119]
ds_read_b64_tr_b16 v[50:51], v25 offset:14336
s_add_u32 s36, s33, 507904
v_mfma_f32_16x16x32_bf16 v[112:115], v[68:71], v[200:203], v[112:115]
ds_read_b64_tr_b16 v[52:53], v25 offset:16384
buffer_store_dwordx4 v[236:239], v240, s[20:23], s36 offen sc0 sc1
v_mfma_f32_16x16x32_bf16 v[116:119], v[68:71], v[204:207], v[116:119]
ds_read_b64_tr_b16 v[54:55], v25 offset:18432
v_mfma_f32_16x16x32_bf16 v[112:115], v[72:75], v[208:211], v[112:115]
ds_read_b64_tr_b16 v[56:57], v25 offset:20480
v_mfma_f32_16x16x32_bf16 v[116:119], v[72:75], v[212:215], v[116:119]
ds_read_b64_tr_b16 v[58:59], v25 offset:22528
v_mfma_f32_16x16x32_bf16 v[112:115], v[76:79], v[216:219], v[112:115]
ds_read_b64_tr_b16 v[60:61], v25 offset:24576
v_mfma_f32_16x16x32_bf16 v[116:119], v[76:79], v[220:223], v[116:119]
ds_read_b64_tr_b16 v[62:63], v25 offset:26624
s_waitcnt lgkmcnt(8)
v_mfma_f32_16x16x32_bf16 v[112:115], v[80:83], v[224:227], v[112:115]
ds_read_b64_tr_b16 v[64:65], v25 offset:28672
v_mfma_f32_16x16x32_bf16 v[116:119], v[80:83], v[228:231], v[116:119]
ds_read_b64_tr_b16 v[66:67], v25 offset:30720
v_mfma_f32_16x16x32_bf16 v[120:123], v[84:87], v[160:163], 0
ds_read_b64_tr_b16 v[68:69], v25 offset:32768
v_mfma_f32_16x16x32_bf16 v[124:127], v[84:87], v[164:167], 0
ds_read_b64_tr_b16 v[70:71], v25 offset:34816
v_mfma_f32_16x16x32_bf16 v[120:123], v[88:91], v[168:171], v[120:123]
ds_read_b64_tr_b16 v[72:73], v26 offset:0
v_mfma_f32_16x16x32_bf16 v[124:127], v[88:91], v[172:175], v[124:127]
ds_read_b64_tr_b16 v[74:75], v26 offset:2048
v_mfma_f32_16x16x32_bf16 v[120:123], v[92:95], v[176:179], v[120:123]
ds_read_b64_tr_b16 v[76:77], v26 offset:4096
v_cvt_pk_bf16_f32 v232, v112, v113
v_mfma_f32_16x16x32_bf16 v[124:127], v[92:95], v[180:183], v[124:127]
ds_read_b64_tr_b16 v[78:79], v26 offset:6144
s_waitcnt lgkmcnt(8)
v_mfma_f32_16x16x32_bf16 v[120:123], v[48:51], v[184:187], v[120:123]
ds_read_b64_tr_b16 v[80:81], v26 offset:8192
v_cvt_pk_bf16_f32 v233, v114, v115
v_mfma_f32_16x16x32_bf16 v[124:127], v[48:51], v[188:191], v[124:127]
ds_read_b64_tr_b16 v[82:83], v26 offset:10240
v_cvt_pk_bf16_f32 v234, v116, v117
v_mfma_f32_16x16x32_bf16 v[120:123], v[52:55], v[192:195], v[120:123]
ds_read_b64_tr_b16 v[84:85], v26 offset:12288
v_cvt_pk_bf16_f32 v235, v118, v119
v_mfma_f32_16x16x32_bf16 v[124:127], v[52:55], v[196:199], v[124:127]
ds_read_b64_tr_b16 v[86:87], v26 offset:14336
s_add_u32 s36, s33, 524288
v_mfma_f32_16x16x32_bf16 v[120:123], v[56:59], v[200:203], v[120:123]
ds_read_b64_tr_b16 v[88:89], v26 offset:16384
buffer_store_dwordx4 v[232:235], v240, s[20:23], s36 offen sc0 sc1
v_mfma_f32_16x16x32_bf16 v[124:127], v[56:59], v[204:207], v[124:127]
ds_read_b64_tr_b16 v[90:91], v26 offset:18432
v_mfma_f32_16x16x32_bf16 v[120:123], v[60:63], v[208:211], v[120:123]
ds_read_b64_tr_b16 v[92:93], v26 offset:20480
v_mfma_f32_16x16x32_bf16 v[124:127], v[60:63], v[212:215], v[124:127]
ds_read_b64_tr_b16 v[94:95], v26 offset:22528
s_waitcnt lgkmcnt(8)
v_mfma_f32_16x16x32_bf16 v[120:123], v[64:67], v[216:219], v[120:123]
ds_read_b64_tr_b16 v[48:49], v26 offset:24576
v_mfma_f32_16x16x32_bf16 v[124:127], v[64:67], v[220:223], v[124:127]
ds_read_b64_tr_b16 v[50:51], v26 offset:26624
v_mfma_f32_16x16x32_bf16 v[120:123], v[68:71], v[224:227], v[120:123]
ds_read_b64_tr_b16 v[52:53], v26 offset:28672
v_mfma_f32_16x16x32_bf16 v[124:127], v[68:71], v[228:231], v[124:127]
ds_read_b64_tr_b16 v[54:55], v26 offset:30720
v_mfma_f32_16x16x32_bf16 v[144:147], v[72:75], v[160:163], 0
ds_read_b64_tr_b16 v[56:57], v26 offset:32768
v_mfma_f32_16x16x32_bf16 v[148:151], v[72:75], v[164:167], 0
ds_read_b64_tr_b16 v[58:59], v26 offset:34816
v_mfma_f32_16x16x32_bf16 v[144:147], v[76:79], v[168:171], v[144:147]
ds_read_b64_tr_b16 v[60:61], v27 offset:0
v_mfma_f32_16x16x32_bf16 v[148:151], v[76:79], v[172:175], v[148:151]
ds_read_b64_tr_b16 v[62:63], v27 offset:2048
s_waitcnt lgkmcnt(8)
v_mfma_f32_16x16x32_bf16 v[144:147], v[80:83], v[176:179], v[144:147]
ds_read_b64_tr_b16 v[64:65], v27 offset:4096
v_cvt_pk_bf16_f32 v236, v120, v121
v_mfma_f32_16x16x32_bf16 v[148:151], v[80:83], v[180:183], v[148:151]
ds_read_b64_tr_b16 v[66:67], v27 offset:6144
v_cvt_pk_bf16_f32 v237, v122, v123
v_mfma_f32_16x16x32_bf16 v[144:147], v[84:87], v[184:187], v[144:147]
ds_read_b64_tr_b16 v[68:69], v27 offset:8192
v_cvt_pk_bf16_f32 v238, v124, v125
v_mfma_f32_16x16x32_bf16 v[148:151], v[84:87], v[188:191], v[148:151]
ds_read_b64_tr_b16 v[70:71], v27 offset:10240
v_cvt_pk_bf16_f32 v239, v126, v127
v_mfma_f32_16x16x32_bf16 v[144:147], v[88:91], v[192:195], v[144:147]
ds_read_b64_tr_b16 v[72:73], v27 offset:12288
s_add_u32 s36, s33, 540672
v_mfma_f32_16x16x32_bf16 v[148:151], v[88:91], v[196:199], v[148:151]
ds_read_b64_tr_b16 v[74:75], v27 offset:14336
buffer_store_dwordx4 v[236:239], v240, s[20:23], s36 offen sc0 sc1
v_mfma_f32_16x16x32_bf16 v[144:147], v[92:95], v[200:203], v[144:147]
ds_read_b64_tr_b16 v[76:77], v27 offset:16384
v_mfma_f32_16x16x32_bf16 v[148:151], v[92:95], v[204:207], v[148:151]
ds_read_b64_tr_b16 v[78:79], v27 offset:18432
s_waitcnt lgkmcnt(8)
v_mfma_f32_16x16x32_bf16 v[144:147], v[48:51], v[208:211], v[144:147]
ds_read_b64_tr_b16 v[80:81], v27 offset:20480
v_mfma_f32_16x16x32_bf16 v[148:151], v[48:51], v[212:215], v[148:151]
ds_read_b64_tr_b16 v[82:83], v27 offset:22528
v_mfma_f32_16x16x32_bf16 v[144:147], v[52:55], v[216:219], v[144:147]
ds_read_b64_tr_b16 v[84:85], v27 offset:24576
v_mfma_f32_16x16x32_bf16 v[148:151], v[52:55], v[220:223], v[148:151]
ds_read_b64_tr_b16 v[86:87], v27 offset:26624
v_mfma_f32_16x16x32_bf16 v[144:147], v[56:59], v[224:227], v[144:147]
ds_read_b64_tr_b16 v[88:89], v27 offset:28672
v_mfma_f32_16x16x32_bf16 v[148:151], v[56:59], v[228:231], v[148:151]
ds_read_b64_tr_b16 v[90:91], v27 offset:30720
v_mfma_f32_16x16x32_bf16 v[152:155], v[60:63], v[160:163], 0
ds_read_b64_tr_b16 v[92:93], v27 offset:32768
v_mfma_f32_16x16x32_bf16 v[156:159], v[60:63], v[164:167], 0
ds_read_b64_tr_b16 v[94:95], v27 offset:34816
s_waitcnt lgkmcnt(8)
v_mfma_f32_16x16x32_bf16 v[152:155], v[64:67], v[168:171], v[152:155]
v_mfma_f32_16x16x32_bf16 v[156:159], v[64:67], v[172:175], v[156:159]
v_mfma_f32_16x16x32_bf16 v[152:155], v[68:71], v[176:179], v[152:155]
v_cvt_pk_bf16_f32 v232, v144, v145
v_mfma_f32_16x16x32_bf16 v[156:159], v[68:71], v[180:183], v[156:159]
v_cvt_pk_bf16_f32 v233, v146, v147
v_mfma_f32_16x16x32_bf16 v[152:155], v[72:75], v[184:187], v[152:155]
v_cvt_pk_bf16_f32 v234, v148, v149
v_mfma_f32_16x16x32_bf16 v[156:159], v[72:75], v[188:191], v[156:159]
v_cvt_pk_bf16_f32 v235, v150, v151
v_mfma_f32_16x16x32_bf16 v[152:155], v[76:79], v[192:195], v[152:155]
s_add_u32 s36, s33, 557056
v_mfma_f32_16x16x32_bf16 v[156:159], v[76:79], v[196:199], v[156:159]
s_waitcnt lgkmcnt(0)
v_mfma_f32_16x16x32_bf16 v[152:155], v[80:83], v[200:203], v[152:155]
buffer_store_dwordx4 v[232:235], v240, s[20:23], s36 offen sc0 sc1
v_mfma_f32_16x16x32_bf16 v[156:159], v[80:83], v[204:207], v[156:159]
v_mfma_f32_16x16x32_bf16 v[152:155], v[84:87], v[208:211], v[152:155]
v_mfma_f32_16x16x32_bf16 v[156:159], v[84:87], v[212:215], v[156:159]
v_mfma_f32_16x16x32_bf16 v[152:155], v[88:91], v[216:219], v[152:155]
v_mfma_f32_16x16x32_bf16 v[156:159], v[88:91], v[220:223], v[156:159]
v_mfma_f32_16x16x32_bf16 v[152:155], v[92:95], v[224:227], v[152:155]
v_mfma_f32_16x16x32_bf16 v[156:159], v[92:95], v[228:231], v[156:159]
L_mlp_alend:
s_nop 7
v_cvt_pk_bf16_f32 v236, v152, v153
v_cvt_pk_bf16_f32 v237, v154, v155
v_cvt_pk_bf16_f32 v238, v156, v157
v_cvt_pk_bf16_f32 v239, v158, v159
s_add_u32 s36, s33, 573440
s_nop 1
buffer_store_dwordx4 v[236:239], v240, s[20:23], s36 offen sc0 sc1
L_mlp_end:
s_endpgm
.globl reduce_kernel
.p2align 8
.type reduce_kernel,@function
reduce_kernel:
s_cmp_ge_u32 s2, 576
s_cbranch_scc1 L_red_end
s_load_dwordx2 s[4:5], s[0:1], 72
s_load_dwordx2 s[6:7], s[0:1], 88
v_lshrrev_b32 v1, 6, v0
v_and_b32 v2, 63, v0
s_nop 0
v_readfirstlane_b32 s16, v1
s_mul_i32 s17, s2, 4
s_add_u32 s17, s17, s16
s_mul_hi_u32 s18, s17, 119304648
s_mul_i32 s19, s18, 36
s_sub_u32 s19, s17, s19
s_waitcnt lgkmcnt(0)
s_mov_b32 s8, s4
s_and_b32 s9, s5, 0xffff
s_mov_b32 s10, 2359296
s_mov_b32 s11, 0x00020000
s_mov_b32 s12, s6
s_and_b32 s13, s7, 0xffff
s_mov_b32 s14, 268435456
s_mov_b32 s15, 0x00020000
v_lshlrev_b32 v3, 4, v2
s_lshl_b32 s20, s17, 14
s_add_u32 s20, s20, 16777216
s_lshl_b32 s21, s17, 10
s_add_u32 s21, s21, 2621440
s_lshl_b32 s22, s19, 6
s_add_u32 s22, s22, 10492672
v_lshrrev_b32 v4, 4, v2
v_lshlrev_b32 v5, 4, v4
buffer_load_dwordx4 v[16:19], v3, s[12:15], s20 offen offset:0
buffer_load_dwordx4 v[20:23], v3, s[12:15], s20 offen offset:1024
buffer_load_dwordx4 v[24:27], v3, s[12:15], s20 offen offset:2048
buffer_load_dwordx4 v[28:31], v3, s[12:15], s20 offen offset:3072
s_add_u32 s20, s20, 4096
buffer_load_dwordx4 v[32:35], v3, s[12:15], s20 offen offset:0
buffer_load_dwordx4 v[36:39], v3, s[12:15], s20 offen offset:1024
buffer_load_dwordx4 v[40:43], v3, s[12:15], s20 offen offset:2048
buffer_load_dwordx4 v[44:47], v3, s[12:15], s20 offen offset:3072
s_add_u32 s20, s20, 4096
buffer_load_dwordx4 v[48:51], v3, s[12:15], s20 offen offset:0
buffer_load_dwordx4 v[52:55], v3, s[12:15], s20 offen offset:1024
buffer_load_dwordx4 v[56:59], v3, s[12:15], s20 offen offset:2048
buffer_load_dwordx4 v[60:63], v3, s[12:15], s20 offen offset:3072
s_add_u32 s20, s20, 4096
buffer_load_dwordx4 v[64:67], v3, s[12:15], s20 offen offset:0
buffer_load_dwordx4 v[68:71], v3, s[12:15], s20 offen offset:1024
buffer_load_dwordx4 v[72:75], v3, s[12:15], s20 offen offset:2048
buffer_load_dwordx4 v[76:79], v3, s[12:15], s20 offen offset:3072
buffer_load_dwordx4 v[8:11], v3, s[12:15], s21 offen
buffer_load_dwordx4 v[12:15], v5, s[12:15], s22 offen
s_waitcnt vmcnt(17)
v_lshlrev_b32 v80, 16, v16
v_and_b32 v81, 0xffff0000, v16
v_lshlrev_b32 v82, 16, v17
v_and_b32 v83, 0xffff0000, v17
v_lshlrev_b32 v84, 16, v18
v_and_b32 v85, 0xffff0000, v18
v_lshlrev_b32 v86, 16, v19
v_and_b32 v87, 0xffff0000, v19
s_waitcnt vmcnt(16)
v_lshlrev_b32 v6, 16, v20
v_and_b32 v7, 0xffff0000, v20
v_add_f32 v80, v80, v6
v_add_f32 v81, v81, v7
v_lshlrev_b32 v6, 16, v21
v_and_b32 v7, 0xffff0000, v21
v_add_f32 v82, v82, v6
v_add_f32 v83, v83, v7
v_lshlrev_b32 v6, 16, v22
v_and_b32 v7, 0xffff0000, v22
v_add_f32 v84, v84, v6
v_add_f32 v85, v85, v7
v_lshlrev_b32 v6, 16, v23
v_and_b32 v7, 0xffff0000, v23
v_add_f32 v86, v86, v6
v_add_f32 v87, v87, v7
s_waitcnt vmcnt(15)
v_lshlrev_b32 v6, 16, v24
v_and_b32 v7, 0xffff0000, v24
v_add_f32 v80, v80, v6
v_add_f32 v81, v81, v7
v_lshlrev_b32 v6, 16, v25
v_and_b32 v7, 0xffff0000, v25
v_add_f32 v82, v82, v6
v_add_f32 v83, v83, v7
v_lshlrev_b32 v6, 16, v26
v_and_b32 v7, 0xffff0000, v26
v_add_f32 v84, v84, v6
v_add_f32 v85, v85, v7
v_lshlrev_b32 v6, 16, v27
v_and_b32 v7, 0xffff0000, v27
v_add_f32 v86, v86, v6
v_add_f32 v87, v87, v7
s_waitcnt vmcnt(14)
v_lshlrev_b32 v6, 16, v28
v_and_b32 v7, 0xffff0000, v28
v_add_f32 v80, v80, v6
v_add_f32 v81, v81, v7
v_lshlrev_b32 v6, 16, v29
v_and_b32 v7, 0xffff0000, v29
v_add_f32 v82, v82, v6
v_add_f32 v83, v83, v7
v_lshlrev_b32 v6, 16, v30
v_and_b32 v7, 0xffff0000, v30
v_add_f32 v84, v84, v6
v_add_f32 v85, v85, v7
v_lshlrev_b32 v6, 16, v31
v_and_b32 v7, 0xffff0000, v31
v_add_f32 v86, v86, v6
v_add_f32 v87, v87, v7
s_waitcnt vmcnt(13)
v_lshlrev_b32 v6, 16, v32
v_and_b32 v7, 0xffff0000, v32
v_add_f32 v80, v80, v6
v_add_f32 v81, v81, v7
v_lshlrev_b32 v6, 16, v33
v_and_b32 v7, 0xffff0000, v33
v_add_f32 v82, v82, v6
v_add_f32 v83, v83, v7
v_lshlrev_b32 v6, 16, v34
v_and_b32 v7, 0xffff0000, v34
v_add_f32 v84, v84, v6
v_add_f32 v85, v85, v7
v_lshlrev_b32 v6, 16, v35
v_and_b32 v7, 0xffff0000, v35
v_add_f32 v86, v86, v6
v_add_f32 v87, v87, v7
s_waitcnt vmcnt(12)
v_lshlrev_b32 v6, 16, v36
v_and_b32 v7, 0xffff0000, v36
v_add_f32 v80, v80, v6
v_add_f32 v81, v81, v7
v_lshlrev_b32 v6, 16, v37
v_and_b32 v7, 0xffff0000, v37
v_add_f32 v82, v82, v6
v_add_f32 v83, v83, v7
v_lshlrev_b32 v6, 16, v38
v_and_b32 v7, 0xffff0000, v38
v_add_f32 v84, v84, v6
v_add_f32 v85, v85, v7
v_lshlrev_b32 v6, 16, v39
v_and_b32 v7, 0xffff0000, v39
v_add_f32 v86, v86, v6
v_add_f32 v87, v87, v7
s_waitcnt vmcnt(11)
v_lshlrev_b32 v6, 16, v40
v_and_b32 v7, 0xffff0000, v40
v_add_f32 v80, v80, v6
v_add_f32 v81, v81, v7
v_lshlrev_b32 v6, 16, v41
v_and_b32 v7, 0xffff0000, v41
v_add_f32 v82, v82, v6
v_add_f32 v83, v83, v7
v_lshlrev_b32 v6, 16, v42
v_and_b32 v7, 0xffff0000, v42
v_add_f32 v84, v84, v6
v_add_f32 v85, v85, v7
v_lshlrev_b32 v6, 16, v43
v_and_b32 v7, 0xffff0000, v43
v_add_f32 v86, v86, v6
v_add_f32 v87, v87, v7
s_waitcnt vmcnt(10)
v_lshlrev_b32 v6, 16, v44
v_and_b32 v7, 0xffff0000, v44
v_add_f32 v80, v80, v6
v_add_f32 v81, v81, v7
v_lshlrev_b32 v6, 16, v45
v_and_b32 v7, 0xffff0000, v45
v_add_f32 v82, v82, v6
v_add_f32 v83, v83, v7
v_lshlrev_b32 v6, 16, v46
v_and_b32 v7, 0xffff0000, v46
v_add_f32 v84, v84, v6
v_add_f32 v85, v85, v7
v_lshlrev_b32 v6, 16, v47
v_and_b32 v7, 0xffff0000, v47
v_add_f32 v86, v86, v6
v_add_f32 v87, v87, v7
s_waitcnt vmcnt(9)
v_lshlrev_b32 v6, 16, v48
v_and_b32 v7, 0xffff0000, v48
v_add_f32 v80, v80, v6
v_add_f32 v81, v81, v7
v_lshlrev_b32 v6, 16, v49
v_and_b32 v7, 0xffff0000, v49
v_add_f32 v82, v82, v6
v_add_f32 v83, v83, v7
v_lshlrev_b32 v6, 16, v50
v_and_b32 v7, 0xffff0000, v50
v_add_f32 v84, v84, v6
v_add_f32 v85, v85, v7
v_lshlrev_b32 v6, 16, v51
v_and_b32 v7, 0xffff0000, v51
v_add_f32 v86, v86, v6
v_add_f32 v87, v87, v7
s_waitcnt vmcnt(8)
v_lshlrev_b32 v6, 16, v52
v_and_b32 v7, 0xffff0000, v52
v_add_f32 v80, v80, v6
v_add_f32 v81, v81, v7
v_lshlrev_b32 v6, 16, v53
v_and_b32 v7, 0xffff0000, v53
v_add_f32 v82, v82, v6
v_add_f32 v83, v83, v7
v_lshlrev_b32 v6, 16, v54
v_and_b32 v7, 0xffff0000, v54
v_add_f32 v84, v84, v6
v_add_f32 v85, v85, v7
v_lshlrev_b32 v6, 16, v55
v_and_b32 v7, 0xffff0000, v55
v_add_f32 v86, v86, v6
v_add_f32 v87, v87, v7
s_waitcnt vmcnt(7)
v_lshlrev_b32 v6, 16, v56
v_and_b32 v7, 0xffff0000, v56
v_add_f32 v80, v80, v6
v_add_f32 v81, v81, v7
v_lshlrev_b32 v6, 16, v57
v_and_b32 v7, 0xffff0000, v57
v_add_f32 v82, v82, v6
v_add_f32 v83, v83, v7
v_lshlrev_b32 v6, 16, v58
v_and_b32 v7, 0xffff0000, v58
v_add_f32 v84, v84, v6
v_add_f32 v85, v85, v7
v_lshlrev_b32 v6, 16, v59
v_and_b32 v7, 0xffff0000, v59
v_add_f32 v86, v86, v6
v_add_f32 v87, v87, v7
s_waitcnt vmcnt(6)
v_lshlrev_b32 v6, 16, v60
v_and_b32 v7, 0xffff0000, v60
v_add_f32 v80, v80, v6
v_add_f32 v81, v81, v7
v_lshlrev_b32 v6, 16, v61
v_and_b32 v7, 0xffff0000, v61
v_add_f32 v82, v82, v6
v_add_f32 v83, v83, v7
v_lshlrev_b32 v6, 16, v62
v_and_b32 v7, 0xffff0000, v62
v_add_f32 v84, v84, v6
v_add_f32 v85, v85, v7
v_lshlrev_b32 v6, 16, v63
v_and_b32 v7, 0xffff0000, v63
v_add_f32 v86, v86, v6
v_add_f32 v87, v87, v7
s_waitcnt vmcnt(5)
v_lshlrev_b32 v6, 16, v64
v_and_b32 v7, 0xffff0000, v64
v_add_f32 v80, v80, v6
v_add_f32 v81, v81, v7
v_lshlrev_b32 v6, 16, v65
v_and_b32 v7, 0xffff0000, v65
v_add_f32 v82, v82, v6
v_add_f32 v83, v83, v7
v_lshlrev_b32 v6, 16, v66
v_and_b32 v7, 0xffff0000, v66
v_add_f32 v84, v84, v6
v_add_f32 v85, v85, v7
v_lshlrev_b32 v6, 16, v67
v_and_b32 v7, 0xffff0000, v67
v_add_f32 v86, v86, v6
v_add_f32 v87, v87, v7
s_waitcnt vmcnt(4)
v_lshlrev_b32 v6, 16, v68
v_and_b32 v7, 0xffff0000, v68
v_add_f32 v80, v80, v6
v_add_f32 v81, v81, v7
v_lshlrev_b32 v6, 16, v69
v_and_b32 v7, 0xffff0000, v69
v_add_f32 v82, v82, v6
v_add_f32 v83, v83, v7
v_lshlrev_b32 v6, 16, v70
v_and_b32 v7, 0xffff0000, v70
v_add_f32 v84, v84, v6
v_add_f32 v85, v85, v7
v_lshlrev_b32 v6, 16, v71
v_and_b32 v7, 0xffff0000, v71
v_add_f32 v86, v86, v6
v_add_f32 v87, v87, v7
s_waitcnt vmcnt(3)
v_lshlrev_b32 v6, 16, v72
v_and_b32 v7, 0xffff0000, v72
v_add_f32 v80, v80, v6
v_add_f32 v81, v81, v7
v_lshlrev_b32 v6, 16, v73
v_and_b32 v7, 0xffff0000, v73
v_add_f32 v82, v82, v6
v_add_f32 v83, v83, v7
v_lshlrev_b32 v6, 16, v74
v_and_b32 v7, 0xffff0000, v74
v_add_f32 v84, v84, v6
v_add_f32 v85, v85, v7
v_lshlrev_b32 v6, 16, v75
v_and_b32 v7, 0xffff0000, v75
v_add_f32 v86, v86, v6
v_add_f32 v87, v87, v7
s_waitcnt vmcnt(2)
v_lshlrev_b32 v6, 16, v76
v_and_b32 v7, 0xffff0000, v76
v_add_f32 v80, v80, v6
v_add_f32 v81, v81, v7
v_lshlrev_b32 v6, 16, v77
v_and_b32 v7, 0xffff0000, v77
v_add_f32 v82, v82, v6
v_add_f32 v83, v83, v7
v_lshlrev_b32 v6, 16, v78
v_and_b32 v7, 0xffff0000, v78
v_add_f32 v84, v84, v6
v_add_f32 v85, v85, v7
v_lshlrev_b32 v6, 16, v79
v_and_b32 v7, 0xffff0000, v79
v_add_f32 v86, v86, v6
v_add_f32 v87, v87, v7
s_waitcnt vmcnt(0)
v_lshlrev_b32 v6, 16, v8
v_and_b32 v7, 0xffff0000, v8
v_fma_f32 v80, v80, v12, v6
v_fma_f32 v81, v81, v13, v7
v_lshlrev_b32 v6, 16, v9
v_and_b32 v7, 0xffff0000, v9
v_fma_f32 v82, v82, v14, v6
v_fma_f32 v83, v83, v15, v7
v_lshlrev_b32 v6, 16, v10
v_and_b32 v7, 0xffff0000, v10
v_fma_f32 v84, v84, v12, v6
v_fma_f32 v85, v85, v13, v7
v_lshlrev_b32 v6, 16, v11
v_and_b32 v7, 0xffff0000, v11
v_fma_f32 v86, v86, v14, v6
v_fma_f32 v87, v87, v15, v7
v_cvt_pk_bf16_f32 v90, v80, v81
v_cvt_pk_bf16_f32 v91, v82, v83
v_cvt_pk_bf16_f32 v92, v84, v85
v_cvt_pk_bf16_f32 v93, v86, v87
s_nop 1
v_permlane16_swap_b32 v90, v92
v_permlane16_swap_b32 v91, v93
v_and_b32 v6, 15, v2
v_and_b32 v7, 1, v4
v_lshl_add_u32 v6, v7, 4, v6
v_mul_u32_u24 v6, 1152, v6
v_lshrrev_b32 v7, 1, v4
v_lshl_add_u32 v6, v7, 4, v6
s_mul_i32 s23, s18, 36864
s_lshl_b32 s24, s19, 5
s_add_u32 s23, s23, s24
buffer_store_dwordx4 v[90:93], v6, s[8:11], s23 offen
L_red_padret:
L_red_end:
s_endpgm
L_text_end:
s_endpgm
.section .rodata,"a"
.p2align 6
.amdhsa_kernel prep_kernel
.amdhsa_next_free_vgpr 256
.amdhsa_next_free_sgpr 96
.amdhsa_accum_offset 256
.amdhsa_group_segment_fixed_size 0
.amdhsa_kernarg_size 96
.amdhsa_user_sgpr_count 2
.amdhsa_user_sgpr_kernarg_segment_ptr 1
.amdhsa_system_sgpr_workgroup_id_x 1
.amdhsa_float_denorm_mode_32 3
.end_amdhsa_kernel
.p2align 6
.amdhsa_kernel qkv_kernel
.amdhsa_next_free_vgpr 408
.amdhsa_next_free_sgpr 96
.amdhsa_accum_offset 256
.amdhsa_group_segment_fixed_size 0
.amdhsa_kernarg_size 96
.amdhsa_user_sgpr_count 2
.amdhsa_user_sgpr_kernarg_segment_ptr 1
.amdhsa_system_sgpr_workgroup_id_x 1
.amdhsa_float_denorm_mode_32 3
.end_amdhsa_kernel
.p2align 6
.amdhsa_kernel wo_kernel
.amdhsa_next_free_vgpr 448
.amdhsa_next_free_sgpr 96
.amdhsa_accum_offset 256
.amdhsa_group_segment_fixed_size 0
.amdhsa_kernarg_size 96
.amdhsa_user_sgpr_count 2
.amdhsa_user_sgpr_kernarg_segment_ptr 1
.amdhsa_system_sgpr_workgroup_id_x 1
.amdhsa_float_denorm_mode_32 3
.end_amdhsa_kernel
.p2align 6
.amdhsa_kernel mlp_kernel
.amdhsa_next_free_vgpr 400
.amdhsa_next_free_sgpr 96
.amdhsa_accum_offset 256
.amdhsa_group_segment_fixed_size 0
.amdhsa_kernarg_size 96
.amdhsa_user_sgpr_count 2
.amdhsa_user_sgpr_kernarg_segment_ptr 1
.amdhsa_system_sgpr_workgroup_id_x 1
.amdhsa_float_denorm_mode_32 3
.end_amdhsa_kernel
.p2align 6
.amdhsa_kernel reduce_kernel
.amdhsa_next_free_vgpr 96
.amdhsa_next_free_sgpr 96
.amdhsa_accum_offset 96
.amdhsa_group_segment_fixed_size 0
.amdhsa_kernarg_size 96
.amdhsa_user_sgpr_count 2
.amdhsa_user_sgpr_kernarg_segment_ptr 1
.amdhsa_system_sgpr_workgroup_id_x 1
.amdhsa_float_denorm_mode_32 3
.end_amdhsa_kernel
```
